```python
import torch

def _softmax(x, axis=-1):
    return torch.softmax(x, dim=axis)
def _gelu(x):
    return torch.nn.functional.gelu(x, approximate="tanh")
def _silu(x):
    return torch.nn.functional.silu(x)
def _sigmoid(x):
    return torch.sigmoid(x)
def _layernorm(x, axis=-1, eps=1e-5):
    m = x.mean(dim=axis, keepdim=True)
    v = x.var(dim=axis, keepdim=True, unbiased=False)
    return (x - m) / torch.sqrt(v + eps)
def _scatter_add(tgt, idx, src, axis=0):
    return tgt.clone().index_add_(axis, idx, src)
def _segment_sum(src, seg, n):
    out = torch.zeros((n,) + src.shape[1:], dtype=src.dtype)
    return out.index_add_(0, seg, src)
def _pad(x, pw):
    flat = tuple(v for pair in reversed(pw) for v in pair)
    return torch.nn.functional.pad(x, flat)

kernel_name = 'sequential_preLN__linear_attn_block__swiglu_ffn__prompt'

def setup_inputs():

    _w = (lambda a: (lambda t: t.to(torch.bfloat16) if t.is_floating_point() else t)(torch.as_tensor(a)))
    def _A_setup():
        B, S, D = 1, 2048, 512
        return {
            "x": _w((lambda *s: torch.randn(*s, dtype=torch.bfloat16) * 0.05)(B, S, D)),
            "wqkv": _w((lambda *s: torch.randn(*s, dtype=torch.bfloat16) * 0.05)(D, 3 * D)),
            "wo": _w((lambda *s: torch.randn(*s, dtype=torch.bfloat16) * 0.05)(D, D)),
        }
    _A_in = _A_setup()

    def _B_setup():
        B, S, D, F = 1, 2048, 512, 1792
        return {
            "x": _w((lambda *s: torch.randn(*s, dtype=torch.bfloat16) * 0.05)(B, S, D)),
            "w_gate": _w((lambda *s: torch.randn(*s, dtype=torch.bfloat16) * 0.05)(D, F)),
            "w_up": _w((lambda *s: torch.randn(*s, dtype=torch.bfloat16) * 0.05)(D, F)),
            "w_down": _w((lambda *s: torch.randn(*s, dtype=torch.bfloat16) * 0.05)(F, D)),
        }
    _B_in = _B_setup()

    return {
        "A_x": _A_in["x"],
        "A_wqkv": _A_in["wqkv"],
        "A_wo": _A_in["wo"],
        "B_x": _B_in["x"],
        "B_w_gate": _B_in["w_gate"],
        "B_w_up": _B_in["w_up"],
        "B_w_down": _B_in["w_down"],
    }

def reference(A_x, A_wqkv, A_wo, B_x, B_w_gate, B_w_up, B_w_down):
    def _A_ref(x, wqkv, wo):
        B, S, D = x.shape
        H = 32; Dh = D // H
        qkv = (lambda x, *d: x.permute(*d))((x @ wqkv).reshape(B, S, 3, H, Dh), 2, 0, 3, 1, 4)
        q, k, v = qkv[0], qkv[1], qkv[2]
        phi = lambda t: torch.where(t > 0, t + 1, torch.exp(t)) + 1e-6
        pq, pk = phi(q), phi(k)
        kv = torch.einsum("bhsd,bhse->bhde", pk, v)
        z = torch.einsum("bhsd->bhd", pk)
        num = torch.einsum("bhqd,bhde->bhqe", pq, kv)
        den = torch.einsum("bhqd,bhd->bhq", pq, z)[..., None] + 1e-6
        o = num / den
        return (lambda x, *d: x.permute(*d))(o, 0, 2, 1, 3).reshape(B, S, D) @ wo

    def _B_ref(x, w_gate, w_up, w_down):
        g = _silu(x @ w_gate)
        u = x @ w_up
        return (g * u) @ w_down

    x = A_x
    h = x + _A_ref(_layernorm(x, axis=-1), A_wqkv, A_wo)
    h2 = h + _B_ref(_layernorm(h, axis=-1), B_w_gate, B_w_up, B_w_down)
    return h2
```

```asm
; @launch kernel=k1_kernel grid=(256,1,1) block=(512,1,1) lds=163840
; @launch kernel=kf_kernel grid=(256,1,1) block=(256,1,1) lds=163840
.amdgcn_target "amdgcn-amd-amdhsa--gfx950"
.text
.globl k1_kernel
.p2align 8
.type k1_kernel,@function
k1_kernel:
  s_cmp_ge_u32 s2, 256
  s_cbranch_scc1 k1_end
  s_load_dwordx16 s[16:31], s[0:1], 0
  s_load_dwordx4 s[32:35], s[0:1], 64
  v_lshrrev_b32 v1, 6, v0
  v_and_b32 v0, 63, v0
  v_readfirstlane_b32 s3, v1
  s_waitcnt lgkmcnt(0)
  s_mov_b32 s59, s3
  s_and_b32 s3, s3, 3
  v_and_b32 v1, 3, v1
  s_and_b32 s4, s2, 7
  s_lshr_b32 s5, s2, 3
  s_lshr_b32 s6, s4, 1
  s_lshl_b32 s6, s6, 3
  s_lshr_b32 s7, s5, 2
  s_add_u32 s6, s6, s7
  s_and_b32 s4, s4, 1
  s_lshl_b32 s4, s4, 2
  s_and_b32 s5, s5, 3
  s_add_u32 s5, s5, s4
  s_mov_b32 s44, s34
  s_mov_b32 s45, s35
  s_mov_b32 s46, 34816
  s_mov_b32 s47, 0x20000
  s_mov_b32 s48, s32
  s_mov_b32 s49, s33
  s_mov_b32 s50, 256
  s_mov_b32 s51, 0x20000
  s_cmp_ge_u32 s59, 4
  s_cbranch_scc1 k1_loader
  s_cmp_eq_u32 s3, 0
  s_cbranch_scc1 k1_w0
  s_cmp_eq_u32 s3, 1
  s_cbranch_scc1 k1_w1
  s_cmp_eq_u32 s3, 2
  s_cbranch_scc1 k1_w2
k1_w3:
  v_and_b32 v20, 31, v0
  v_lshrrev_b32 v21, 5, v0
  v_bfe_u32 v22, v0, 1, 3
  v_xor_b32 v22, v22, v21
  v_lshlrev_b32 v22, 4, v22
  v_lshl_add_u32 v22, v20, 7, v22
  v_add_u32 v8, 4096, v22
  v_xor_b32 v9, 32, v8
  v_xor_b32 v10, 64, v8
  v_xor_b32 v11, 96, v8
  v_add_u32 v12, 0x10000, v8
  v_add_u32 v13, 0x10000, v9
  v_add_u32 v14, 0x10000, v10
  v_add_u32 v15, 0x10000, v11
  v_bfe_u32 v22, v0, 2, 2
  v_lshl_add_u32 v23, v21, 3, v22
  v_mul_u32_u24 v23, 384, v23
  v_bfe_u32 v22, v0, 3, 1
  v_xor_b32 v22, 1, v22
  v_lshl_add_u32 v23, v22, 6, v23
  v_bfe_u32 v22, v0, 4, 1
  v_lshl_add_u32 v23, v22, 5, v23
  v_and_b32 v22, 3, v0
  v_lshl_add_u32 v16, v22, 3, v23
  v_add_u32 v17, 0x10000, v16
  v_mov_b32 v112, 0
  v_mov_b32 v113, 0
  v_mov_b32 v114, 0
  v_mov_b32 v115, 0
  v_mov_b32 v116, 0
  v_mov_b32 v117, 0
  v_mov_b32 v118, 0
  v_mov_b32 v232, 0
  v_mov_b32 v233, 0
  v_mov_b32 v234, 0
  v_mov_b32 v235, 0
  v_mov_b32 v236, 0
  v_mov_b32 v237, 0
  v_mov_b32 v238, 0
  v_and_b32 v18, 3, v0
  v_lshlrev_b32 v18, 4, v18
  v_add_u32 v18, 159936, v18
  v_mov_b32 v24, 0
  v_mov_b32 v25, 0
  v_mov_b32 v26, 0
  v_mov_b32 v27, 0
  ds_write_b128 v18, v[24:27]
  v_mov_b32 v119, 159744
  v_mov_b32 v123, 1
  s_mov_b32 s36, s16
  s_mov_b32 s37, s17
  s_mov_b32 s38, 2097152
  s_mov_b32 s39, 0x20000
  s_mov_b32 s40, s18
  s_mov_b32 s41, s19
  s_mov_b32 s42, 1572864
  s_mov_b32 s43, 0x20000
  s_lshr_b32 s12, s2, 3
  s_lshl_b32 s12, s12, 2
  s_add_u32 s12, s12, 3
  s_and_b32 s13, s2, 7
  s_lshr_b32 s15, s13, 1
  s_lshl_b32 s15, s15, 19
  s_lshl_b32 s14, s12, 12
  s_add_u32 s15, s15, s14
  v_lshlrev_b32 v245, 7, v20
  v_min_u32 v22, 47, v0
  v_mul_u32_u24 v23, 43, v22
  v_lshrrev_b32 v23, 9, v23
  v_mul_u32_u24 v24, 12, v23
  v_sub_u32 v24, v22, v24
  v_mul_u32_u24 v23, 3072, v23
  v_lshrrev_b32 v25, 2, v24
  v_lshl_add_u32 v23, v25, 10, v23
  v_and_b32 v24, 3, v24
  v_lshl_add_u32 v23, v24, 7, v23
  s_mul_i32 s14, s12, 12288
  s_and_b32 s13, s13, 1
  s_lshl_b32 s13, s13, 9
  s_add_u32 s14, s14, s13
  s_waitcnt lgkmcnt(0)
  s_barrier
  v_mov_b32 v176, 0x3f800008
  v_mov_b32 v177, 0x3f800008
  v_mov_b32 v178, 0x3fb8aa3b
  v_mov_b32 v179, 0x3fb8aa3b
  v_mov_b32 v180, 0xbfb8aa47
  v_mov_b32 v181, 0xbfb8aa47
  v_mov_b32 v182, 0x358637bd
  v_mov_b32 v183, 0x358637bd
  v_mov_b32 v224, 0x3f803f80
  v_mov_b32 v225, 0x3f803f80
  v_mov_b32 v226, 0x3f803f80
  v_mov_b32 v227, 0x3f803f80
  v_lshlrev_b32 v228, 2, v20
  v_add_u32 v229, 160000, v228
  v_add_u32 v228, 156672, v228
  v_lshlrev_b32 v230, 4, v21
  v_add_u32 v230, 160000, v230
  s_barrier
  buffer_load_dword v240, v245, s[36:39], s15 offen
  ds_read_b128 v[24:27], v8 offset:0
  ds_read_b64_tr_b16 v[32:33], v16 offset:8192
  ds_read_b64_tr_b16 v[34:35], v16 offset:9728
  ds_read_b64_tr_b16 v[36:37], v16 offset:8320
  ds_read_b64_tr_b16 v[38:39], v16 offset:9856
  ds_read_b64_tr_b16 v[40:41], v16 offset:8448
  ds_read_b64_tr_b16 v[42:43], v16 offset:9984
  s_waitcnt lgkmcnt(0)
  v_mfma_f32_32x32x16_bf16 v[64:79], v[32:35], v[24:27], 0
  ds_read_b128 v[28:31], v9 offset:0
  ds_read_b64_tr_b16 v[44:45], v16 offset:14336
  ds_read_b64_tr_b16 v[46:47], v16 offset:15872
  ds_read_b64_tr_b16 v[48:49], v16 offset:14464
  v_mfma_f32_32x32x16_bf16 v[80:95], v[24:27], v[36:39], 0
  ds_read_b64_tr_b16 v[50:51], v16 offset:16000
  ds_read_b64_tr_b16 v[52:53], v16 offset:14592
  ds_read_b64_tr_b16 v[54:55], v16 offset:16128
  v_mfma_f32_32x32x16_bf16 v[96:111], v[24:27], v[40:43], 0
  s_waitcnt lgkmcnt(0)
  v_mfma_f32_32x32x16_bf16 v[64:79], v[44:47], v[28:31], v[64:79]
  ds_read_b128 v[24:27], v10 offset:0
  ds_read_b64_tr_b16 v[32:33], v16 offset:20480
  ds_read_b64_tr_b16 v[34:35], v16 offset:22016
  ds_read_b64_tr_b16 v[36:37], v16 offset:20608
  v_mfma_f32_32x32x16_bf16 v[80:95], v[28:31], v[48:51], v[80:95]
  ds_read_b64_tr_b16 v[38:39], v16 offset:22144
  ds_read_b64_tr_b16 v[40:41], v16 offset:20736
  ds_read_b64_tr_b16 v[42:43], v16 offset:22272
  v_mfma_f32_32x32x16_bf16 v[96:111], v[28:31], v[52:55], v[96:111]
  v_dot2c_f32_bf16 v112, 0x3f803f80, v28
  v_dot2c_f32_bf16 v114, v28, v28
  v_dot2c_f32_bf16 v113, 0x3f803f80, v29
  v_dot2c_f32_bf16 v115, v29, v29
  v_dot2c_f32_bf16 v232, 0x3f803f80, v30
  v_dot2c_f32_bf16 v234, v30, v30
  v_dot2c_f32_bf16 v233, 0x3f803f80, v31
  v_dot2c_f32_bf16 v235, v31, v31
  v_dot2c_f32_bf16 v236, 0x3f803f80, v44
  v_dot2c_f32_bf16 v237, 0x3f803f80, v48
  v_dot2c_f32_bf16 v238, 0x3f803f80, v52
  v_dot2c_f32_bf16 v116, 0x3f803f80, v45
  v_dot2c_f32_bf16 v117, 0x3f803f80, v49
  v_dot2c_f32_bf16 v118, 0x3f803f80, v53
  v_dot2c_f32_bf16 v236, 0x3f803f80, v46
  v_dot2c_f32_bf16 v237, 0x3f803f80, v50
  v_dot2c_f32_bf16 v238, 0x3f803f80, v54
  v_dot2c_f32_bf16 v116, 0x3f803f80, v47
  v_dot2c_f32_bf16 v117, 0x3f803f80, v51
  v_dot2c_f32_bf16 v118, 0x3f803f80, v55
  s_waitcnt lgkmcnt(0)
  v_mfma_f32_32x32x16_bf16 v[64:79], v[32:35], v[24:27], v[64:79]
  ds_read_b128 v[28:31], v11 offset:0
  ds_read_b64_tr_b16 v[44:45], v16 offset:26624
  ds_read_b64_tr_b16 v[46:47], v16 offset:28160
  ds_read_b64_tr_b16 v[48:49], v16 offset:26752
  v_mfma_f32_32x32x16_bf16 v[80:95], v[24:27], v[36:39], v[80:95]
  ds_read_b64_tr_b16 v[50:51], v16 offset:28288
  ds_read_b64_tr_b16 v[52:53], v16 offset:26880
  ds_read_b64_tr_b16 v[54:55], v16 offset:28416
  v_mfma_f32_32x32x16_bf16 v[96:111], v[24:27], v[40:43], v[96:111]
  s_waitcnt lgkmcnt(0)
  s_barrier
  v_mfma_f32_32x32x16_bf16 v[64:79], v[44:47], v[28:31], v[64:79]
  ds_read_b128 v[24:27], v8 offset:32768
  ds_read_b64_tr_b16 v[32:33], v16 offset:40960
  ds_read_b64_tr_b16 v[34:35], v16 offset:42496
  ds_read_b64_tr_b16 v[36:37], v16 offset:41088
  v_mfma_f32_32x32x16_bf16 v[80:95], v[28:31], v[48:51], v[80:95]
  ds_read_b64_tr_b16 v[38:39], v16 offset:42624
  ds_read_b64_tr_b16 v[40:41], v16 offset:41216
  ds_read_b64_tr_b16 v[42:43], v16 offset:42752
  v_mfma_f32_32x32x16_bf16 v[96:111], v[28:31], v[52:55], v[96:111]
  v_dot2c_f32_bf16 v112, 0x3f803f80, v28
  v_dot2c_f32_bf16 v114, v28, v28
  v_dot2c_f32_bf16 v113, 0x3f803f80, v29
  v_dot2c_f32_bf16 v115, v29, v29
  v_dot2c_f32_bf16 v232, 0x3f803f80, v30
  v_dot2c_f32_bf16 v234, v30, v30
  v_dot2c_f32_bf16 v233, 0x3f803f80, v31
  v_dot2c_f32_bf16 v235, v31, v31
  v_dot2c_f32_bf16 v236, 0x3f803f80, v44
  v_dot2c_f32_bf16 v237, 0x3f803f80, v48
  v_dot2c_f32_bf16 v238, 0x3f803f80, v52
  v_dot2c_f32_bf16 v116, 0x3f803f80, v45
  v_dot2c_f32_bf16 v117, 0x3f803f80, v49
  v_dot2c_f32_bf16 v118, 0x3f803f80, v53
  v_dot2c_f32_bf16 v236, 0x3f803f80, v46
  v_dot2c_f32_bf16 v237, 0x3f803f80, v50
  v_dot2c_f32_bf16 v238, 0x3f803f80, v54
  v_dot2c_f32_bf16 v116, 0x3f803f80, v47
  v_dot2c_f32_bf16 v117, 0x3f803f80, v51
  v_dot2c_f32_bf16 v118, 0x3f803f80, v55
  s_waitcnt lgkmcnt(0)
  v_mfma_f32_32x32x16_bf16 v[64:79], v[32:35], v[24:27], v[64:79]
  ds_read_b128 v[28:31], v9 offset:32768
  ds_read_b64_tr_b16 v[44:45], v16 offset:47104
  ds_read_b64_tr_b16 v[46:47], v16 offset:48640
  ds_read_b64_tr_b16 v[48:49], v16 offset:47232
  v_mfma_f32_32x32x16_bf16 v[80:95], v[24:27], v[36:39], v[80:95]
  ds_read_b64_tr_b16 v[50:51], v16 offset:48768
  ds_read_b64_tr_b16 v[52:53], v16 offset:47360
  ds_read_b64_tr_b16 v[54:55], v16 offset:48896
  v_mfma_f32_32x32x16_bf16 v[96:111], v[24:27], v[40:43], v[96:111]
  s_waitcnt lgkmcnt(0)
  v_mfma_f32_32x32x16_bf16 v[64:79], v[44:47], v[28:31], v[64:79]
  ds_read_b128 v[24:27], v10 offset:32768
  ds_read_b64_tr_b16 v[32:33], v16 offset:53248
  ds_read_b64_tr_b16 v[34:35], v16 offset:54784
  ds_read_b64_tr_b16 v[36:37], v16 offset:53376
  v_mfma_f32_32x32x16_bf16 v[80:95], v[28:31], v[48:51], v[80:95]
  ds_read_b64_tr_b16 v[38:39], v16 offset:54912
  ds_read_b64_tr_b16 v[40:41], v16 offset:53504
  ds_read_b64_tr_b16 v[42:43], v16 offset:55040
  v_mfma_f32_32x32x16_bf16 v[96:111], v[28:31], v[52:55], v[96:111]
  v_dot2c_f32_bf16 v112, 0x3f803f80, v28
  v_dot2c_f32_bf16 v114, v28, v28
  v_dot2c_f32_bf16 v113, 0x3f803f80, v29
  v_dot2c_f32_bf16 v115, v29, v29
  v_dot2c_f32_bf16 v232, 0x3f803f80, v30
  v_dot2c_f32_bf16 v234, v30, v30
  v_dot2c_f32_bf16 v233, 0x3f803f80, v31
  v_dot2c_f32_bf16 v235, v31, v31
  v_dot2c_f32_bf16 v236, 0x3f803f80, v44
  v_dot2c_f32_bf16 v237, 0x3f803f80, v48
  v_dot2c_f32_bf16 v238, 0x3f803f80, v52
  v_dot2c_f32_bf16 v116, 0x3f803f80, v45
  v_dot2c_f32_bf16 v117, 0x3f803f80, v49
  v_dot2c_f32_bf16 v118, 0x3f803f80, v53
  v_dot2c_f32_bf16 v236, 0x3f803f80, v46
  v_dot2c_f32_bf16 v237, 0x3f803f80, v50
  v_dot2c_f32_bf16 v238, 0x3f803f80, v54
  v_dot2c_f32_bf16 v116, 0x3f803f80, v47
  v_dot2c_f32_bf16 v117, 0x3f803f80, v51
  v_dot2c_f32_bf16 v118, 0x3f803f80, v55
  s_waitcnt lgkmcnt(0)
  v_mfma_f32_32x32x16_bf16 v[64:79], v[32:35], v[24:27], v[64:79]
  ds_read_b128 v[28:31], v11 offset:32768
  ds_read_b64_tr_b16 v[44:45], v16 offset:59392
  ds_read_b64_tr_b16 v[46:47], v16 offset:60928
  ds_read_b64_tr_b16 v[48:49], v16 offset:59520
  v_mfma_f32_32x32x16_bf16 v[80:95], v[24:27], v[36:39], v[80:95]
  ds_read_b64_tr_b16 v[50:51], v16 offset:61056
  ds_read_b64_tr_b16 v[52:53], v16 offset:59648
  ds_read_b64_tr_b16 v[54:55], v16 offset:61184
  v_mfma_f32_32x32x16_bf16 v[96:111], v[24:27], v[40:43], v[96:111]
  s_waitcnt lgkmcnt(0)
  s_barrier
  v_mfma_f32_32x32x16_bf16 v[64:79], v[44:47], v[28:31], v[64:79]
  ds_read_b128 v[24:27], v12 offset:0
  ds_read_b64_tr_b16 v[32:33], v17 offset:8192
  ds_read_b64_tr_b16 v[34:35], v17 offset:9728
  ds_read_b64_tr_b16 v[36:37], v17 offset:8320
  v_mfma_f32_32x32x16_bf16 v[80:95], v[28:31], v[48:51], v[80:95]
  ds_read_b64_tr_b16 v[38:39], v17 offset:9856
  ds_read_b64_tr_b16 v[40:41], v17 offset:8448
  ds_read_b64_tr_b16 v[42:43], v17 offset:9984
  v_mfma_f32_32x32x16_bf16 v[96:111], v[28:31], v[52:55], v[96:111]
  v_dot2c_f32_bf16 v112, 0x3f803f80, v28
  v_dot2c_f32_bf16 v114, v28, v28
  v_dot2c_f32_bf16 v113, 0x3f803f80, v29
  v_dot2c_f32_bf16 v115, v29, v29
  v_dot2c_f32_bf16 v232, 0x3f803f80, v30
  v_dot2c_f32_bf16 v234, v30, v30
  v_dot2c_f32_bf16 v233, 0x3f803f80, v31
  v_dot2c_f32_bf16 v235, v31, v31
  v_dot2c_f32_bf16 v236, 0x3f803f80, v44
  v_dot2c_f32_bf16 v237, 0x3f803f80, v48
  v_dot2c_f32_bf16 v238, 0x3f803f80, v52
  v_dot2c_f32_bf16 v116, 0x3f803f80, v45
  v_dot2c_f32_bf16 v117, 0x3f803f80, v49
  v_dot2c_f32_bf16 v118, 0x3f803f80, v53
  v_dot2c_f32_bf16 v236, 0x3f803f80, v46
  v_dot2c_f32_bf16 v237, 0x3f803f80, v50
  v_dot2c_f32_bf16 v238, 0x3f803f80, v54
  v_dot2c_f32_bf16 v116, 0x3f803f80, v47
  v_dot2c_f32_bf16 v117, 0x3f803f80, v51
  v_dot2c_f32_bf16 v118, 0x3f803f80, v55
  s_waitcnt lgkmcnt(0)
  v_mfma_f32_32x32x16_bf16 v[64:79], v[32:35], v[24:27], v[64:79]
  ds_read_b128 v[28:31], v13 offset:0
  ds_read_b64_tr_b16 v[44:45], v17 offset:14336
  ds_read_b64_tr_b16 v[46:47], v17 offset:15872
  ds_read_b64_tr_b16 v[48:49], v17 offset:14464
  v_mfma_f32_32x32x16_bf16 v[80:95], v[24:27], v[36:39], v[80:95]
  ds_read_b64_tr_b16 v[50:51], v17 offset:16000
  ds_read_b64_tr_b16 v[52:53], v17 offset:14592
  ds_read_b64_tr_b16 v[54:55], v17 offset:16128
  v_mfma_f32_32x32x16_bf16 v[96:111], v[24:27], v[40:43], v[96:111]
  s_waitcnt lgkmcnt(0)
  v_mfma_f32_32x32x16_bf16 v[64:79], v[44:47], v[28:31], v[64:79]
  ds_read_b128 v[24:27], v14 offset:0
  ds_read_b64_tr_b16 v[32:33], v17 offset:20480
  ds_read_b64_tr_b16 v[34:35], v17 offset:22016
  ds_read_b64_tr_b16 v[36:37], v17 offset:20608
  v_mfma_f32_32x32x16_bf16 v[80:95], v[28:31], v[48:51], v[80:95]
  ds_read_b64_tr_b16 v[38:39], v17 offset:22144
  ds_read_b64_tr_b16 v[40:41], v17 offset:20736
  ds_read_b64_tr_b16 v[42:43], v17 offset:22272
  v_mfma_f32_32x32x16_bf16 v[96:111], v[28:31], v[52:55], v[96:111]
  v_dot2c_f32_bf16 v112, 0x3f803f80, v28
  v_dot2c_f32_bf16 v114, v28, v28
  v_dot2c_f32_bf16 v113, 0x3f803f80, v29
  v_dot2c_f32_bf16 v115, v29, v29
  v_dot2c_f32_bf16 v232, 0x3f803f80, v30
  v_dot2c_f32_bf16 v234, v30, v30
  v_dot2c_f32_bf16 v233, 0x3f803f80, v31
  v_dot2c_f32_bf16 v235, v31, v31
  v_dot2c_f32_bf16 v236, 0x3f803f80, v44
  v_dot2c_f32_bf16 v237, 0x3f803f80, v48
  v_dot2c_f32_bf16 v238, 0x3f803f80, v52
  v_dot2c_f32_bf16 v116, 0x3f803f80, v45
  v_dot2c_f32_bf16 v117, 0x3f803f80, v49
  v_dot2c_f32_bf16 v118, 0x3f803f80, v53
  v_dot2c_f32_bf16 v236, 0x3f803f80, v46
  v_dot2c_f32_bf16 v237, 0x3f803f80, v50
  v_dot2c_f32_bf16 v238, 0x3f803f80, v54
  v_dot2c_f32_bf16 v116, 0x3f803f80, v47
  v_dot2c_f32_bf16 v117, 0x3f803f80, v51
  v_dot2c_f32_bf16 v118, 0x3f803f80, v55
  s_waitcnt lgkmcnt(0)
  v_mfma_f32_32x32x16_bf16 v[64:79], v[32:35], v[24:27], v[64:79]
  ds_read_b128 v[28:31], v15 offset:0
  ds_read_b64_tr_b16 v[44:45], v17 offset:26624
  ds_read_b64_tr_b16 v[46:47], v17 offset:28160
  ds_read_b64_tr_b16 v[48:49], v17 offset:26752
  v_mfma_f32_32x32x16_bf16 v[80:95], v[24:27], v[36:39], v[80:95]
  ds_read_b64_tr_b16 v[50:51], v17 offset:28288
  ds_read_b64_tr_b16 v[52:53], v17 offset:26880
  ds_read_b64_tr_b16 v[54:55], v17 offset:28416
  v_mfma_f32_32x32x16_bf16 v[96:111], v[24:27], v[40:43], v[96:111]
  s_waitcnt lgkmcnt(0)
  s_barrier
  v_mfma_f32_32x32x16_bf16 v[64:79], v[44:47], v[28:31], v[64:79]
  ds_read_b128 v[24:27], v12 offset:32768
  ds_read_b64_tr_b16 v[32:33], v17 offset:40960
  ds_read_b64_tr_b16 v[34:35], v17 offset:42496
  ds_read_b64_tr_b16 v[36:37], v17 offset:41088
  v_mfma_f32_32x32x16_bf16 v[80:95], v[28:31], v[48:51], v[80:95]
  ds_read_b64_tr_b16 v[38:39], v17 offset:42624
  ds_read_b64_tr_b16 v[40:41], v17 offset:41216
  ds_read_b64_tr_b16 v[42:43], v17 offset:42752
  v_mfma_f32_32x32x16_bf16 v[96:111], v[28:31], v[52:55], v[96:111]
  v_dot2c_f32_bf16 v112, 0x3f803f80, v28
  v_dot2c_f32_bf16 v114, v28, v28
  v_dot2c_f32_bf16 v113, 0x3f803f80, v29
  v_dot2c_f32_bf16 v115, v29, v29
  v_dot2c_f32_bf16 v232, 0x3f803f80, v30
  v_dot2c_f32_bf16 v234, v30, v30
  v_dot2c_f32_bf16 v233, 0x3f803f80, v31
  v_dot2c_f32_bf16 v235, v31, v31
  v_dot2c_f32_bf16 v236, 0x3f803f80, v44
  v_dot2c_f32_bf16 v237, 0x3f803f80, v48
  v_dot2c_f32_bf16 v238, 0x3f803f80, v52
  v_dot2c_f32_bf16 v116, 0x3f803f80, v45
  v_dot2c_f32_bf16 v117, 0x3f803f80, v49
  v_dot2c_f32_bf16 v118, 0x3f803f80, v53
  v_dot2c_f32_bf16 v236, 0x3f803f80, v46
  v_dot2c_f32_bf16 v237, 0x3f803f80, v50
  v_dot2c_f32_bf16 v238, 0x3f803f80, v54
  v_dot2c_f32_bf16 v116, 0x3f803f80, v47
  v_dot2c_f32_bf16 v117, 0x3f803f80, v51
  v_dot2c_f32_bf16 v118, 0x3f803f80, v55
  s_waitcnt lgkmcnt(0)
  v_mfma_f32_32x32x16_bf16 v[64:79], v[32:35], v[24:27], v[64:79]
  ds_read_b128 v[28:31], v13 offset:32768
  ds_read_b64_tr_b16 v[44:45], v17 offset:47104
  ds_read_b64_tr_b16 v[46:47], v17 offset:48640
  ds_read_b64_tr_b16 v[48:49], v17 offset:47232
  v_mfma_f32_32x32x16_bf16 v[80:95], v[24:27], v[36:39], v[80:95]
  ds_read_b64_tr_b16 v[50:51], v17 offset:48768
  ds_read_b64_tr_b16 v[52:53], v17 offset:47360
  ds_read_b64_tr_b16 v[54:55], v17 offset:48896
  v_mfma_f32_32x32x16_bf16 v[96:111], v[24:27], v[40:43], v[96:111]
  s_waitcnt lgkmcnt(0)
  v_mfma_f32_32x32x16_bf16 v[64:79], v[44:47], v[28:31], v[64:79]
  ds_read_b128 v[24:27], v14 offset:32768
  ds_read_b64_tr_b16 v[32:33], v17 offset:53248
  ds_read_b64_tr_b16 v[34:35], v17 offset:54784
  ds_read_b64_tr_b16 v[36:37], v17 offset:53376
  v_mfma_f32_32x32x16_bf16 v[80:95], v[28:31], v[48:51], v[80:95]
  ds_read_b64_tr_b16 v[38:39], v17 offset:54912
  ds_read_b64_tr_b16 v[40:41], v17 offset:53504
  ds_read_b64_tr_b16 v[42:43], v17 offset:55040
  v_mfma_f32_32x32x16_bf16 v[96:111], v[28:31], v[52:55], v[96:111]
  v_dot2c_f32_bf16 v112, 0x3f803f80, v28
  v_dot2c_f32_bf16 v114, v28, v28
  v_dot2c_f32_bf16 v113, 0x3f803f80, v29
  v_dot2c_f32_bf16 v115, v29, v29
  v_dot2c_f32_bf16 v232, 0x3f803f80, v30
  v_dot2c_f32_bf16 v234, v30, v30
  v_dot2c_f32_bf16 v233, 0x3f803f80, v31
  v_dot2c_f32_bf16 v235, v31, v31
  v_dot2c_f32_bf16 v236, 0x3f803f80, v44
  v_dot2c_f32_bf16 v237, 0x3f803f80, v48
  v_dot2c_f32_bf16 v238, 0x3f803f80, v52
  v_dot2c_f32_bf16 v116, 0x3f803f80, v45
  v_dot2c_f32_bf16 v117, 0x3f803f80, v49
  v_dot2c_f32_bf16 v118, 0x3f803f80, v53
  v_dot2c_f32_bf16 v236, 0x3f803f80, v46
  v_dot2c_f32_bf16 v237, 0x3f803f80, v50
  v_dot2c_f32_bf16 v238, 0x3f803f80, v54
  v_dot2c_f32_bf16 v116, 0x3f803f80, v47
  v_dot2c_f32_bf16 v117, 0x3f803f80, v51
  v_dot2c_f32_bf16 v118, 0x3f803f80, v55
  s_waitcnt lgkmcnt(0)
  v_mfma_f32_32x32x16_bf16 v[64:79], v[32:35], v[24:27], v[64:79]
  ds_read_b128 v[28:31], v15 offset:32768
  ds_read_b64_tr_b16 v[44:45], v17 offset:59392
  ds_read_b64_tr_b16 v[46:47], v17 offset:60928
  ds_read_b64_tr_b16 v[48:49], v17 offset:59520
  v_mfma_f32_32x32x16_bf16 v[80:95], v[24:27], v[36:39], v[80:95]
  ds_read_b64_tr_b16 v[50:51], v17 offset:61056
  ds_read_b64_tr_b16 v[52:53], v17 offset:59648
  ds_read_b64_tr_b16 v[54:55], v17 offset:61184
  v_mfma_f32_32x32x16_bf16 v[96:111], v[24:27], v[40:43], v[96:111]
  s_waitcnt lgkmcnt(0)
  s_barrier
  v_mfma_f32_32x32x16_bf16 v[64:79], v[44:47], v[28:31], v[64:79]
  ds_read_b128 v[24:27], v8 offset:0
  ds_read_b64_tr_b16 v[32:33], v16 offset:8192
  ds_read_b64_tr_b16 v[34:35], v16 offset:9728
  ds_read_b64_tr_b16 v[36:37], v16 offset:8320
  v_mfma_f32_32x32x16_bf16 v[80:95], v[28:31], v[48:51], v[80:95]
  ds_read_b64_tr_b16 v[38:39], v16 offset:9856
  ds_read_b64_tr_b16 v[40:41], v16 offset:8448
  ds_read_b64_tr_b16 v[42:43], v16 offset:9984
  v_mfma_f32_32x32x16_bf16 v[96:111], v[28:31], v[52:55], v[96:111]
  v_dot2c_f32_bf16 v112, 0x3f803f80, v28
  v_dot2c_f32_bf16 v114, v28, v28
  v_dot2c_f32_bf16 v113, 0x3f803f80, v29
  v_dot2c_f32_bf16 v115, v29, v29
  v_dot2c_f32_bf16 v232, 0x3f803f80, v30
  v_dot2c_f32_bf16 v234, v30, v30
  v_dot2c_f32_bf16 v233, 0x3f803f80, v31
  v_dot2c_f32_bf16 v235, v31, v31
  v_dot2c_f32_bf16 v236, 0x3f803f80, v44
  v_dot2c_f32_bf16 v237, 0x3f803f80, v48
  v_dot2c_f32_bf16 v238, 0x3f803f80, v52
  v_dot2c_f32_bf16 v116, 0x3f803f80, v45
  v_dot2c_f32_bf16 v117, 0x3f803f80, v49
  v_dot2c_f32_bf16 v118, 0x3f803f80, v53
  v_dot2c_f32_bf16 v236, 0x3f803f80, v46
  v_dot2c_f32_bf16 v237, 0x3f803f80, v50
  v_dot2c_f32_bf16 v238, 0x3f803f80, v54
  v_dot2c_f32_bf16 v116, 0x3f803f80, v47
  v_dot2c_f32_bf16 v117, 0x3f803f80, v51
  v_dot2c_f32_bf16 v118, 0x3f803f80, v55
  s_waitcnt lgkmcnt(0)
  v_mfma_f32_32x32x16_bf16 v[64:79], v[32:35], v[24:27], v[64:79]
  ds_read_b128 v[28:31], v9 offset:0
  ds_read_b64_tr_b16 v[44:45], v16 offset:14336
  ds_read_b64_tr_b16 v[46:47], v16 offset:15872
  ds_read_b64_tr_b16 v[48:49], v16 offset:14464
  v_mfma_f32_32x32x16_bf16 v[80:95], v[24:27], v[36:39], v[80:95]
  ds_read_b64_tr_b16 v[50:51], v16 offset:16000
  ds_read_b64_tr_b16 v[52:53], v16 offset:14592
  ds_read_b64_tr_b16 v[54:55], v16 offset:16128
  v_mfma_f32_32x32x16_bf16 v[96:111], v[24:27], v[40:43], v[96:111]
  s_waitcnt lgkmcnt(0)
  v_mfma_f32_32x32x16_bf16 v[64:79], v[44:47], v[28:31], v[64:79]
  ds_read_b128 v[24:27], v10 offset:0
  ds_read_b64_tr_b16 v[32:33], v16 offset:20480
  ds_read_b64_tr_b16 v[34:35], v16 offset:22016
  ds_read_b64_tr_b16 v[36:37], v16 offset:20608
  v_mfma_f32_32x32x16_bf16 v[80:95], v[28:31], v[48:51], v[80:95]
  ds_read_b64_tr_b16 v[38:39], v16 offset:22144
  ds_read_b64_tr_b16 v[40:41], v16 offset:20736
  ds_read_b64_tr_b16 v[42:43], v16 offset:22272
  v_mfma_f32_32x32x16_bf16 v[96:111], v[28:31], v[52:55], v[96:111]
  v_dot2c_f32_bf16 v112, 0x3f803f80, v28
  v_dot2c_f32_bf16 v114, v28, v28
  v_dot2c_f32_bf16 v113, 0x3f803f80, v29
  v_dot2c_f32_bf16 v115, v29, v29
  v_dot2c_f32_bf16 v232, 0x3f803f80, v30
  v_dot2c_f32_bf16 v234, v30, v30
  v_dot2c_f32_bf16 v233, 0x3f803f80, v31
  v_dot2c_f32_bf16 v235, v31, v31
  v_dot2c_f32_bf16 v236, 0x3f803f80, v44
  v_dot2c_f32_bf16 v237, 0x3f803f80, v48
  v_dot2c_f32_bf16 v238, 0x3f803f80, v52
  v_dot2c_f32_bf16 v116, 0x3f803f80, v45
  v_dot2c_f32_bf16 v117, 0x3f803f80, v49
  v_dot2c_f32_bf16 v118, 0x3f803f80, v53
  v_dot2c_f32_bf16 v236, 0x3f803f80, v46
  v_dot2c_f32_bf16 v237, 0x3f803f80, v50
  v_dot2c_f32_bf16 v238, 0x3f803f80, v54
  v_dot2c_f32_bf16 v116, 0x3f803f80, v47
  v_dot2c_f32_bf16 v117, 0x3f803f80, v51
  v_dot2c_f32_bf16 v118, 0x3f803f80, v55
  s_waitcnt lgkmcnt(0)
  v_mfma_f32_32x32x16_bf16 v[64:79], v[32:35], v[24:27], v[64:79]
  ds_read_b128 v[28:31], v11 offset:0
  ds_read_b64_tr_b16 v[44:45], v16 offset:26624
  ds_read_b64_tr_b16 v[46:47], v16 offset:28160
  ds_read_b64_tr_b16 v[48:49], v16 offset:26752
  v_mfma_f32_32x32x16_bf16 v[80:95], v[24:27], v[36:39], v[80:95]
  ds_read_b64_tr_b16 v[50:51], v16 offset:28288
  ds_read_b64_tr_b16 v[52:53], v16 offset:26880
  ds_read_b64_tr_b16 v[54:55], v16 offset:28416
  ds_read_b128 v[124:127], v119 offset:144
  v_mfma_f32_32x32x16_bf16 v[96:111], v[24:27], v[40:43], v[96:111]
  s_waitcnt lgkmcnt(0)
  v_and_b32 v124, v124, v125
  v_and_b32 v126, v126, v127
  v_and_b32 v124, v124, v126
  s_nop 0
  v_readfirstlane_b32 s14, v124
  s_nop 3
  s_cmp_lg_u32 s14, 0
  s_cbranch_scc1 k1_lf3_4_ok
  v_mov_b32 v18, 159888
k1_lf3_4:
  ds_read_b128 v[124:127], v18
  s_waitcnt lgkmcnt(0)
  v_and_b32 v124, v124, v125
  v_and_b32 v126, v126, v127
  v_and_b32 v124, v124, v126
  s_nop 0
  v_readfirstlane_b32 s14, v124
  s_nop 3
  s_cmp_eq_u32 s14, 0
  s_cbranch_scc1 k1_lf3_4
k1_lf3_4_ok:
  v_mfma_f32_32x32x16_bf16 v[64:79], v[44:47], v[28:31], v[64:79]
  ds_read_b128 v[24:27], v8 offset:32768
  ds_read_b64_tr_b16 v[32:33], v16 offset:40960
  ds_read_b64_tr_b16 v[34:35], v16 offset:42496
  ds_read_b64_tr_b16 v[36:37], v16 offset:41088
  v_mfma_f32_32x32x16_bf16 v[80:95], v[28:31], v[48:51], v[80:95]
  ds_read_b64_tr_b16 v[38:39], v16 offset:42624
  ds_read_b64_tr_b16 v[40:41], v16 offset:41216
  ds_read_b64_tr_b16 v[42:43], v16 offset:42752
  v_mfma_f32_32x32x16_bf16 v[96:111], v[28:31], v[52:55], v[96:111]
  v_dot2c_f32_bf16 v112, 0x3f803f80, v28
  v_dot2c_f32_bf16 v114, v28, v28
  v_dot2c_f32_bf16 v113, 0x3f803f80, v29
  v_dot2c_f32_bf16 v115, v29, v29
  v_dot2c_f32_bf16 v232, 0x3f803f80, v30
  v_dot2c_f32_bf16 v234, v30, v30
  v_dot2c_f32_bf16 v233, 0x3f803f80, v31
  v_dot2c_f32_bf16 v235, v31, v31
  v_dot2c_f32_bf16 v236, 0x3f803f80, v44
  v_dot2c_f32_bf16 v237, 0x3f803f80, v48
  v_dot2c_f32_bf16 v238, 0x3f803f80, v52
  v_dot2c_f32_bf16 v116, 0x3f803f80, v45
  v_dot2c_f32_bf16 v117, 0x3f803f80, v49
  v_dot2c_f32_bf16 v118, 0x3f803f80, v53
  v_dot2c_f32_bf16 v236, 0x3f803f80, v46
  v_dot2c_f32_bf16 v237, 0x3f803f80, v50
  v_dot2c_f32_bf16 v238, 0x3f803f80, v54
  v_dot2c_f32_bf16 v116, 0x3f803f80, v47
  v_dot2c_f32_bf16 v117, 0x3f803f80, v51
  v_dot2c_f32_bf16 v118, 0x3f803f80, v55
  s_waitcnt lgkmcnt(0)
  v_mfma_f32_32x32x16_bf16 v[64:79], v[32:35], v[24:27], v[64:79]
  ds_read_b128 v[28:31], v9 offset:32768
  ds_read_b64_tr_b16 v[44:45], v16 offset:47104
  ds_read_b64_tr_b16 v[46:47], v16 offset:48640
  ds_read_b64_tr_b16 v[48:49], v16 offset:47232
  v_mfma_f32_32x32x16_bf16 v[80:95], v[24:27], v[36:39], v[80:95]
  ds_read_b64_tr_b16 v[50:51], v16 offset:48768
  ds_read_b64_tr_b16 v[52:53], v16 offset:47360
  ds_read_b64_tr_b16 v[54:55], v16 offset:48896
  v_mfma_f32_32x32x16_bf16 v[96:111], v[24:27], v[40:43], v[96:111]
  s_waitcnt lgkmcnt(0)
  v_mfma_f32_32x32x16_bf16 v[64:79], v[44:47], v[28:31], v[64:79]
  ds_read_b128 v[24:27], v10 offset:32768
  ds_read_b64_tr_b16 v[32:33], v16 offset:53248
  ds_read_b64_tr_b16 v[34:35], v16 offset:54784
  ds_read_b64_tr_b16 v[36:37], v16 offset:53376
  v_mfma_f32_32x32x16_bf16 v[80:95], v[28:31], v[48:51], v[80:95]
  ds_read_b64_tr_b16 v[38:39], v16 offset:54912
  ds_read_b64_tr_b16 v[40:41], v16 offset:53504
  ds_read_b64_tr_b16 v[42:43], v16 offset:55040
  v_mfma_f32_32x32x16_bf16 v[96:111], v[28:31], v[52:55], v[96:111]
  v_dot2c_f32_bf16 v112, 0x3f803f80, v28
  v_dot2c_f32_bf16 v114, v28, v28
  v_dot2c_f32_bf16 v113, 0x3f803f80, v29
  v_dot2c_f32_bf16 v115, v29, v29
  v_dot2c_f32_bf16 v232, 0x3f803f80, v30
  v_dot2c_f32_bf16 v234, v30, v30
  v_dot2c_f32_bf16 v233, 0x3f803f80, v31
  v_dot2c_f32_bf16 v235, v31, v31
  v_dot2c_f32_bf16 v236, 0x3f803f80, v44
  v_dot2c_f32_bf16 v237, 0x3f803f80, v48
  v_dot2c_f32_bf16 v238, 0x3f803f80, v52
  v_dot2c_f32_bf16 v116, 0x3f803f80, v45
  v_dot2c_f32_bf16 v117, 0x3f803f80, v49
  v_dot2c_f32_bf16 v118, 0x3f803f80, v53
  v_dot2c_f32_bf16 v236, 0x3f803f80, v46
  v_dot2c_f32_bf16 v237, 0x3f803f80, v50
  v_dot2c_f32_bf16 v238, 0x3f803f80, v54
  v_dot2c_f32_bf16 v116, 0x3f803f80, v47
  v_dot2c_f32_bf16 v117, 0x3f803f80, v51
  v_dot2c_f32_bf16 v118, 0x3f803f80, v55
  s_waitcnt lgkmcnt(0)
  v_mfma_f32_32x32x16_bf16 v[64:79], v[32:35], v[24:27], v[64:79]
  ds_read_b128 v[28:31], v11 offset:32768
  ds_read_b64_tr_b16 v[44:45], v16 offset:59392
  ds_read_b64_tr_b16 v[46:47], v16 offset:60928
  ds_read_b64_tr_b16 v[48:49], v16 offset:59520
  v_mfma_f32_32x32x16_bf16 v[80:95], v[24:27], v[36:39], v[80:95]
  ds_read_b64_tr_b16 v[50:51], v16 offset:61056
  ds_read_b64_tr_b16 v[52:53], v16 offset:59648
  ds_read_b64_tr_b16 v[54:55], v16 offset:61184
  ds_read_b128 v[124:127], v119 offset:160
  v_mfma_f32_32x32x16_bf16 v[96:111], v[24:27], v[40:43], v[96:111]
  s_waitcnt lgkmcnt(0)
  v_and_b32 v124, v124, v125
  v_and_b32 v126, v126, v127
  v_and_b32 v124, v124, v126
  s_nop 0
  v_readfirstlane_b32 s14, v124
  s_nop 3
  s_cmp_lg_u32 s14, 0
  s_cbranch_scc1 k1_lf3_5_ok
  v_mov_b32 v18, 159904
k1_lf3_5:
  ds_read_b128 v[124:127], v18
  s_waitcnt lgkmcnt(0)
  v_and_b32 v124, v124, v125
  v_and_b32 v126, v126, v127
  v_and_b32 v124, v124, v126
  s_nop 0
  v_readfirstlane_b32 s14, v124
  s_nop 3
  s_cmp_eq_u32 s14, 0
  s_cbranch_scc1 k1_lf3_5
k1_lf3_5_ok:
  v_mfma_f32_32x32x16_bf16 v[64:79], v[44:47], v[28:31], v[64:79]
  ds_read_b128 v[24:27], v12 offset:0
  ds_read_b64_tr_b16 v[32:33], v17 offset:8192
  ds_read_b64_tr_b16 v[34:35], v17 offset:9728
  ds_read_b64_tr_b16 v[36:37], v17 offset:8320
  v_mfma_f32_32x32x16_bf16 v[80:95], v[28:31], v[48:51], v[80:95]
  ds_read_b64_tr_b16 v[38:39], v17 offset:9856
  ds_read_b64_tr_b16 v[40:41], v17 offset:8448
  ds_read_b64_tr_b16 v[42:43], v17 offset:9984
  v_mfma_f32_32x32x16_bf16 v[96:111], v[28:31], v[52:55], v[96:111]
  v_dot2c_f32_bf16 v112, 0x3f803f80, v28
  v_dot2c_f32_bf16 v114, v28, v28
  v_dot2c_f32_bf16 v113, 0x3f803f80, v29
  v_dot2c_f32_bf16 v115, v29, v29
  v_dot2c_f32_bf16 v232, 0x3f803f80, v30
  v_dot2c_f32_bf16 v234, v30, v30
  v_dot2c_f32_bf16 v233, 0x3f803f80, v31
  v_dot2c_f32_bf16 v235, v31, v31
  v_dot2c_f32_bf16 v236, 0x3f803f80, v44
  v_dot2c_f32_bf16 v237, 0x3f803f80, v48
  v_dot2c_f32_bf16 v238, 0x3f803f80, v52
  v_dot2c_f32_bf16 v116, 0x3f803f80, v45
  v_dot2c_f32_bf16 v117, 0x3f803f80, v49
  v_dot2c_f32_bf16 v118, 0x3f803f80, v53
  v_dot2c_f32_bf16 v236, 0x3f803f80, v46
  v_dot2c_f32_bf16 v237, 0x3f803f80, v50
  v_dot2c_f32_bf16 v238, 0x3f803f80, v54
  v_dot2c_f32_bf16 v116, 0x3f803f80, v47
  v_dot2c_f32_bf16 v117, 0x3f803f80, v51
  v_dot2c_f32_bf16 v118, 0x3f803f80, v55
  s_waitcnt lgkmcnt(0)
  s_lshl_b32 s14, s5, 2
  v_mov_b32 v120, s14
  buffer_load_dword v121, v120, s[48:51], 0 offen sc1
  v_mfma_f32_32x32x16_bf16 v[64:79], v[32:35], v[24:27], v[64:79]
  ds_read_b128 v[28:31], v13 offset:0
  ds_read_b64_tr_b16 v[44:45], v17 offset:14336
  ds_read_b64_tr_b16 v[46:47], v17 offset:15872
  ds_read_b64_tr_b16 v[48:49], v17 offset:14464
  v_mfma_f32_32x32x16_bf16 v[80:95], v[24:27], v[36:39], v[80:95]
  ds_read_b64_tr_b16 v[50:51], v17 offset:16000
  ds_read_b64_tr_b16 v[52:53], v17 offset:14592
  ds_read_b64_tr_b16 v[54:55], v17 offset:16128
  v_mfma_f32_32x32x16_bf16 v[96:111], v[24:27], v[40:43], v[96:111]
  s_waitcnt lgkmcnt(0)
  v_mfma_f32_32x32x16_bf16 v[64:79], v[44:47], v[28:31], v[64:79]
  ds_read_b128 v[24:27], v14 offset:0
  ds_read_b64_tr_b16 v[32:33], v17 offset:20480
  ds_read_b64_tr_b16 v[34:35], v17 offset:22016
  ds_read_b64_tr_b16 v[36:37], v17 offset:20608
  v_mfma_f32_32x32x16_bf16 v[80:95], v[28:31], v[48:51], v[80:95]
  ds_read_b64_tr_b16 v[38:39], v17 offset:22144
  ds_read_b64_tr_b16 v[40:41], v17 offset:20736
  ds_read_b64_tr_b16 v[42:43], v17 offset:22272
  v_mfma_f32_32x32x16_bf16 v[96:111], v[28:31], v[52:55], v[96:111]
  v_dot2c_f32_bf16 v112, 0x3f803f80, v28
  v_dot2c_f32_bf16 v114, v28, v28
  v_dot2c_f32_bf16 v113, 0x3f803f80, v29
  v_dot2c_f32_bf16 v115, v29, v29
  v_dot2c_f32_bf16 v232, 0x3f803f80, v30
  v_dot2c_f32_bf16 v234, v30, v30
  v_dot2c_f32_bf16 v233, 0x3f803f80, v31
  v_dot2c_f32_bf16 v235, v31, v31
  v_dot2c_f32_bf16 v236, 0x3f803f80, v44
  v_dot2c_f32_bf16 v237, 0x3f803f80, v48
  v_dot2c_f32_bf16 v238, 0x3f803f80, v52
  v_dot2c_f32_bf16 v116, 0x3f803f80, v45
  v_dot2c_f32_bf16 v117, 0x3f803f80, v49
  v_dot2c_f32_bf16 v118, 0x3f803f80, v53
  v_dot2c_f32_bf16 v236, 0x3f803f80, v46
  v_dot2c_f32_bf16 v237, 0x3f803f80, v50
  v_dot2c_f32_bf16 v238, 0x3f803f80, v54
  v_dot2c_f32_bf16 v116, 0x3f803f80, v47
  v_dot2c_f32_bf16 v117, 0x3f803f80, v51
  v_dot2c_f32_bf16 v118, 0x3f803f80, v55
  s_waitcnt lgkmcnt(0)
  v_mfma_f32_32x32x16_bf16 v[64:79], v[32:35], v[24:27], v[64:79]
  ds_read_b128 v[28:31], v15 offset:0
  ds_read_b64_tr_b16 v[44:45], v17 offset:26624
  ds_read_b64_tr_b16 v[46:47], v17 offset:28160
  ds_read_b64_tr_b16 v[48:49], v17 offset:26752
  v_mfma_f32_32x32x16_bf16 v[80:95], v[24:27], v[36:39], v[80:95]
  ds_read_b64_tr_b16 v[50:51], v17 offset:28288
  ds_read_b64_tr_b16 v[52:53], v17 offset:26880
  ds_read_b64_tr_b16 v[54:55], v17 offset:28416
  ds_read_b128 v[124:127], v119 offset:176
  v_mfma_f32_32x32x16_bf16 v[96:111], v[24:27], v[40:43], v[96:111]
  s_waitcnt lgkmcnt(0)
  v_and_b32 v124, v124, v125
  v_and_b32 v126, v126, v127
  v_and_b32 v124, v124, v126
  s_nop 0
  v_readfirstlane_b32 s14, v124
  s_nop 3
  s_cmp_lg_u32 s14, 0
  s_cbranch_scc1 k1_lf3_6_ok
  v_mov_b32 v18, 159920
k1_lf3_6:
  ds_read_b128 v[124:127], v18
  s_waitcnt lgkmcnt(0)
  v_and_b32 v124, v124, v125
  v_and_b32 v126, v126, v127
  v_and_b32 v124, v124, v126
  s_nop 0
  v_readfirstlane_b32 s14, v124
  s_nop 3
  s_cmp_eq_u32 s14, 0
  s_cbranch_scc1 k1_lf3_6
k1_lf3_6_ok:
  v_mfma_f32_32x32x16_bf16 v[64:79], v[44:47], v[28:31], v[64:79]
  ds_read_b128 v[24:27], v12 offset:32768
  ds_read_b64_tr_b16 v[32:33], v17 offset:40960
  ds_read_b64_tr_b16 v[34:35], v17 offset:42496
  ds_read_b64_tr_b16 v[36:37], v17 offset:41088
  v_mfma_f32_32x32x16_bf16 v[80:95], v[28:31], v[48:51], v[80:95]
  ds_read_b64_tr_b16 v[38:39], v17 offset:42624
  ds_read_b64_tr_b16 v[40:41], v17 offset:41216
  ds_read_b64_tr_b16 v[42:43], v17 offset:42752
  v_mfma_f32_32x32x16_bf16 v[96:111], v[28:31], v[52:55], v[96:111]
  v_dot2c_f32_bf16 v112, 0x3f803f80, v28
  v_dot2c_f32_bf16 v114, v28, v28
  v_dot2c_f32_bf16 v113, 0x3f803f80, v29
  v_dot2c_f32_bf16 v115, v29, v29
  v_dot2c_f32_bf16 v232, 0x3f803f80, v30
  v_dot2c_f32_bf16 v234, v30, v30
  v_dot2c_f32_bf16 v233, 0x3f803f80, v31
  v_dot2c_f32_bf16 v235, v31, v31
  v_dot2c_f32_bf16 v236, 0x3f803f80, v44
  v_dot2c_f32_bf16 v237, 0x3f803f80, v48
  v_dot2c_f32_bf16 v238, 0x3f803f80, v52
  v_dot2c_f32_bf16 v116, 0x3f803f80, v45
  v_dot2c_f32_bf16 v117, 0x3f803f80, v49
  v_dot2c_f32_bf16 v118, 0x3f803f80, v53
  v_dot2c_f32_bf16 v236, 0x3f803f80, v46
  v_dot2c_f32_bf16 v237, 0x3f803f80, v50
  v_dot2c_f32_bf16 v238, 0x3f803f80, v54
  v_dot2c_f32_bf16 v116, 0x3f803f80, v47
  v_dot2c_f32_bf16 v117, 0x3f803f80, v51
  v_dot2c_f32_bf16 v118, 0x3f803f80, v55
  s_waitcnt lgkmcnt(0)
  v_mov_b32 v18, 159756
  v_mov_b32 v123, 1
  ds_write_b32 v18, v123
  v_mfma_f32_32x32x16_bf16 v[64:79], v[32:35], v[24:27], v[64:79]
  ds_read_b128 v[28:31], v13 offset:32768
  ds_read_b64_tr_b16 v[44:45], v17 offset:47104
  ds_read_b64_tr_b16 v[46:47], v17 offset:48640
  ds_read_b64_tr_b16 v[48:49], v17 offset:47232
  v_mfma_f32_32x32x16_bf16 v[80:95], v[24:27], v[36:39], v[80:95]
  ds_read_b64_tr_b16 v[50:51], v17 offset:48768
  ds_read_b64_tr_b16 v[52:53], v17 offset:47360
  ds_read_b64_tr_b16 v[54:55], v17 offset:48896
  v_mfma_f32_32x32x16_bf16 v[96:111], v[24:27], v[40:43], v[96:111]
  s_waitcnt lgkmcnt(0)
  v_mfma_f32_32x32x16_bf16 v[64:79], v[44:47], v[28:31], v[64:79]
  ds_read_b128 v[24:27], v14 offset:32768
  ds_read_b64_tr_b16 v[32:33], v17 offset:53248
  ds_read_b64_tr_b16 v[34:35], v17 offset:54784
  ds_read_b64_tr_b16 v[36:37], v17 offset:53376
  v_mfma_f32_32x32x16_bf16 v[80:95], v[28:31], v[48:51], v[80:95]
  ds_read_b64_tr_b16 v[38:39], v17 offset:54912
  ds_read_b64_tr_b16 v[40:41], v17 offset:53504
  ds_read_b64_tr_b16 v[42:43], v17 offset:55040
  v_mfma_f32_32x32x16_bf16 v[96:111], v[28:31], v[52:55], v[96:111]
  v_dot2c_f32_bf16 v112, 0x3f803f80, v28
  v_dot2c_f32_bf16 v114, v28, v28
  v_dot2c_f32_bf16 v113, 0x3f803f80, v29
  v_dot2c_f32_bf16 v115, v29, v29
  v_dot2c_f32_bf16 v232, 0x3f803f80, v30
  v_dot2c_f32_bf16 v234, v30, v30
  v_dot2c_f32_bf16 v233, 0x3f803f80, v31
  v_dot2c_f32_bf16 v235, v31, v31
  v_dot2c_f32_bf16 v236, 0x3f803f80, v44
  v_dot2c_f32_bf16 v237, 0x3f803f80, v48
  v_dot2c_f32_bf16 v238, 0x3f803f80, v52
  v_dot2c_f32_bf16 v116, 0x3f803f80, v45
  v_dot2c_f32_bf16 v117, 0x3f803f80, v49
  v_dot2c_f32_bf16 v118, 0x3f803f80, v53
  v_dot2c_f32_bf16 v236, 0x3f803f80, v46
  v_dot2c_f32_bf16 v237, 0x3f803f80, v50
  v_dot2c_f32_bf16 v238, 0x3f803f80, v54
  v_dot2c_f32_bf16 v116, 0x3f803f80, v47
  v_dot2c_f32_bf16 v117, 0x3f803f80, v51
  v_dot2c_f32_bf16 v118, 0x3f803f80, v55
  s_waitcnt lgkmcnt(0)
  v_mfma_f32_32x32x16_bf16 v[64:79], v[32:35], v[24:27], v[64:79]
  ds_read_b128 v[28:31], v15 offset:32768
  ds_read_b64_tr_b16 v[44:45], v17 offset:59392
  ds_read_b64_tr_b16 v[46:47], v17 offset:60928
  ds_read_b64_tr_b16 v[48:49], v17 offset:59520
  v_mfma_f32_32x32x16_bf16 v[80:95], v[24:27], v[36:39], v[80:95]
  ds_read_b64_tr_b16 v[50:51], v17 offset:61056
  ds_read_b64_tr_b16 v[52:53], v17 offset:59648
  ds_read_b64_tr_b16 v[54:55], v17 offset:61184
  v_mfma_f32_32x32x16_bf16 v[96:111], v[24:27], v[40:43], v[96:111]
  s_waitcnt lgkmcnt(0)
  v_mfma_f32_32x32x16_bf16 v[64:79], v[44:47], v[28:31], v[64:79]
  v_mfma_f32_32x32x16_bf16 v[80:95], v[28:31], v[48:51], v[80:95]
  v_mfma_f32_32x32x16_bf16 v[96:111], v[28:31], v[52:55], v[96:111]
  v_dot2c_f32_bf16 v112, 0x3f803f80, v28
  v_dot2c_f32_bf16 v114, v28, v28
  v_dot2c_f32_bf16 v113, 0x3f803f80, v29
  v_dot2c_f32_bf16 v115, v29, v29
  v_dot2c_f32_bf16 v232, 0x3f803f80, v30
  v_dot2c_f32_bf16 v234, v30, v30
  v_dot2c_f32_bf16 v233, 0x3f803f80, v31
  v_dot2c_f32_bf16 v235, v31, v31
  v_dot2c_f32_bf16 v236, 0x3f803f80, v44
  v_dot2c_f32_bf16 v237, 0x3f803f80, v48
  v_dot2c_f32_bf16 v238, 0x3f803f80, v52
  v_dot2c_f32_bf16 v116, 0x3f803f80, v45
  v_dot2c_f32_bf16 v117, 0x3f803f80, v49
  v_dot2c_f32_bf16 v118, 0x3f803f80, v53
  v_dot2c_f32_bf16 v236, 0x3f803f80, v46
  v_dot2c_f32_bf16 v237, 0x3f803f80, v50
  v_dot2c_f32_bf16 v238, 0x3f803f80, v54
  v_dot2c_f32_bf16 v116, 0x3f803f80, v47
  v_dot2c_f32_bf16 v117, 0x3f803f80, v51
  v_dot2c_f32_bf16 v118, 0x3f803f80, v55
  s_waitcnt lgkmcnt(0)
  s_nop 2
  v_add_f32 v112, v112, v113
  v_add_f32 v232, v232, v233
  v_add_f32 v114, v114, v115
  v_add_f32 v234, v234, v235
  v_add_f32 v116, v116, v236
  v_add_f32 v117, v117, v237
  v_add_f32 v118, v118, v238
  v_add_f32 v112, v112, v232
  v_add_f32 v114, v114, v234
  v_mov_b32 v24, v112
  v_mov_b32 v25, v114
  v_mov_b32 v26, v116
  v_mov_b32 v27, v117
  v_mov_b32 v28, v118
  s_nop 1
  v_permlane32_swap_b32 v112, v24
  v_permlane32_swap_b32 v114, v25
  v_permlane32_swap_b32 v116, v26
  v_permlane32_swap_b32 v117, v27
  v_permlane32_swap_b32 v118, v28
  s_nop 1
  v_add_f32 v112, v112, v24
  v_add_f32 v114, v114, v25
  v_add_f32 v116, v116, v26
  v_add_f32 v117, v117, v27
  v_add_f32 v118, v118, v28
  ds_write_b32 v228, v112 offset:768
  ds_write_b32 v228, v114 offset:896
  ds_write_b32 v228, v116 offset:2176
  ds_write_b32 v228, v117 offset:2304
  ds_write_b32 v228, v118 offset:2432
  v_mov_b32 v18, 159772
  v_mov_b32 v123, 1
  ds_write_b32 v18, v123
  v_mov_b32 v18, 159760
k1_sp3a:
  ds_read_b128 v[124:127], v18
  s_waitcnt lgkmcnt(0)
  v_and_b32 v124, v124, v125
  v_and_b32 v126, v126, v127
  v_and_b32 v124, v124, v126
  s_nop 0
  v_readfirstlane_b32 s14, v124
  s_nop 3
  s_cmp_eq_u32 s14, 0
  s_cbranch_scc1 k1_sp3a
  ds_read_b32 v24, v228 offset:512
  ds_read_b32 v25, v228 offset:640
  ds_read_b32 v26, v228 offset:1792
  ds_read_b32 v27, v228 offset:1920
  ds_read_b32 v28, v228 offset:2048
  s_waitcnt lgkmcnt(0)
  v_add_f32 v112, v112, v24
  v_add_f32 v114, v114, v25
  v_add_f32 v116, v116, v26
  v_add_f32 v117, v117, v27
  v_add_f32 v118, v118, v28
  ds_write_b32 v229, v116 offset:1792
  v_mul_f32 v112, 0x3b000000, v112
  v_mul_f32 v114, 0x3b000000, v114
  v_fma_f32 v114, -v112, v112, v114
  v_max_f32 v114, 0, v114
  v_add_f32 v114, 0x3727c5ac, v114
  v_rsq_f32 v114, v114
  s_nop 0
  v_mul_f32 v112, v112, v114
  v_sub_f32 v112, 0, v112
  ds_write_b32 v229, v114 offset:1536
  ds_write_b32 v229, v112 offset:1664
  v_mov_b32 v184, v114
  v_mov_b32 v186, v112
  v_mov_b32 v188, v117
  v_mov_b32 v190, v118
  s_waitcnt lgkmcnt(0)
  ds_read_b128 v[128:131], v230 offset:1536
  ds_read_b128 v[144:147], v230 offset:1664
  ds_read_b128 v[132:135], v230 offset:1568
  ds_read_b128 v[148:151], v230 offset:1696
  ds_read_b128 v[136:139], v230 offset:1600
  ds_read_b128 v[152:155], v230 offset:1728
  ds_read_b128 v[140:143], v230 offset:1632
  ds_read_b128 v[156:159], v230 offset:1760
  ds_read_b128 v[160:163], v230 offset:1792
  ds_read_b128 v[164:167], v230 offset:1824
  ds_read_b128 v[168:171], v230 offset:1856
  ds_read_b128 v[172:175], v230 offset:1888
  ds_read_b128 v[124:127], v119
  s_waitcnt lgkmcnt(5)
  v_pk_mul_f32 v[24:25], v[144:145], v[190:191] op_sel_hi:[1,0]
  v_pk_mul_f32 v[26:27], v[146:147], v[190:191] op_sel_hi:[1,0]
  v_pk_mul_f32 v[28:29], v[148:149], v[190:191] op_sel_hi:[1,0]
  v_pk_mul_f32 v[30:31], v[150:151], v[190:191] op_sel_hi:[1,0]
  v_pk_mul_f32 v[32:33], v[152:153], v[190:191] op_sel_hi:[1,0]
  v_pk_mul_f32 v[34:35], v[154:155], v[190:191] op_sel_hi:[1,0]
  v_pk_mul_f32 v[36:37], v[156:157], v[190:191] op_sel_hi:[1,0]
  v_pk_mul_f32 v[38:39], v[158:159], v[190:191] op_sel_hi:[1,0]
  v_pk_fma_f32 v[96:97], v[96:97], v[128:129], v[24:25]
  v_pk_fma_f32 v[98:99], v[98:99], v[130:131], v[26:27]
  v_pk_fma_f32 v[100:101], v[100:101], v[132:133], v[28:29]
  v_pk_fma_f32 v[102:103], v[102:103], v[134:135], v[30:31]
  v_pk_fma_f32 v[104:105], v[104:105], v[136:137], v[32:33]
  v_pk_fma_f32 v[106:107], v[106:107], v[138:139], v[34:35]
  v_pk_fma_f32 v[108:109], v[108:109], v[140:141], v[36:37]
  v_pk_fma_f32 v[110:111], v[110:111], v[142:143], v[38:39]
  v_pk_fma_f32 v[40:41], v[144:145], v[188:189], v[176:177] op_sel_hi:[1,0,1]
  v_pk_fma_f32 v[42:43], v[146:147], v[188:189], v[176:177] op_sel_hi:[1,0,1]
  v_pk_fma_f32 v[44:45], v[148:149], v[188:189], v[176:177] op_sel_hi:[1,0,1]
  v_pk_fma_f32 v[46:47], v[150:151], v[188:189], v[176:177] op_sel_hi:[1,0,1]
  v_pk_fma_f32 v[48:49], v[152:153], v[188:189], v[176:177] op_sel_hi:[1,0,1]
  v_pk_fma_f32 v[50:51], v[154:155], v[188:189], v[176:177] op_sel_hi:[1,0,1]
  v_pk_fma_f32 v[52:53], v[156:157], v[188:189], v[176:177] op_sel_hi:[1,0,1]
  v_pk_fma_f32 v[54:55], v[158:159], v[188:189], v[176:177] op_sel_hi:[1,0,1]
  v_pk_fma_f32 v[80:81], v[80:81], v[128:129], v[40:41]
  v_pk_fma_f32 v[82:83], v[82:83], v[130:131], v[42:43]
  v_pk_fma_f32 v[84:85], v[84:85], v[132:133], v[44:45]
  v_pk_fma_f32 v[86:87], v[86:87], v[134:135], v[46:47]
  v_pk_fma_f32 v[88:89], v[88:89], v[136:137], v[48:49]
  v_pk_fma_f32 v[90:91], v[90:91], v[138:139], v[50:51]
  v_pk_fma_f32 v[92:93], v[92:93], v[140:141], v[52:53]
  v_pk_fma_f32 v[94:95], v[94:95], v[142:143], v[54:55]
  v_pk_fma_f32 v[40:41], v[80:81], v[178:179], v[180:181]
  v_pk_fma_f32 v[42:43], v[82:83], v[178:179], v[180:181]
  v_pk_fma_f32 v[44:45], v[84:85], v[178:179], v[180:181]
  v_pk_fma_f32 v[46:47], v[86:87], v[178:179], v[180:181]
  v_pk_fma_f32 v[48:49], v[88:89], v[178:179], v[180:181]
  v_pk_fma_f32 v[50:51], v[90:91], v[178:179], v[180:181]
  v_pk_fma_f32 v[52:53], v[92:93], v[178:179], v[180:181]
  v_pk_fma_f32 v[54:55], v[94:95], v[178:179], v[180:181]
  v_exp_f32_e64 v40, v40 clamp
  v_exp_f32_e64 v41, v41 clamp
  v_exp_f32_e64 v42, v42 clamp
  v_exp_f32_e64 v43, v43 clamp
  v_exp_f32_e64 v44, v44 clamp
  v_exp_f32_e64 v45, v45 clamp
  v_exp_f32_e64 v46, v46 clamp
  v_exp_f32_e64 v47, v47 clamp
  v_exp_f32_e64 v48, v48 clamp
  v_exp_f32_e64 v49, v49 clamp
  v_exp_f32_e64 v50, v50 clamp
  v_exp_f32_e64 v51, v51 clamp
  v_exp_f32_e64 v52, v52 clamp
  v_exp_f32_e64 v53, v53 clamp
  v_exp_f32_e64 v54, v54 clamp
  v_exp_f32_e64 v55, v55 clamp
  v_pk_add_f32 v[40:41], v[40:41], v[182:183]
  v_pk_add_f32 v[42:43], v[42:43], v[182:183]
  v_pk_add_f32 v[44:45], v[44:45], v[182:183]
  v_pk_add_f32 v[46:47], v[46:47], v[182:183]
  v_pk_add_f32 v[48:49], v[48:49], v[182:183]
  v_pk_add_f32 v[50:51], v[50:51], v[182:183]
  v_pk_add_f32 v[52:53], v[52:53], v[182:183]
  v_pk_add_f32 v[54:55], v[54:55], v[182:183]
  v_max_f32 v80, v80, v40
  v_max_f32 v81, v81, v41
  v_max_f32 v82, v82, v42
  v_max_f32 v83, v83, v43
  v_max_f32 v84, v84, v44
  v_max_f32 v85, v85, v45
  v_max_f32 v86, v86, v46
  v_max_f32 v87, v87, v47
  v_max_f32 v88, v88, v48
  v_max_f32 v89, v89, v49
  v_max_f32 v90, v90, v50
  v_max_f32 v91, v91, v51
  v_max_f32 v92, v92, v52
  v_max_f32 v93, v93, v53
  v_max_f32 v94, v94, v54
  v_max_f32 v95, v95, v55
  v_cvt_pk_bf16_f32 v216, v96, v97
  v_cvt_pk_bf16_f32 v217, v98, v99
  v_cvt_pk_bf16_f32 v218, v100, v101
  v_cvt_pk_bf16_f32 v219, v102, v103
  v_cvt_pk_bf16_f32 v220, v104, v105
  v_cvt_pk_bf16_f32 v221, v106, v107
  v_cvt_pk_bf16_f32 v222, v108, v109
  v_cvt_pk_bf16_f32 v223, v110, v111
  v_cvt_pk_bf16_f32 v208, v80, v81
  v_cvt_pk_bf16_f32 v209, v82, v83
  v_cvt_pk_bf16_f32 v210, v84, v85
  v_cvt_pk_bf16_f32 v211, v86, v87
  v_cvt_pk_bf16_f32 v212, v88, v89
  v_cvt_pk_bf16_f32 v213, v90, v91
  v_cvt_pk_bf16_f32 v214, v92, v93
  v_cvt_pk_bf16_f32 v215, v94, v95
  s_nop 1
  v_mfma_f32_32x32x16_bf16 v[80:95], v[216:219], v[208:211], 0
  v_mfma_f32_32x32x16_bf16 v[96:111], v[224:227], v[208:211], 0
  v_mfma_f32_32x32x16_bf16 v[80:95], v[220:223], v[212:215], v[80:95]
  v_mfma_f32_32x32x16_bf16 v[96:111], v[224:227], v[212:215], v[96:111]
  v_and_b32 v22, 16, v0
  v_cmp_ne_u32 vcc, 0, v22
  v_lshlrev_b32 v19, 2, v0
  v_add_u32 v19, 73728, v19
  v_bfe_u32 v9, v0, 4, 1
  s_movk_i32 s13, 1088
  v_mul_lo_u32 v9, v9, s13
  v_and_b32 v10, 15, v0
  v_lshl_add_u32 v9, v10, 2, v9
  v_lshl_add_u32 v10, v21, 8, v9
  s_lshl_b32 s13, s5, 2
  s_add_u32 s13, s13, 2
  s_mulk_i32 s13, 1088
  s_waitcnt lgkmcnt(0)
  v_and_b32 v124, v124, v125
  v_and_b32 v126, v126, v127
  v_and_b32 v124, v124, v126
  s_nop 0
  v_readfirstlane_b32 s14, v124
  s_nop 3
  s_cmp_lg_u32 s14, 0
  s_cbranch_scc1 k1_d63_ok
  v_mov_b32 v18, 159744
k1_d63:
  ds_read_b128 v[124:127], v18
  s_waitcnt lgkmcnt(0)
  v_and_b32 v124, v124, v125
  v_and_b32 v126, v126, v127
  v_and_b32 v124, v124, v126
  s_nop 0
  v_readfirstlane_b32 s14, v124
  s_nop 3
  s_cmp_eq_u32 s14, 0
  s_cbranch_scc1 k1_d63
k1_d63_ok:
  v_cndmask_b32 v24, v80, v88, vcc
  v_cndmask_b32 v25, v81, v89, vcc
  v_cndmask_b32 v26, v82, v90, vcc
  v_cndmask_b32 v27, v83, v91, vcc
  v_cndmask_b32 v28, v84, v92, vcc
  v_cndmask_b32 v29, v85, v93, vcc
  v_cndmask_b32 v30, v86, v94, vcc
  v_cndmask_b32 v31, v87, v95, vcc
  ds_write_b32 v19, v24 offset:6912
  ds_write_b32 v19, v25 offset:7168
  ds_write_b32 v19, v26 offset:7424
  ds_write_b32 v19, v27 offset:7680
  ds_write_b32 v19, v96 offset:8960
  v_mov_b32 v18, 159788
  v_mov_b32 v123, 1
  ds_write_b32 v18, v123
  v_mov_b32 v18, 159780
k1_sp3c:
  ds_read_b32 v122, v18
  s_waitcnt lgkmcnt(0)
  v_readfirstlane_b32 s14, v122
  s_nop 3
  s_cmp_eq_u32 s14, 0
  s_cbranch_scc1 k1_sp3c
  ds_read_b32 v32, v19 offset:5632
  ds_read_b32 v33, v19 offset:5888
  ds_read_b32 v34, v19 offset:6144
  ds_read_b32 v35, v19 offset:6400
  s_waitcnt vmcnt(0)
  s_waitcnt lgkmcnt(0)
  v_add_f32 v28, v28, v32
  v_add_f32 v29, v29, v33
  v_add_f32 v30, v30, v34
  v_add_f32 v31, v31, v35
  s_mov_b32 s15, 0
k1_poll3:
  v_readfirstlane_b32 s14, v121
  s_add_u32 s15, s15, 1
  s_nop 2
  s_cmp_lg_u32 s14, 0
  s_cbranch_scc1 k1_go3
  s_cmp_ge_u32 s15, 0x20000
  s_cbranch_scc1 k1_go3
  s_sleep 2
  buffer_load_dword v121, v120, s[48:51], 0 offen sc1
  s_waitcnt vmcnt(0)
  s_branch k1_poll3
k1_go3:
  buffer_atomic_add_f32 v28, v10, s[44:47], s13 offen offset:512
  buffer_atomic_add_f32 v29, v10, s[44:47], s13 offen offset:576
  buffer_atomic_add_f32 v30, v10, s[44:47], s13 offen offset:640
  buffer_atomic_add_f32 v31, v10, s[44:47], s13 offen offset:704
  v_pk_fma_f32 v[40:41], v[160:161], v[186:187], v[176:177] op_sel_hi:[1,0,1]
  v_pk_fma_f32 v[42:43], v[162:163], v[186:187], v[176:177] op_sel_hi:[1,0,1]
  v_pk_fma_f32 v[44:45], v[164:165], v[186:187], v[176:177] op_sel_hi:[1,0,1]
  v_pk_fma_f32 v[46:47], v[166:167], v[186:187], v[176:177] op_sel_hi:[1,0,1]
  v_pk_fma_f32 v[48:49], v[168:169], v[186:187], v[176:177] op_sel_hi:[1,0,1]
  v_pk_fma_f32 v[50:51], v[170:171], v[186:187], v[176:177] op_sel_hi:[1,0,1]
  v_pk_fma_f32 v[52:53], v[172:173], v[186:187], v[176:177] op_sel_hi:[1,0,1]
  v_pk_fma_f32 v[54:55], v[174:175], v[186:187], v[176:177] op_sel_hi:[1,0,1]
  v_pk_fma_f32 v[64:65], v[64:65], v[184:185], v[40:41] op_sel_hi:[1,0,1]
  v_pk_fma_f32 v[66:67], v[66:67], v[184:185], v[42:43] op_sel_hi:[1,0,1]
  v_pk_fma_f32 v[68:69], v[68:69], v[184:185], v[44:45] op_sel_hi:[1,0,1]
  v_pk_fma_f32 v[70:71], v[70:71], v[184:185], v[46:47] op_sel_hi:[1,0,1]
  v_pk_fma_f32 v[72:73], v[72:73], v[184:185], v[48:49] op_sel_hi:[1,0,1]
  v_pk_fma_f32 v[74:75], v[74:75], v[184:185], v[50:51] op_sel_hi:[1,0,1]
  v_pk_fma_f32 v[76:77], v[76:77], v[184:185], v[52:53] op_sel_hi:[1,0,1]
  v_pk_fma_f32 v[78:79], v[78:79], v[184:185], v[54:55] op_sel_hi:[1,0,1]
  v_pk_fma_f32 v[40:41], v[64:65], v[178:179], v[180:181]
  v_pk_fma_f32 v[42:43], v[66:67], v[178:179], v[180:181]
  v_pk_fma_f32 v[44:45], v[68:69], v[178:179], v[180:181]
  v_pk_fma_f32 v[46:47], v[70:71], v[178:179], v[180:181]
  v_pk_fma_f32 v[48:49], v[72:73], v[178:179], v[180:181]
  v_pk_fma_f32 v[50:51], v[74:75], v[178:179], v[180:181]
  v_pk_fma_f32 v[52:53], v[76:77], v[178:179], v[180:181]
  v_pk_fma_f32 v[54:55], v[78:79], v[178:179], v[180:181]
  v_exp_f32_e64 v40, v40 clamp
  v_exp_f32_e64 v41, v41 clamp
  v_exp_f32_e64 v42, v42 clamp
  v_exp_f32_e64 v43, v43 clamp
  v_exp_f32_e64 v44, v44 clamp
  v_exp_f32_e64 v45, v45 clamp
  v_exp_f32_e64 v46, v46 clamp
  v_exp_f32_e64 v47, v47 clamp
  v_exp_f32_e64 v48, v48 clamp
  v_exp_f32_e64 v49, v49 clamp
  v_exp_f32_e64 v50, v50 clamp
  v_exp_f32_e64 v51, v51 clamp
  v_exp_f32_e64 v52, v52 clamp
  v_exp_f32_e64 v53, v53 clamp
  v_exp_f32_e64 v54, v54 clamp
  v_exp_f32_e64 v55, v55 clamp
  v_pk_add_f32 v[40:41], v[40:41], v[182:183]
  v_pk_add_f32 v[42:43], v[42:43], v[182:183]
  v_pk_add_f32 v[44:45], v[44:45], v[182:183]
  v_pk_add_f32 v[46:47], v[46:47], v[182:183]
  v_pk_add_f32 v[48:49], v[48:49], v[182:183]
  v_pk_add_f32 v[50:51], v[50:51], v[182:183]
  v_pk_add_f32 v[52:53], v[52:53], v[182:183]
  v_pk_add_f32 v[54:55], v[54:55], v[182:183]
  v_max_f32 v64, v64, v40
  v_max_f32 v65, v65, v41
  v_max_f32 v66, v66, v42
  v_max_f32 v67, v67, v43
  v_max_f32 v68, v68, v44
  v_max_f32 v69, v69, v45
  v_max_f32 v70, v70, v46
  v_max_f32 v71, v71, v47
  v_max_f32 v72, v72, v48
  v_max_f32 v73, v73, v49
  v_max_f32 v74, v74, v50
  v_max_f32 v75, v75, v51
  v_max_f32 v76, v76, v52
  v_max_f32 v77, v77, v53
  v_max_f32 v78, v78, v54
  v_max_f32 v79, v79, v55
  v_cvt_pk_bf16_f32 v200, v64, v65
  v_cvt_pk_bf16_f32 v201, v66, v67
  v_cvt_pk_bf16_f32 v202, v68, v69
  v_cvt_pk_bf16_f32 v203, v70, v71
  v_cvt_pk_bf16_f32 v204, v72, v73
  v_cvt_pk_bf16_f32 v205, v74, v75
  v_cvt_pk_bf16_f32 v206, v76, v77
  v_cvt_pk_bf16_f32 v207, v78, v79
  s_add_u32 s52, s34, 1048576
  s_addc_u32 s53, s35, 0
  s_mov_b32 s54, 2097152
  s_mov_b32 s55, 0x20000
  s_lshl_b32 s12, s6, 1
  s_add_u32 s12, s12, 1
  s_lshl_b32 s12, s12, 5
  s_lshl_b32 s13, s5, 2
  s_add_u32 s12, s12, s13
  s_add_u32 s12, s12, 2
  s_lshl_b32 s12, s12, 10
  v_lshlrev_b32 v18, 4, v0
  buffer_store_dwordx4 v[200:203], v18, s[52:55], s12 offen sc1
  buffer_store_dwordx4 v[204:207], v18, s[52:55], s12 offen offset:1024 sc1
  s_branch k1_fin
k1_w0:
  v_and_b32 v20, 31, v0
  v_lshrrev_b32 v21, 5, v0
  v_bfe_u32 v22, v0, 1, 3
  v_xor_b32 v22, v22, v21
  v_lshlrev_b32 v22, 4, v22
  v_lshl_add_u32 v22, v20, 7, v22
  v_add_u32 v8, 0, v22
  v_xor_b32 v9, 32, v8
  v_xor_b32 v10, 64, v8
  v_xor_b32 v11, 96, v8
  v_add_u32 v12, 0x10000, v8
  v_add_u32 v13, 0x10000, v9
  v_add_u32 v14, 0x10000, v10
  v_add_u32 v15, 0x10000, v11
  v_bfe_u32 v22, v0, 2, 2
  v_lshl_add_u32 v23, v21, 3, v22
  v_mul_u32_u24 v23, 384, v23
  v_bfe_u32 v22, v0, 3, 1
  v_lshl_add_u32 v23, v22, 6, v23
  v_bfe_u32 v22, v0, 4, 1
  v_lshl_add_u32 v23, v22, 5, v23
  v_and_b32 v22, 3, v0
  v_lshl_add_u32 v16, v22, 3, v23
  v_add_u32 v17, 0x10000, v16
  v_mov_b32 v112, 0
  v_mov_b32 v113, 0
  v_mov_b32 v114, 0
  v_mov_b32 v115, 0
  v_mov_b32 v116, 0
  v_mov_b32 v117, 0
  v_mov_b32 v118, 0
  v_mov_b32 v232, 0
  v_mov_b32 v233, 0
  v_mov_b32 v234, 0
  v_mov_b32 v235, 0
  v_mov_b32 v236, 0
  v_mov_b32 v237, 0
  v_mov_b32 v238, 0
  v_and_b32 v18, 3, v0
  v_lshlrev_b32 v18, 4, v18
  v_add_u32 v18, 159744, v18
  v_mov_b32 v24, 0
  v_mov_b32 v25, 0
  v_mov_b32 v26, 0
  v_mov_b32 v27, 0
  ds_write_b128 v18, v[24:27]
  v_mov_b32 v119, 159744
  v_mov_b32 v123, 1
  s_mov_b32 s36, s16
  s_mov_b32 s37, s17
  s_mov_b32 s38, 2097152
  s_mov_b32 s39, 0x20000
  s_mov_b32 s40, s18
  s_mov_b32 s41, s19
  s_mov_b32 s42, 1572864
  s_mov_b32 s43, 0x20000
  s_lshr_b32 s12, s2, 3
  s_lshl_b32 s12, s12, 2
  s_add_u32 s12, s12, 0
  s_and_b32 s13, s2, 7
  s_lshr_b32 s15, s13, 1
  s_lshl_b32 s15, s15, 19
  s_lshl_b32 s14, s12, 12
  s_add_u32 s15, s15, s14
  v_lshlrev_b32 v245, 7, v20
  v_min_u32 v22, 47, v0
  v_mul_u32_u24 v23, 43, v22
  v_lshrrev_b32 v23, 9, v23
  v_mul_u32_u24 v24, 12, v23
  v_sub_u32 v24, v22, v24
  v_mul_u32_u24 v23, 3072, v23
  v_lshrrev_b32 v25, 2, v24
  v_lshl_add_u32 v23, v25, 10, v23
  v_and_b32 v24, 3, v24
  v_lshl_add_u32 v23, v24, 7, v23
  s_mul_i32 s14, s12, 12288
  s_and_b32 s13, s13, 1
  s_lshl_b32 s13, s13, 9
  s_add_u32 s14, s14, s13
  s_waitcnt lgkmcnt(0)
  s_barrier
  s_getpc_b64 s[64:65]
k1_pc:
  s_add_u32 s64, s64, k1_kernel-k1_pc
  s_addc_u32 s65, s65, -1
  s_lshr_b32 s12, s2, 3
  s_lshl_b32 s12, s12, 13
  v_lshlrev_b32 v22, 7, v0
  v_add_u32 v22, s12, v22
  s_mov_b32 s13, code_end-k1_kernel-4
  s_cmp_gt_u32 s12, s13
  s_cbranch_scc1 k1_nocpf
  v_min_u32 v22, s13, v22
  global_load_dword v242, v22, s[64:65]
k1_nocpf:
  v_mov_b32 v176, 0x3f800008
  v_mov_b32 v177, 0x3f800008
  v_mov_b32 v178, 0x3fb8aa3b
  v_mov_b32 v179, 0x3fb8aa3b
  v_mov_b32 v180, 0xbfb8aa47
  v_mov_b32 v181, 0xbfb8aa47
  v_mov_b32 v182, 0x358637bd
  v_mov_b32 v183, 0x358637bd
  v_mov_b32 v224, 0x3f803f80
  v_mov_b32 v225, 0x3f803f80
  v_mov_b32 v226, 0x3f803f80
  v_mov_b32 v227, 0x3f803f80
  v_lshlrev_b32 v228, 2, v20
  v_add_u32 v229, 160000, v228
  v_add_u32 v228, 156672, v228
  v_lshlrev_b32 v230, 4, v21
  v_add_u32 v230, 160000, v230
  s_barrier
  buffer_load_dword v240, v245, s[36:39], s15 offen
  ds_read_b128 v[24:27], v8 offset:0
  ds_read_b64_tr_b16 v[32:33], v16 offset:8192
  ds_read_b64_tr_b16 v[34:35], v16 offset:9728
  ds_read_b64_tr_b16 v[36:37], v16 offset:8320
  ds_read_b64_tr_b16 v[38:39], v16 offset:9856
  ds_read_b64_tr_b16 v[40:41], v16 offset:8448
  ds_read_b64_tr_b16 v[42:43], v16 offset:9984
  s_waitcnt lgkmcnt(0)
  v_mfma_f32_32x32x16_bf16 v[64:79], v[32:35], v[24:27], 0
  ds_read_b128 v[28:31], v9 offset:0
  ds_read_b64_tr_b16 v[44:45], v16 offset:14336
  ds_read_b64_tr_b16 v[46:47], v16 offset:15872
  ds_read_b64_tr_b16 v[48:49], v16 offset:14464
  v_mfma_f32_32x32x16_bf16 v[80:95], v[24:27], v[36:39], 0
  ds_read_b64_tr_b16 v[50:51], v16 offset:16000
  ds_read_b64_tr_b16 v[52:53], v16 offset:14592
  ds_read_b64_tr_b16 v[54:55], v16 offset:16128
  v_mfma_f32_32x32x16_bf16 v[96:111], v[24:27], v[40:43], 0
  v_dot2c_f32_bf16 v112, 0x3f803f80, v24
  v_dot2c_f32_bf16 v114, v24, v24
  v_dot2c_f32_bf16 v113, 0x3f803f80, v25
  v_dot2c_f32_bf16 v115, v25, v25
  v_dot2c_f32_bf16 v232, 0x3f803f80, v26
  v_dot2c_f32_bf16 v234, v26, v26
  v_dot2c_f32_bf16 v233, 0x3f803f80, v27
  v_dot2c_f32_bf16 v235, v27, v27
  v_dot2c_f32_bf16 v236, 0x3f803f80, v32
  v_dot2c_f32_bf16 v237, 0x3f803f80, v36
  v_dot2c_f32_bf16 v238, 0x3f803f80, v40
  v_dot2c_f32_bf16 v116, 0x3f803f80, v33
  v_dot2c_f32_bf16 v117, 0x3f803f80, v37
  v_dot2c_f32_bf16 v118, 0x3f803f80, v41
  v_dot2c_f32_bf16 v236, 0x3f803f80, v34
  v_dot2c_f32_bf16 v237, 0x3f803f80, v38
  v_dot2c_f32_bf16 v238, 0x3f803f80, v42
  v_dot2c_f32_bf16 v116, 0x3f803f80, v35
  v_dot2c_f32_bf16 v117, 0x3f803f80, v39
  v_dot2c_f32_bf16 v118, 0x3f803f80, v43
  s_waitcnt lgkmcnt(0)
  v_mfma_f32_32x32x16_bf16 v[64:79], v[44:47], v[28:31], v[64:79]
  ds_read_b128 v[24:27], v10 offset:0
  ds_read_b64_tr_b16 v[32:33], v16 offset:20480
  ds_read_b64_tr_b16 v[34:35], v16 offset:22016
  ds_read_b64_tr_b16 v[36:37], v16 offset:20608
  v_mfma_f32_32x32x16_bf16 v[80:95], v[28:31], v[48:51], v[80:95]
  ds_read_b64_tr_b16 v[38:39], v16 offset:22144
  ds_read_b64_tr_b16 v[40:41], v16 offset:20736
  ds_read_b64_tr_b16 v[42:43], v16 offset:22272
  v_mfma_f32_32x32x16_bf16 v[96:111], v[28:31], v[52:55], v[96:111]
  s_waitcnt lgkmcnt(0)
  v_mfma_f32_32x32x16_bf16 v[64:79], v[32:35], v[24:27], v[64:79]
  ds_read_b128 v[28:31], v11 offset:0
  ds_read_b64_tr_b16 v[44:45], v16 offset:26624
  ds_read_b64_tr_b16 v[46:47], v16 offset:28160
  ds_read_b64_tr_b16 v[48:49], v16 offset:26752
  v_mfma_f32_32x32x16_bf16 v[80:95], v[24:27], v[36:39], v[80:95]
  ds_read_b64_tr_b16 v[50:51], v16 offset:28288
  ds_read_b64_tr_b16 v[52:53], v16 offset:26880
  ds_read_b64_tr_b16 v[54:55], v16 offset:28416
  v_mfma_f32_32x32x16_bf16 v[96:111], v[24:27], v[40:43], v[96:111]
  v_dot2c_f32_bf16 v112, 0x3f803f80, v24
  v_dot2c_f32_bf16 v114, v24, v24
  v_dot2c_f32_bf16 v113, 0x3f803f80, v25
  v_dot2c_f32_bf16 v115, v25, v25
  v_dot2c_f32_bf16 v232, 0x3f803f80, v26
  v_dot2c_f32_bf16 v234, v26, v26
  v_dot2c_f32_bf16 v233, 0x3f803f80, v27
  v_dot2c_f32_bf16 v235, v27, v27
  v_dot2c_f32_bf16 v236, 0x3f803f80, v32
  v_dot2c_f32_bf16 v237, 0x3f803f80, v36
  v_dot2c_f32_bf16 v238, 0x3f803f80, v40
  v_dot2c_f32_bf16 v116, 0x3f803f80, v33
  v_dot2c_f32_bf16 v117, 0x3f803f80, v37
  v_dot2c_f32_bf16 v118, 0x3f803f80, v41
  v_dot2c_f32_bf16 v236, 0x3f803f80, v34
  v_dot2c_f32_bf16 v237, 0x3f803f80, v38
  v_dot2c_f32_bf16 v238, 0x3f803f80, v42
  v_dot2c_f32_bf16 v116, 0x3f803f80, v35
  v_dot2c_f32_bf16 v117, 0x3f803f80, v39
  v_dot2c_f32_bf16 v118, 0x3f803f80, v43
  s_waitcnt lgkmcnt(0)
  s_barrier
  v_mfma_f32_32x32x16_bf16 v[64:79], v[44:47], v[28:31], v[64:79]
  ds_read_b128 v[24:27], v8 offset:32768
  ds_read_b64_tr_b16 v[32:33], v16 offset:40960
  ds_read_b64_tr_b16 v[34:35], v16 offset:42496
  ds_read_b64_tr_b16 v[36:37], v16 offset:41088
  v_mfma_f32_32x32x16_bf16 v[80:95], v[28:31], v[48:51], v[80:95]
  ds_read_b64_tr_b16 v[38:39], v16 offset:42624
  ds_read_b64_tr_b16 v[40:41], v16 offset:41216
  ds_read_b64_tr_b16 v[42:43], v16 offset:42752
  v_mfma_f32_32x32x16_bf16 v[96:111], v[28:31], v[52:55], v[96:111]
  s_waitcnt lgkmcnt(0)
  v_mfma_f32_32x32x16_bf16 v[64:79], v[32:35], v[24:27], v[64:79]
  ds_read_b128 v[28:31], v9 offset:32768
  ds_read_b64_tr_b16 v[44:45], v16 offset:47104
  ds_read_b64_tr_b16 v[46:47], v16 offset:48640
  ds_read_b64_tr_b16 v[48:49], v16 offset:47232
  v_mfma_f32_32x32x16_bf16 v[80:95], v[24:27], v[36:39], v[80:95]
  ds_read_b64_tr_b16 v[50:51], v16 offset:48768
  ds_read_b64_tr_b16 v[52:53], v16 offset:47360
  ds_read_b64_tr_b16 v[54:55], v16 offset:48896
  v_mfma_f32_32x32x16_bf16 v[96:111], v[24:27], v[40:43], v[96:111]
  v_dot2c_f32_bf16 v112, 0x3f803f80, v24
  v_dot2c_f32_bf16 v114, v24, v24
  v_dot2c_f32_bf16 v113, 0x3f803f80, v25
  v_dot2c_f32_bf16 v115, v25, v25
  v_dot2c_f32_bf16 v232, 0x3f803f80, v26
  v_dot2c_f32_bf16 v234, v26, v26
  v_dot2c_f32_bf16 v233, 0x3f803f80, v27
  v_dot2c_f32_bf16 v235, v27, v27
  v_dot2c_f32_bf16 v236, 0x3f803f80, v32
  v_dot2c_f32_bf16 v237, 0x3f803f80, v36
  v_dot2c_f32_bf16 v238, 0x3f803f80, v40
  v_dot2c_f32_bf16 v116, 0x3f803f80, v33
  v_dot2c_f32_bf16 v117, 0x3f803f80, v37
  v_dot2c_f32_bf16 v118, 0x3f803f80, v41
  v_dot2c_f32_bf16 v236, 0x3f803f80, v34
  v_dot2c_f32_bf16 v237, 0x3f803f80, v38
  v_dot2c_f32_bf16 v238, 0x3f803f80, v42
  v_dot2c_f32_bf16 v116, 0x3f803f80, v35
  v_dot2c_f32_bf16 v117, 0x3f803f80, v39
  v_dot2c_f32_bf16 v118, 0x3f803f80, v43
  s_waitcnt lgkmcnt(0)
  v_mfma_f32_32x32x16_bf16 v[64:79], v[44:47], v[28:31], v[64:79]
  ds_read_b128 v[24:27], v10 offset:32768
  ds_read_b64_tr_b16 v[32:33], v16 offset:53248
  ds_read_b64_tr_b16 v[34:35], v16 offset:54784
  ds_read_b64_tr_b16 v[36:37], v16 offset:53376
  v_mfma_f32_32x32x16_bf16 v[80:95], v[28:31], v[48:51], v[80:95]
  ds_read_b64_tr_b16 v[38:39], v16 offset:54912
  ds_read_b64_tr_b16 v[40:41], v16 offset:53504
  ds_read_b64_tr_b16 v[42:43], v16 offset:55040
  v_mfma_f32_32x32x16_bf16 v[96:111], v[28:31], v[52:55], v[96:111]
  s_waitcnt lgkmcnt(0)
  v_mfma_f32_32x32x16_bf16 v[64:79], v[32:35], v[24:27], v[64:79]
  ds_read_b128 v[28:31], v11 offset:32768
  ds_read_b64_tr_b16 v[44:45], v16 offset:59392
  ds_read_b64_tr_b16 v[46:47], v16 offset:60928
  ds_read_b64_tr_b16 v[48:49], v16 offset:59520
  v_mfma_f32_32x32x16_bf16 v[80:95], v[24:27], v[36:39], v[80:95]
  ds_read_b64_tr_b16 v[50:51], v16 offset:61056
  ds_read_b64_tr_b16 v[52:53], v16 offset:59648
  ds_read_b64_tr_b16 v[54:55], v16 offset:61184
  v_mfma_f32_32x32x16_bf16 v[96:111], v[24:27], v[40:43], v[96:111]
  v_dot2c_f32_bf16 v112, 0x3f803f80, v24
  v_dot2c_f32_bf16 v114, v24, v24
  v_dot2c_f32_bf16 v113, 0x3f803f80, v25
  v_dot2c_f32_bf16 v115, v25, v25
  v_dot2c_f32_bf16 v232, 0x3f803f80, v26
  v_dot2c_f32_bf16 v234, v26, v26
  v_dot2c_f32_bf16 v233, 0x3f803f80, v27
  v_dot2c_f32_bf16 v235, v27, v27
  v_dot2c_f32_bf16 v236, 0x3f803f80, v32
  v_dot2c_f32_bf16 v237, 0x3f803f80, v36
  v_dot2c_f32_bf16 v238, 0x3f803f80, v40
  v_dot2c_f32_bf16 v116, 0x3f803f80, v33
  v_dot2c_f32_bf16 v117, 0x3f803f80, v37
  v_dot2c_f32_bf16 v118, 0x3f803f80, v41
  v_dot2c_f32_bf16 v236, 0x3f803f80, v34
  v_dot2c_f32_bf16 v237, 0x3f803f80, v38
  v_dot2c_f32_bf16 v238, 0x3f803f80, v42
  v_dot2c_f32_bf16 v116, 0x3f803f80, v35
  v_dot2c_f32_bf16 v117, 0x3f803f80, v39
  v_dot2c_f32_bf16 v118, 0x3f803f80, v43
  s_waitcnt lgkmcnt(0)
  s_barrier
  v_mfma_f32_32x32x16_bf16 v[64:79], v[44:47], v[28:31], v[64:79]
  ds_read_b128 v[24:27], v12 offset:0
  ds_read_b64_tr_b16 v[32:33], v17 offset:8192
  ds_read_b64_tr_b16 v[34:35], v17 offset:9728
  ds_read_b64_tr_b16 v[36:37], v17 offset:8320
  v_mfma_f32_32x32x16_bf16 v[80:95], v[28:31], v[48:51], v[80:95]
  ds_read_b64_tr_b16 v[38:39], v17 offset:9856
  ds_read_b64_tr_b16 v[40:41], v17 offset:8448
  ds_read_b64_tr_b16 v[42:43], v17 offset:9984
  v_mfma_f32_32x32x16_bf16 v[96:111], v[28:31], v[52:55], v[96:111]
  s_waitcnt lgkmcnt(0)
  v_mfma_f32_32x32x16_bf16 v[64:79], v[32:35], v[24:27], v[64:79]
  ds_read_b128 v[28:31], v13 offset:0
  ds_read_b64_tr_b16 v[44:45], v17 offset:14336
  ds_read_b64_tr_b16 v[46:47], v17 offset:15872
  ds_read_b64_tr_b16 v[48:49], v17 offset:14464
  v_mfma_f32_32x32x16_bf16 v[80:95], v[24:27], v[36:39], v[80:95]
  ds_read_b64_tr_b16 v[50:51], v17 offset:16000
  ds_read_b64_tr_b16 v[52:53], v17 offset:14592
  ds_read_b64_tr_b16 v[54:55], v17 offset:16128
  v_mfma_f32_32x32x16_bf16 v[96:111], v[24:27], v[40:43], v[96:111]
  v_dot2c_f32_bf16 v112, 0x3f803f80, v24
  v_dot2c_f32_bf16 v114, v24, v24
  v_dot2c_f32_bf16 v113, 0x3f803f80, v25
  v_dot2c_f32_bf16 v115, v25, v25
  v_dot2c_f32_bf16 v232, 0x3f803f80, v26
  v_dot2c_f32_bf16 v234, v26, v26
  v_dot2c_f32_bf16 v233, 0x3f803f80, v27
  v_dot2c_f32_bf16 v235, v27, v27
  v_dot2c_f32_bf16 v236, 0x3f803f80, v32
  v_dot2c_f32_bf16 v237, 0x3f803f80, v36
  v_dot2c_f32_bf16 v238, 0x3f803f80, v40
  v_dot2c_f32_bf16 v116, 0x3f803f80, v33
  v_dot2c_f32_bf16 v117, 0x3f803f80, v37
  v_dot2c_f32_bf16 v118, 0x3f803f80, v41
  v_dot2c_f32_bf16 v236, 0x3f803f80, v34
  v_dot2c_f32_bf16 v237, 0x3f803f80, v38
  v_dot2c_f32_bf16 v238, 0x3f803f80, v42
  v_dot2c_f32_bf16 v116, 0x3f803f80, v35
  v_dot2c_f32_bf16 v117, 0x3f803f80, v39
  v_dot2c_f32_bf16 v118, 0x3f803f80, v43
  s_waitcnt lgkmcnt(0)
  v_mfma_f32_32x32x16_bf16 v[64:79], v[44:47], v[28:31], v[64:79]
  ds_read_b128 v[24:27], v14 offset:0
  ds_read_b64_tr_b16 v[32:33], v17 offset:20480
  ds_read_b64_tr_b16 v[34:35], v17 offset:22016
  ds_read_b64_tr_b16 v[36:37], v17 offset:20608
  v_mfma_f32_32x32x16_bf16 v[80:95], v[28:31], v[48:51], v[80:95]
  ds_read_b64_tr_b16 v[38:39], v17 offset:22144
  ds_read_b64_tr_b16 v[40:41], v17 offset:20736
  ds_read_b64_tr_b16 v[42:43], v17 offset:22272
  v_mfma_f32_32x32x16_bf16 v[96:111], v[28:31], v[52:55], v[96:111]
  s_waitcnt lgkmcnt(0)
  v_mfma_f32_32x32x16_bf16 v[64:79], v[32:35], v[24:27], v[64:79]
  ds_read_b128 v[28:31], v15 offset:0
  ds_read_b64_tr_b16 v[44:45], v17 offset:26624
  ds_read_b64_tr_b16 v[46:47], v17 offset:28160
  ds_read_b64_tr_b16 v[48:49], v17 offset:26752
  v_mfma_f32_32x32x16_bf16 v[80:95], v[24:27], v[36:39], v[80:95]
  ds_read_b64_tr_b16 v[50:51], v17 offset:28288
  ds_read_b64_tr_b16 v[52:53], v17 offset:26880
  ds_read_b64_tr_b16 v[54:55], v17 offset:28416
  v_mfma_f32_32x32x16_bf16 v[96:111], v[24:27], v[40:43], v[96:111]
  v_dot2c_f32_bf16 v112, 0x3f803f80, v24
  v_dot2c_f32_bf16 v114, v24, v24
  v_dot2c_f32_bf16 v113, 0x3f803f80, v25
  v_dot2c_f32_bf16 v115, v25, v25
  v_dot2c_f32_bf16 v232, 0x3f803f80, v26
  v_dot2c_f32_bf16 v234, v26, v26
  v_dot2c_f32_bf16 v233, 0x3f803f80, v27
  v_dot2c_f32_bf16 v235, v27, v27
  v_dot2c_f32_bf16 v236, 0x3f803f80, v32
  v_dot2c_f32_bf16 v237, 0x3f803f80, v36
  v_dot2c_f32_bf16 v238, 0x3f803f80, v40
  v_dot2c_f32_bf16 v116, 0x3f803f80, v33
  v_dot2c_f32_bf16 v117, 0x3f803f80, v37
  v_dot2c_f32_bf16 v118, 0x3f803f80, v41
  v_dot2c_f32_bf16 v236, 0x3f803f80, v34
  v_dot2c_f32_bf16 v237, 0x3f803f80, v38
  v_dot2c_f32_bf16 v238, 0x3f803f80, v42
  v_dot2c_f32_bf16 v116, 0x3f803f80, v35
  v_dot2c_f32_bf16 v117, 0x3f803f80, v39
  v_dot2c_f32_bf16 v118, 0x3f803f80, v43
  s_waitcnt lgkmcnt(0)
  s_barrier
  v_mfma_f32_32x32x16_bf16 v[64:79], v[44:47], v[28:31], v[64:79]
  ds_read_b128 v[24:27], v12 offset:32768
  ds_read_b64_tr_b16 v[32:33], v17 offset:40960
  ds_read_b64_tr_b16 v[34:35], v17 offset:42496
  ds_read_b64_tr_b16 v[36:37], v17 offset:41088
  v_mfma_f32_32x32x16_bf16 v[80:95], v[28:31], v[48:51], v[80:95]
  ds_read_b64_tr_b16 v[38:39], v17 offset:42624
  ds_read_b64_tr_b16 v[40:41], v17 offset:41216
  ds_read_b64_tr_b16 v[42:43], v17 offset:42752
  v_mfma_f32_32x32x16_bf16 v[96:111], v[28:31], v[52:55], v[96:111]
  s_waitcnt lgkmcnt(0)
  v_mfma_f32_32x32x16_bf16 v[64:79], v[32:35], v[24:27], v[64:79]
  ds_read_b128 v[28:31], v13 offset:32768
  ds_read_b64_tr_b16 v[44:45], v17 offset:47104
  ds_read_b64_tr_b16 v[46:47], v17 offset:48640
  ds_read_b64_tr_b16 v[48:49], v17 offset:47232
  v_mfma_f32_32x32x16_bf16 v[80:95], v[24:27], v[36:39], v[80:95]
  ds_read_b64_tr_b16 v[50:51], v17 offset:48768
  ds_read_b64_tr_b16 v[52:53], v17 offset:47360
  ds_read_b64_tr_b16 v[54:55], v17 offset:48896
  v_mfma_f32_32x32x16_bf16 v[96:111], v[24:27], v[40:43], v[96:111]
  v_dot2c_f32_bf16 v112, 0x3f803f80, v24
  v_dot2c_f32_bf16 v114, v24, v24
  v_dot2c_f32_bf16 v113, 0x3f803f80, v25
  v_dot2c_f32_bf16 v115, v25, v25
  v_dot2c_f32_bf16 v232, 0x3f803f80, v26
  v_dot2c_f32_bf16 v234, v26, v26
  v_dot2c_f32_bf16 v233, 0x3f803f80, v27
  v_dot2c_f32_bf16 v235, v27, v27
  v_dot2c_f32_bf16 v236, 0x3f803f80, v32
  v_dot2c_f32_bf16 v237, 0x3f803f80, v36
  v_dot2c_f32_bf16 v238, 0x3f803f80, v40
  v_dot2c_f32_bf16 v116, 0x3f803f80, v33
  v_dot2c_f32_bf16 v117, 0x3f803f80, v37
  v_dot2c_f32_bf16 v118, 0x3f803f80, v41
  v_dot2c_f32_bf16 v236, 0x3f803f80, v34
  v_dot2c_f32_bf16 v237, 0x3f803f80, v38
  v_dot2c_f32_bf16 v238, 0x3f803f80, v42
  v_dot2c_f32_bf16 v116, 0x3f803f80, v35
  v_dot2c_f32_bf16 v117, 0x3f803f80, v39
  v_dot2c_f32_bf16 v118, 0x3f803f80, v43
  s_waitcnt lgkmcnt(0)
  v_mfma_f32_32x32x16_bf16 v[64:79], v[44:47], v[28:31], v[64:79]
  ds_read_b128 v[24:27], v14 offset:32768
  ds_read_b64_tr_b16 v[32:33], v17 offset:53248
  ds_read_b64_tr_b16 v[34:35], v17 offset:54784
  ds_read_b64_tr_b16 v[36:37], v17 offset:53376
  v_mfma_f32_32x32x16_bf16 v[80:95], v[28:31], v[48:51], v[80:95]
  ds_read_b64_tr_b16 v[38:39], v17 offset:54912
  ds_read_b64_tr_b16 v[40:41], v17 offset:53504
  ds_read_b64_tr_b16 v[42:43], v17 offset:55040
  v_mfma_f32_32x32x16_bf16 v[96:111], v[28:31], v[52:55], v[96:111]
  s_waitcnt lgkmcnt(0)
  v_mfma_f32_32x32x16_bf16 v[64:79], v[32:35], v[24:27], v[64:79]
  ds_read_b128 v[28:31], v15 offset:32768
  ds_read_b64_tr_b16 v[44:45], v17 offset:59392
  ds_read_b64_tr_b16 v[46:47], v17 offset:60928
  ds_read_b64_tr_b16 v[48:49], v17 offset:59520
  v_mfma_f32_32x32x16_bf16 v[80:95], v[24:27], v[36:39], v[80:95]
  ds_read_b64_tr_b16 v[50:51], v17 offset:61056
  ds_read_b64_tr_b16 v[52:53], v17 offset:59648
  ds_read_b64_tr_b16 v[54:55], v17 offset:61184
  v_mfma_f32_32x32x16_bf16 v[96:111], v[24:27], v[40:43], v[96:111]
  v_dot2c_f32_bf16 v112, 0x3f803f80, v24
  v_dot2c_f32_bf16 v114, v24, v24
  v_dot2c_f32_bf16 v113, 0x3f803f80, v25
  v_dot2c_f32_bf16 v115, v25, v25
  v_dot2c_f32_bf16 v232, 0x3f803f80, v26
  v_dot2c_f32_bf16 v234, v26, v26
  v_dot2c_f32_bf16 v233, 0x3f803f80, v27
  v_dot2c_f32_bf16 v235, v27, v27
  v_dot2c_f32_bf16 v236, 0x3f803f80, v32
  v_dot2c_f32_bf16 v237, 0x3f803f80, v36
  v_dot2c_f32_bf16 v238, 0x3f803f80, v40
  v_dot2c_f32_bf16 v116, 0x3f803f80, v33
  v_dot2c_f32_bf16 v117, 0x3f803f80, v37
  v_dot2c_f32_bf16 v118, 0x3f803f80, v41
  v_dot2c_f32_bf16 v236, 0x3f803f80, v34
  v_dot2c_f32_bf16 v237, 0x3f803f80, v38
  v_dot2c_f32_bf16 v238, 0x3f803f80, v42
  v_dot2c_f32_bf16 v116, 0x3f803f80, v35
  v_dot2c_f32_bf16 v117, 0x3f803f80, v39
  v_dot2c_f32_bf16 v118, 0x3f803f80, v43
  s_waitcnt lgkmcnt(0)
  s_barrier
  v_mfma_f32_32x32x16_bf16 v[64:79], v[44:47], v[28:31], v[64:79]
  ds_read_b128 v[24:27], v8 offset:0
  ds_read_b64_tr_b16 v[32:33], v16 offset:8192
  ds_read_b64_tr_b16 v[34:35], v16 offset:9728
  ds_read_b64_tr_b16 v[36:37], v16 offset:8320
  v_mfma_f32_32x32x16_bf16 v[80:95], v[28:31], v[48:51], v[80:95]
  ds_read_b64_tr_b16 v[38:39], v16 offset:9856
  ds_read_b64_tr_b16 v[40:41], v16 offset:8448
  ds_read_b64_tr_b16 v[42:43], v16 offset:9984
  v_mfma_f32_32x32x16_bf16 v[96:111], v[28:31], v[52:55], v[96:111]
  s_waitcnt lgkmcnt(0)
  v_mfma_f32_32x32x16_bf16 v[64:79], v[32:35], v[24:27], v[64:79]
  ds_read_b128 v[28:31], v9 offset:0
  ds_read_b64_tr_b16 v[44:45], v16 offset:14336
  ds_read_b64_tr_b16 v[46:47], v16 offset:15872
  ds_read_b64_tr_b16 v[48:49], v16 offset:14464
  v_mfma_f32_32x32x16_bf16 v[80:95], v[24:27], v[36:39], v[80:95]
  ds_read_b64_tr_b16 v[50:51], v16 offset:16000
  ds_read_b64_tr_b16 v[52:53], v16 offset:14592
  ds_read_b64_tr_b16 v[54:55], v16 offset:16128
  v_mfma_f32_32x32x16_bf16 v[96:111], v[24:27], v[40:43], v[96:111]
  v_dot2c_f32_bf16 v112, 0x3f803f80, v24
  v_dot2c_f32_bf16 v114, v24, v24
  v_dot2c_f32_bf16 v113, 0x3f803f80, v25
  v_dot2c_f32_bf16 v115, v25, v25
  v_dot2c_f32_bf16 v232, 0x3f803f80, v26
  v_dot2c_f32_bf16 v234, v26, v26
  v_dot2c_f32_bf16 v233, 0x3f803f80, v27
  v_dot2c_f32_bf16 v235, v27, v27
  v_dot2c_f32_bf16 v236, 0x3f803f80, v32
  v_dot2c_f32_bf16 v237, 0x3f803f80, v36
  v_dot2c_f32_bf16 v238, 0x3f803f80, v40
  v_dot2c_f32_bf16 v116, 0x3f803f80, v33
  v_dot2c_f32_bf16 v117, 0x3f803f80, v37
  v_dot2c_f32_bf16 v118, 0x3f803f80, v41
  v_dot2c_f32_bf16 v236, 0x3f803f80, v34
  v_dot2c_f32_bf16 v237, 0x3f803f80, v38
  v_dot2c_f32_bf16 v238, 0x3f803f80, v42
  v_dot2c_f32_bf16 v116, 0x3f803f80, v35
  v_dot2c_f32_bf16 v117, 0x3f803f80, v39
  v_dot2c_f32_bf16 v118, 0x3f803f80, v43
  s_waitcnt lgkmcnt(0)
  v_mfma_f32_32x32x16_bf16 v[64:79], v[44:47], v[28:31], v[64:79]
  ds_read_b128 v[24:27], v10 offset:0
  ds_read_b64_tr_b16 v[32:33], v16 offset:20480
  ds_read_b64_tr_b16 v[34:35], v16 offset:22016
  ds_read_b64_tr_b16 v[36:37], v16 offset:20608
  v_mfma_f32_32x32x16_bf16 v[80:95], v[28:31], v[48:51], v[80:95]
  ds_read_b64_tr_b16 v[38:39], v16 offset:22144
  ds_read_b64_tr_b16 v[40:41], v16 offset:20736
  ds_read_b64_tr_b16 v[42:43], v16 offset:22272
  v_mfma_f32_32x32x16_bf16 v[96:111], v[28:31], v[52:55], v[96:111]
  s_waitcnt lgkmcnt(0)
  v_mfma_f32_32x32x16_bf16 v[64:79], v[32:35], v[24:27], v[64:79]
  ds_read_b128 v[28:31], v11 offset:0
  ds_read_b64_tr_b16 v[44:45], v16 offset:26624
  ds_read_b64_tr_b16 v[46:47], v16 offset:28160
  ds_read_b64_tr_b16 v[48:49], v16 offset:26752
  v_mfma_f32_32x32x16_bf16 v[80:95], v[24:27], v[36:39], v[80:95]
  ds_read_b64_tr_b16 v[50:51], v16 offset:28288
  ds_read_b64_tr_b16 v[52:53], v16 offset:26880
  ds_read_b64_tr_b16 v[54:55], v16 offset:28416
  ds_read_b128 v[124:127], v119 offset:144
  v_mfma_f32_32x32x16_bf16 v[96:111], v[24:27], v[40:43], v[96:111]
  v_dot2c_f32_bf16 v112, 0x3f803f80, v24
  v_dot2c_f32_bf16 v114, v24, v24
  v_dot2c_f32_bf16 v113, 0x3f803f80, v25
  v_dot2c_f32_bf16 v115, v25, v25
  v_dot2c_f32_bf16 v232, 0x3f803f80, v26
  v_dot2c_f32_bf16 v234, v26, v26
  v_dot2c_f32_bf16 v233, 0x3f803f80, v27
  v_dot2c_f32_bf16 v235, v27, v27
  v_dot2c_f32_bf16 v236, 0x3f803f80, v32
  v_dot2c_f32_bf16 v237, 0x3f803f80, v36
  v_dot2c_f32_bf16 v238, 0x3f803f80, v40
  v_dot2c_f32_bf16 v116, 0x3f803f80, v33
  v_dot2c_f32_bf16 v117, 0x3f803f80, v37
  v_dot2c_f32_bf16 v118, 0x3f803f80, v41
  v_dot2c_f32_bf16 v236, 0x3f803f80, v34
  v_dot2c_f32_bf16 v237, 0x3f803f80, v38
  v_dot2c_f32_bf16 v238, 0x3f803f80, v42
  v_dot2c_f32_bf16 v116, 0x3f803f80, v35
  v_dot2c_f32_bf16 v117, 0x3f803f80, v39
  v_dot2c_f32_bf16 v118, 0x3f803f80, v43
  s_waitcnt lgkmcnt(0)
  v_and_b32 v124, v124, v125
  v_and_b32 v126, v126, v127
  v_and_b32 v124, v124, v126
  s_nop 0
  v_readfirstlane_b32 s14, v124
  s_nop 3
  s_cmp_lg_u32 s14, 0
  s_cbranch_scc1 k1_lf0_4_ok
  v_mov_b32 v18, 159888
k1_lf0_4:
  ds_read_b128 v[124:127], v18
  s_waitcnt lgkmcnt(0)
  v_and_b32 v124, v124, v125
  v_and_b32 v126, v126, v127
  v_and_b32 v124, v124, v126
  s_nop 0
  v_readfirstlane_b32 s14, v124
  s_nop 3
  s_cmp_eq_u32 s14, 0
  s_cbranch_scc1 k1_lf0_4
k1_lf0_4_ok:
  v_mfma_f32_32x32x16_bf16 v[64:79], v[44:47], v[28:31], v[64:79]
  ds_read_b128 v[24:27], v8 offset:32768
  ds_read_b64_tr_b16 v[32:33], v16 offset:40960
  ds_read_b64_tr_b16 v[34:35], v16 offset:42496
  ds_read_b64_tr_b16 v[36:37], v16 offset:41088
  v_mfma_f32_32x32x16_bf16 v[80:95], v[28:31], v[48:51], v[80:95]
  ds_read_b64_tr_b16 v[38:39], v16 offset:42624
  ds_read_b64_tr_b16 v[40:41], v16 offset:41216
  ds_read_b64_tr_b16 v[42:43], v16 offset:42752
  v_mfma_f32_32x32x16_bf16 v[96:111], v[28:31], v[52:55], v[96:111]
  s_waitcnt lgkmcnt(0)
  v_mfma_f32_32x32x16_bf16 v[64:79], v[32:35], v[24:27], v[64:79]
  ds_read_b128 v[28:31], v9 offset:32768
  ds_read_b64_tr_b16 v[44:45], v16 offset:47104
  ds_read_b64_tr_b16 v[46:47], v16 offset:48640
  ds_read_b64_tr_b16 v[48:49], v16 offset:47232
  v_mfma_f32_32x32x16_bf16 v[80:95], v[24:27], v[36:39], v[80:95]
  ds_read_b64_tr_b16 v[50:51], v16 offset:48768
  ds_read_b64_tr_b16 v[52:53], v16 offset:47360
  ds_read_b64_tr_b16 v[54:55], v16 offset:48896
  v_mfma_f32_32x32x16_bf16 v[96:111], v[24:27], v[40:43], v[96:111]
  v_dot2c_f32_bf16 v112, 0x3f803f80, v24
  v_dot2c_f32_bf16 v114, v24, v24
  v_dot2c_f32_bf16 v113, 0x3f803f80, v25
  v_dot2c_f32_bf16 v115, v25, v25
  v_dot2c_f32_bf16 v232, 0x3f803f80, v26
  v_dot2c_f32_bf16 v234, v26, v26
  v_dot2c_f32_bf16 v233, 0x3f803f80, v27
  v_dot2c_f32_bf16 v235, v27, v27
  v_dot2c_f32_bf16 v236, 0x3f803f80, v32
  v_dot2c_f32_bf16 v237, 0x3f803f80, v36
  v_dot2c_f32_bf16 v238, 0x3f803f80, v40
  v_dot2c_f32_bf16 v116, 0x3f803f80, v33
  v_dot2c_f32_bf16 v117, 0x3f803f80, v37
  v_dot2c_f32_bf16 v118, 0x3f803f80, v41
  v_dot2c_f32_bf16 v236, 0x3f803f80, v34
  v_dot2c_f32_bf16 v237, 0x3f803f80, v38
  v_dot2c_f32_bf16 v238, 0x3f803f80, v42
  v_dot2c_f32_bf16 v116, 0x3f803f80, v35
  v_dot2c_f32_bf16 v117, 0x3f803f80, v39
  v_dot2c_f32_bf16 v118, 0x3f803f80, v43
  s_waitcnt lgkmcnt(0)
  v_mfma_f32_32x32x16_bf16 v[64:79], v[44:47], v[28:31], v[64:79]
  ds_read_b128 v[24:27], v10 offset:32768
  ds_read_b64_tr_b16 v[32:33], v16 offset:53248
  ds_read_b64_tr_b16 v[34:35], v16 offset:54784
  ds_read_b64_tr_b16 v[36:37], v16 offset:53376
  v_mfma_f32_32x32x16_bf16 v[80:95], v[28:31], v[48:51], v[80:95]
  ds_read_b64_tr_b16 v[38:39], v16 offset:54912
  ds_read_b64_tr_b16 v[40:41], v16 offset:53504
  ds_read_b64_tr_b16 v[42:43], v16 offset:55040
  v_mfma_f32_32x32x16_bf16 v[96:111], v[28:31], v[52:55], v[96:111]
  s_waitcnt lgkmcnt(0)
  v_mfma_f32_32x32x16_bf16 v[64:79], v[32:35], v[24:27], v[64:79]
  ds_read_b128 v[28:31], v11 offset:32768
  ds_read_b64_tr_b16 v[44:45], v16 offset:59392
  ds_read_b64_tr_b16 v[46:47], v16 offset:60928
  ds_read_b64_tr_b16 v[48:49], v16 offset:59520
  v_mfma_f32_32x32x16_bf16 v[80:95], v[24:27], v[36:39], v[80:95]
  ds_read_b64_tr_b16 v[50:51], v16 offset:61056
  ds_read_b64_tr_b16 v[52:53], v16 offset:59648
  ds_read_b64_tr_b16 v[54:55], v16 offset:61184
  ds_read_b128 v[124:127], v119 offset:160
  v_mfma_f32_32x32x16_bf16 v[96:111], v[24:27], v[40:43], v[96:111]
  v_dot2c_f32_bf16 v112, 0x3f803f80, v24
  v_dot2c_f32_bf16 v114, v24, v24
  v_dot2c_f32_bf16 v113, 0x3f803f80, v25
  v_dot2c_f32_bf16 v115, v25, v25
  v_dot2c_f32_bf16 v232, 0x3f803f80, v26
  v_dot2c_f32_bf16 v234, v26, v26
  v_dot2c_f32_bf16 v233, 0x3f803f80, v27
  v_dot2c_f32_bf16 v235, v27, v27
  v_dot2c_f32_bf16 v236, 0x3f803f80, v32
  v_dot2c_f32_bf16 v237, 0x3f803f80, v36
  v_dot2c_f32_bf16 v238, 0x3f803f80, v40
  v_dot2c_f32_bf16 v116, 0x3f803f80, v33
  v_dot2c_f32_bf16 v117, 0x3f803f80, v37
  v_dot2c_f32_bf16 v118, 0x3f803f80, v41
  v_dot2c_f32_bf16 v236, 0x3f803f80, v34
  v_dot2c_f32_bf16 v237, 0x3f803f80, v38
  v_dot2c_f32_bf16 v238, 0x3f803f80, v42
  v_dot2c_f32_bf16 v116, 0x3f803f80, v35
  v_dot2c_f32_bf16 v117, 0x3f803f80, v39
  v_dot2c_f32_bf16 v118, 0x3f803f80, v43
  s_waitcnt lgkmcnt(0)
  v_and_b32 v124, v124, v125
  v_and_b32 v126, v126, v127
  v_and_b32 v124, v124, v126
  s_nop 0
  v_readfirstlane_b32 s14, v124
  s_nop 3
  s_cmp_lg_u32 s14, 0
  s_cbranch_scc1 k1_lf0_5_ok
  v_mov_b32 v18, 159904
k1_lf0_5:
  ds_read_b128 v[124:127], v18
  s_waitcnt lgkmcnt(0)
  v_and_b32 v124, v124, v125
  v_and_b32 v126, v126, v127
  v_and_b32 v124, v124, v126
  s_nop 0
  v_readfirstlane_b32 s14, v124
  s_nop 3
  s_cmp_eq_u32 s14, 0
  s_cbranch_scc1 k1_lf0_5
k1_lf0_5_ok:
  v_mfma_f32_32x32x16_bf16 v[64:79], v[44:47], v[28:31], v[64:79]
  ds_read_b128 v[24:27], v12 offset:0
  ds_read_b64_tr_b16 v[32:33], v17 offset:8192
  ds_read_b64_tr_b16 v[34:35], v17 offset:9728
  ds_read_b64_tr_b16 v[36:37], v17 offset:8320
  v_mfma_f32_32x32x16_bf16 v[80:95], v[28:31], v[48:51], v[80:95]
  ds_read_b64_tr_b16 v[38:39], v17 offset:9856
  ds_read_b64_tr_b16 v[40:41], v17 offset:8448
  ds_read_b64_tr_b16 v[42:43], v17 offset:9984
  v_mfma_f32_32x32x16_bf16 v[96:111], v[28:31], v[52:55], v[96:111]
  s_waitcnt lgkmcnt(0)
  s_lshl_b32 s14, s5, 2
  v_mov_b32 v120, s14
  buffer_load_dword v121, v120, s[48:51], 0 offen sc1
  v_mfma_f32_32x32x16_bf16 v[64:79], v[32:35], v[24:27], v[64:79]
  ds_read_b128 v[28:31], v13 offset:0
  ds_read_b64_tr_b16 v[44:45], v17 offset:14336
  ds_read_b64_tr_b16 v[46:47], v17 offset:15872
  ds_read_b64_tr_b16 v[48:49], v17 offset:14464
  v_mfma_f32_32x32x16_bf16 v[80:95], v[24:27], v[36:39], v[80:95]
  ds_read_b64_tr_b16 v[50:51], v17 offset:16000
  ds_read_b64_tr_b16 v[52:53], v17 offset:14592
  ds_read_b64_tr_b16 v[54:55], v17 offset:16128
  v_mfma_f32_32x32x16_bf16 v[96:111], v[24:27], v[40:43], v[96:111]
  v_dot2c_f32_bf16 v112, 0x3f803f80, v24
  v_dot2c_f32_bf16 v114, v24, v24
  v_dot2c_f32_bf16 v113, 0x3f803f80, v25
  v_dot2c_f32_bf16 v115, v25, v25
  v_dot2c_f32_bf16 v232, 0x3f803f80, v26
  v_dot2c_f32_bf16 v234, v26, v26
  v_dot2c_f32_bf16 v233, 0x3f803f80, v27
  v_dot2c_f32_bf16 v235, v27, v27
  v_dot2c_f32_bf16 v236, 0x3f803f80, v32
  v_dot2c_f32_bf16 v237, 0x3f803f80, v36
  v_dot2c_f32_bf16 v238, 0x3f803f80, v40
  v_dot2c_f32_bf16 v116, 0x3f803f80, v33
  v_dot2c_f32_bf16 v117, 0x3f803f80, v37
  v_dot2c_f32_bf16 v118, 0x3f803f80, v41
  v_dot2c_f32_bf16 v236, 0x3f803f80, v34
  v_dot2c_f32_bf16 v237, 0x3f803f80, v38
  v_dot2c_f32_bf16 v238, 0x3f803f80, v42
  v_dot2c_f32_bf16 v116, 0x3f803f80, v35
  v_dot2c_f32_bf16 v117, 0x3f803f80, v39
  v_dot2c_f32_bf16 v118, 0x3f803f80, v43
  s_waitcnt lgkmcnt(0)
  v_mfma_f32_32x32x16_bf16 v[64:79], v[44:47], v[28:31], v[64:79]
  ds_read_b128 v[24:27], v14 offset:0
  ds_read_b64_tr_b16 v[32:33], v17 offset:20480
  ds_read_b64_tr_b16 v[34:35], v17 offset:22016
  ds_read_b64_tr_b16 v[36:37], v17 offset:20608
  v_mfma_f32_32x32x16_bf16 v[80:95], v[28:31], v[48:51], v[80:95]
  ds_read_b64_tr_b16 v[38:39], v17 offset:22144
  ds_read_b64_tr_b16 v[40:41], v17 offset:20736
  ds_read_b64_tr_b16 v[42:43], v17 offset:22272
  v_mfma_f32_32x32x16_bf16 v[96:111], v[28:31], v[52:55], v[96:111]
  s_waitcnt lgkmcnt(0)
  v_mfma_f32_32x32x16_bf16 v[64:79], v[32:35], v[24:27], v[64:79]
  ds_read_b128 v[28:31], v15 offset:0
  ds_read_b64_tr_b16 v[44:45], v17 offset:26624
  ds_read_b64_tr_b16 v[46:47], v17 offset:28160
  ds_read_b64_tr_b16 v[48:49], v17 offset:26752
  v_mfma_f32_32x32x16_bf16 v[80:95], v[24:27], v[36:39], v[80:95]
  ds_read_b64_tr_b16 v[50:51], v17 offset:28288
  ds_read_b64_tr_b16 v[52:53], v17 offset:26880
  ds_read_b64_tr_b16 v[54:55], v17 offset:28416
  ds_read_b128 v[124:127], v119 offset:176
  v_mfma_f32_32x32x16_bf16 v[96:111], v[24:27], v[40:43], v[96:111]
  v_dot2c_f32_bf16 v112, 0x3f803f80, v24
  v_dot2c_f32_bf16 v114, v24, v24
  v_dot2c_f32_bf16 v113, 0x3f803f80, v25
  v_dot2c_f32_bf16 v115, v25, v25
  v_dot2c_f32_bf16 v232, 0x3f803f80, v26
  v_dot2c_f32_bf16 v234, v26, v26
  v_dot2c_f32_bf16 v233, 0x3f803f80, v27
  v_dot2c_f32_bf16 v235, v27, v27
  v_dot2c_f32_bf16 v236, 0x3f803f80, v32
  v_dot2c_f32_bf16 v237, 0x3f803f80, v36
  v_dot2c_f32_bf16 v238, 0x3f803f80, v40
  v_dot2c_f32_bf16 v116, 0x3f803f80, v33
  v_dot2c_f32_bf16 v117, 0x3f803f80, v37
  v_dot2c_f32_bf16 v118, 0x3f803f80, v41
  v_dot2c_f32_bf16 v236, 0x3f803f80, v34
  v_dot2c_f32_bf16 v237, 0x3f803f80, v38
  v_dot2c_f32_bf16 v238, 0x3f803f80, v42
  v_dot2c_f32_bf16 v116, 0x3f803f80, v35
  v_dot2c_f32_bf16 v117, 0x3f803f80, v39
  v_dot2c_f32_bf16 v118, 0x3f803f80, v43
  s_waitcnt lgkmcnt(0)
  v_and_b32 v124, v124, v125
  v_and_b32 v126, v126, v127
  v_and_b32 v124, v124, v126
  s_nop 0
  v_readfirstlane_b32 s14, v124
  s_nop 3
  s_cmp_lg_u32 s14, 0
  s_cbranch_scc1 k1_lf0_6_ok
  v_mov_b32 v18, 159920
k1_lf0_6:
  ds_read_b128 v[124:127], v18
  s_waitcnt lgkmcnt(0)
  v_and_b32 v124, v124, v125
  v_and_b32 v126, v126, v127
  v_and_b32 v124, v124, v126
  s_nop 0
  v_readfirstlane_b32 s14, v124
  s_nop 3
  s_cmp_eq_u32 s14, 0
  s_cbranch_scc1 k1_lf0_6
k1_lf0_6_ok:
  v_mfma_f32_32x32x16_bf16 v[64:79], v[44:47], v[28:31], v[64:79]
  ds_read_b128 v[24:27], v12 offset:32768
  ds_read_b64_tr_b16 v[32:33], v17 offset:40960
  ds_read_b64_tr_b16 v[34:35], v17 offset:42496
  ds_read_b64_tr_b16 v[36:37], v17 offset:41088
  v_mfma_f32_32x32x16_bf16 v[80:95], v[28:31], v[48:51], v[80:95]
  ds_read_b64_tr_b16 v[38:39], v17 offset:42624
  ds_read_b64_tr_b16 v[40:41], v17 offset:41216
  ds_read_b64_tr_b16 v[42:43], v17 offset:42752
  v_mfma_f32_32x32x16_bf16 v[96:111], v[28:31], v[52:55], v[96:111]
  s_waitcnt lgkmcnt(0)
  v_mov_b32 v18, 159744
  v_mov_b32 v123, 1
  ds_write_b32 v18, v123
  v_mfma_f32_32x32x16_bf16 v[64:79], v[32:35], v[24:27], v[64:79]
  ds_read_b128 v[28:31], v13 offset:32768
  ds_read_b64_tr_b16 v[44:45], v17 offset:47104
  ds_read_b64_tr_b16 v[46:47], v17 offset:48640
  ds_read_b64_tr_b16 v[48:49], v17 offset:47232
  v_mfma_f32_32x32x16_bf16 v[80:95], v[24:27], v[36:39], v[80:95]
  ds_read_b64_tr_b16 v[50:51], v17 offset:48768
  ds_read_b64_tr_b16 v[52:53], v17 offset:47360
  ds_read_b64_tr_b16 v[54:55], v17 offset:48896
  v_mfma_f32_32x32x16_bf16 v[96:111], v[24:27], v[40:43], v[96:111]
  v_dot2c_f32_bf16 v112, 0x3f803f80, v24
  v_dot2c_f32_bf16 v114, v24, v24
  v_dot2c_f32_bf16 v113, 0x3f803f80, v25
  v_dot2c_f32_bf16 v115, v25, v25
  v_dot2c_f32_bf16 v232, 0x3f803f80, v26
  v_dot2c_f32_bf16 v234, v26, v26
  v_dot2c_f32_bf16 v233, 0x3f803f80, v27
  v_dot2c_f32_bf16 v235, v27, v27
  v_dot2c_f32_bf16 v236, 0x3f803f80, v32
  v_dot2c_f32_bf16 v237, 0x3f803f80, v36
  v_dot2c_f32_bf16 v238, 0x3f803f80, v40
  v_dot2c_f32_bf16 v116, 0x3f803f80, v33
  v_dot2c_f32_bf16 v117, 0x3f803f80, v37
  v_dot2c_f32_bf16 v118, 0x3f803f80, v41
  v_dot2c_f32_bf16 v236, 0x3f803f80, v34
  v_dot2c_f32_bf16 v237, 0x3f803f80, v38
  v_dot2c_f32_bf16 v238, 0x3f803f80, v42
  v_dot2c_f32_bf16 v116, 0x3f803f80, v35
  v_dot2c_f32_bf16 v117, 0x3f803f80, v39
  v_dot2c_f32_bf16 v118, 0x3f803f80, v43
  s_waitcnt lgkmcnt(0)
  v_mfma_f32_32x32x16_bf16 v[64:79], v[44:47], v[28:31], v[64:79]
  ds_read_b128 v[24:27], v14 offset:32768
  ds_read_b64_tr_b16 v[32:33], v17 offset:53248
  ds_read_b64_tr_b16 v[34:35], v17 offset:54784
  ds_read_b64_tr_b16 v[36:37], v17 offset:53376
  v_mfma_f32_32x32x16_bf16 v[80:95], v[28:31], v[48:51], v[80:95]
  ds_read_b64_tr_b16 v[38:39], v17 offset:54912
  ds_read_b64_tr_b16 v[40:41], v17 offset:53504
  ds_read_b64_tr_b16 v[42:43], v17 offset:55040
  v_mfma_f32_32x32x16_bf16 v[96:111], v[28:31], v[52:55], v[96:111]
  s_waitcnt lgkmcnt(0)
  v_mfma_f32_32x32x16_bf16 v[64:79], v[32:35], v[24:27], v[64:79]
  ds_read_b128 v[28:31], v15 offset:32768
  ds_read_b64_tr_b16 v[44:45], v17 offset:59392
  ds_read_b64_tr_b16 v[46:47], v17 offset:60928
  ds_read_b64_tr_b16 v[48:49], v17 offset:59520
  v_mfma_f32_32x32x16_bf16 v[80:95], v[24:27], v[36:39], v[80:95]
  ds_read_b64_tr_b16 v[50:51], v17 offset:61056
  ds_read_b64_tr_b16 v[52:53], v17 offset:59648
  ds_read_b64_tr_b16 v[54:55], v17 offset:61184
  v_mfma_f32_32x32x16_bf16 v[96:111], v[24:27], v[40:43], v[96:111]
  v_dot2c_f32_bf16 v112, 0x3f803f80, v24
  v_dot2c_f32_bf16 v114, v24, v24
  v_dot2c_f32_bf16 v113, 0x3f803f80, v25
  v_dot2c_f32_bf16 v115, v25, v25
  v_dot2c_f32_bf16 v232, 0x3f803f80, v26
  v_dot2c_f32_bf16 v234, v26, v26
  v_dot2c_f32_bf16 v233, 0x3f803f80, v27
  v_dot2c_f32_bf16 v235, v27, v27
  v_dot2c_f32_bf16 v236, 0x3f803f80, v32
  v_dot2c_f32_bf16 v237, 0x3f803f80, v36
  v_dot2c_f32_bf16 v238, 0x3f803f80, v40
  v_dot2c_f32_bf16 v116, 0x3f803f80, v33
  v_dot2c_f32_bf16 v117, 0x3f803f80, v37
  v_dot2c_f32_bf16 v118, 0x3f803f80, v41
  v_dot2c_f32_bf16 v236, 0x3f803f80, v34
  v_dot2c_f32_bf16 v237, 0x3f803f80, v38
  v_dot2c_f32_bf16 v238, 0x3f803f80, v42
  v_dot2c_f32_bf16 v116, 0x3f803f80, v35
  v_dot2c_f32_bf16 v117, 0x3f803f80, v39
  v_dot2c_f32_bf16 v118, 0x3f803f80, v43
  s_waitcnt lgkmcnt(0)
  v_mfma_f32_32x32x16_bf16 v[64:79], v[44:47], v[28:31], v[64:79]
  v_mfma_f32_32x32x16_bf16 v[80:95], v[28:31], v[48:51], v[80:95]
  v_mfma_f32_32x32x16_bf16 v[96:111], v[28:31], v[52:55], v[96:111]
  s_waitcnt lgkmcnt(0)
  s_nop 2
  v_add_f32 v112, v112, v113
  v_add_f32 v232, v232, v233
  v_add_f32 v114, v114, v115
  v_add_f32 v234, v234, v235
  v_add_f32 v116, v116, v236
  v_add_f32 v117, v117, v237
  v_add_f32 v118, v118, v238
  v_add_f32 v112, v112, v232
  v_add_f32 v114, v114, v234
  v_mov_b32 v24, v112
  v_mov_b32 v25, v114
  v_mov_b32 v26, v116
  v_mov_b32 v27, v117
  v_mov_b32 v28, v118
  s_nop 1
  v_permlane32_swap_b32 v112, v24
  v_permlane32_swap_b32 v114, v25
  v_permlane32_swap_b32 v116, v26
  v_permlane32_swap_b32 v117, v27
  v_permlane32_swap_b32 v118, v28
  s_nop 1
  v_add_f32 v112, v112, v24
  v_add_f32 v114, v114, v25
  v_add_f32 v116, v116, v26
  v_add_f32 v117, v117, v27
  v_add_f32 v118, v118, v28
  ds_write_b32 v228, v112 offset:0
  ds_write_b32 v228, v114 offset:128
  ds_write_b32 v228, v116 offset:1024
  ds_write_b32 v228, v117 offset:1152
  ds_write_b32 v228, v118 offset:1280
  v_mov_b32 v18, 159760
  v_mov_b32 v123, 1
  ds_write_b32 v18, v123
  v_mov_b32 v18, 159760
k1_sp0a:
  ds_read_b128 v[124:127], v18
  s_waitcnt lgkmcnt(0)
  v_and_b32 v124, v124, v125
  v_and_b32 v126, v126, v127
  v_and_b32 v124, v124, v126
  s_nop 0
  v_readfirstlane_b32 s14, v124
  s_nop 3
  s_cmp_eq_u32 s14, 0
  s_cbranch_scc1 k1_sp0a
  ds_read_b32 v24, v228 offset:256
  ds_read_b32 v25, v228 offset:384
  ds_read_b32 v26, v228 offset:1408
  ds_read_b32 v27, v228 offset:1536
  ds_read_b32 v28, v228 offset:1664
  s_waitcnt lgkmcnt(0)
  v_add_f32 v112, v112, v24
  v_add_f32 v114, v114, v25
  v_add_f32 v116, v116, v26
  v_add_f32 v117, v117, v27
  v_add_f32 v118, v118, v28
  ds_write_b32 v229, v116 offset:256
  v_mul_f32 v112, 0x3b000000, v112
  v_mul_f32 v114, 0x3b000000, v114
  v_fma_f32 v114, -v112, v112, v114
  v_max_f32 v114, 0, v114
  v_add_f32 v114, 0x3727c5ac, v114
  v_rsq_f32 v114, v114
  s_nop 0
  v_mul_f32 v112, v112, v114
  v_sub_f32 v112, 0, v112
  ds_write_b32 v229, v114 offset:0
  ds_write_b32 v229, v112 offset:128
  v_mov_b32 v184, v114
  v_mov_b32 v186, v112
  v_mov_b32 v188, v117
  v_mov_b32 v190, v118
  s_waitcnt lgkmcnt(0)
  ds_read_b128 v[128:131], v230 offset:0
  ds_read_b128 v[144:147], v230 offset:128
  ds_read_b128 v[132:135], v230 offset:32
  ds_read_b128 v[148:151], v230 offset:160
  ds_read_b128 v[136:139], v230 offset:64
  ds_read_b128 v[152:155], v230 offset:192
  ds_read_b128 v[140:143], v230 offset:96
  ds_read_b128 v[156:159], v230 offset:224
  ds_read_b128 v[160:163], v230 offset:256
  ds_read_b128 v[164:167], v230 offset:288
  ds_read_b128 v[168:171], v230 offset:320
  ds_read_b128 v[172:175], v230 offset:352
  ds_read_b128 v[124:127], v119
  s_waitcnt lgkmcnt(5)
  v_pk_mul_f32 v[24:25], v[144:145], v[190:191] op_sel_hi:[1,0]
  v_pk_mul_f32 v[26:27], v[146:147], v[190:191] op_sel_hi:[1,0]
  v_pk_mul_f32 v[28:29], v[148:149], v[190:191] op_sel_hi:[1,0]
  v_pk_mul_f32 v[30:31], v[150:151], v[190:191] op_sel_hi:[1,0]
  v_pk_mul_f32 v[32:33], v[152:153], v[190:191] op_sel_hi:[1,0]
  v_pk_mul_f32 v[34:35], v[154:155], v[190:191] op_sel_hi:[1,0]
  v_pk_mul_f32 v[36:37], v[156:157], v[190:191] op_sel_hi:[1,0]
  v_pk_mul_f32 v[38:39], v[158:159], v[190:191] op_sel_hi:[1,0]
  v_pk_fma_f32 v[96:97], v[96:97], v[128:129], v[24:25]
  v_pk_fma_f32 v[98:99], v[98:99], v[130:131], v[26:27]
  v_pk_fma_f32 v[100:101], v[100:101], v[132:133], v[28:29]
  v_pk_fma_f32 v[102:103], v[102:103], v[134:135], v[30:31]
  v_pk_fma_f32 v[104:105], v[104:105], v[136:137], v[32:33]
  v_pk_fma_f32 v[106:107], v[106:107], v[138:139], v[34:35]
  v_pk_fma_f32 v[108:109], v[108:109], v[140:141], v[36:37]
  v_pk_fma_f32 v[110:111], v[110:111], v[142:143], v[38:39]
  v_pk_fma_f32 v[40:41], v[144:145], v[188:189], v[176:177] op_sel_hi:[1,0,1]
  v_pk_fma_f32 v[42:43], v[146:147], v[188:189], v[176:177] op_sel_hi:[1,0,1]
  v_pk_fma_f32 v[44:45], v[148:149], v[188:189], v[176:177] op_sel_hi:[1,0,1]
  v_pk_fma_f32 v[46:47], v[150:151], v[188:189], v[176:177] op_sel_hi:[1,0,1]
  v_pk_fma_f32 v[48:49], v[152:153], v[188:189], v[176:177] op_sel_hi:[1,0,1]
  v_pk_fma_f32 v[50:51], v[154:155], v[188:189], v[176:177] op_sel_hi:[1,0,1]
  v_pk_fma_f32 v[52:53], v[156:157], v[188:189], v[176:177] op_sel_hi:[1,0,1]
  v_pk_fma_f32 v[54:55], v[158:159], v[188:189], v[176:177] op_sel_hi:[1,0,1]
  v_pk_fma_f32 v[80:81], v[80:81], v[128:129], v[40:41]
  v_pk_fma_f32 v[82:83], v[82:83], v[130:131], v[42:43]
  v_pk_fma_f32 v[84:85], v[84:85], v[132:133], v[44:45]
  v_pk_fma_f32 v[86:87], v[86:87], v[134:135], v[46:47]
  v_pk_fma_f32 v[88:89], v[88:89], v[136:137], v[48:49]
  v_pk_fma_f32 v[90:91], v[90:91], v[138:139], v[50:51]
  v_pk_fma_f32 v[92:93], v[92:93], v[140:141], v[52:53]
  v_pk_fma_f32 v[94:95], v[94:95], v[142:143], v[54:55]
  v_pk_fma_f32 v[40:41], v[80:81], v[178:179], v[180:181]
  v_pk_fma_f32 v[42:43], v[82:83], v[178:179], v[180:181]
  v_pk_fma_f32 v[44:45], v[84:85], v[178:179], v[180:181]
  v_pk_fma_f32 v[46:47], v[86:87], v[178:179], v[180:181]
  v_pk_fma_f32 v[48:49], v[88:89], v[178:179], v[180:181]
  v_pk_fma_f32 v[50:51], v[90:91], v[178:179], v[180:181]
  v_pk_fma_f32 v[52:53], v[92:93], v[178:179], v[180:181]
  v_pk_fma_f32 v[54:55], v[94:95], v[178:179], v[180:181]
  v_exp_f32_e64 v40, v40 clamp
  v_exp_f32_e64 v41, v41 clamp
  v_exp_f32_e64 v42, v42 clamp
  v_exp_f32_e64 v43, v43 clamp
  v_exp_f32_e64 v44, v44 clamp
  v_exp_f32_e64 v45, v45 clamp
  v_exp_f32_e64 v46, v46 clamp
  v_exp_f32_e64 v47, v47 clamp
  v_exp_f32_e64 v48, v48 clamp
  v_exp_f32_e64 v49, v49 clamp
  v_exp_f32_e64 v50, v50 clamp
  v_exp_f32_e64 v51, v51 clamp
  v_exp_f32_e64 v52, v52 clamp
  v_exp_f32_e64 v53, v53 clamp
  v_exp_f32_e64 v54, v54 clamp
  v_exp_f32_e64 v55, v55 clamp
  v_pk_add_f32 v[40:41], v[40:41], v[182:183]
  v_pk_add_f32 v[42:43], v[42:43], v[182:183]
  v_pk_add_f32 v[44:45], v[44:45], v[182:183]
  v_pk_add_f32 v[46:47], v[46:47], v[182:183]
  v_pk_add_f32 v[48:49], v[48:49], v[182:183]
  v_pk_add_f32 v[50:51], v[50:51], v[182:183]
  v_pk_add_f32 v[52:53], v[52:53], v[182:183]
  v_pk_add_f32 v[54:55], v[54:55], v[182:183]
  v_max_f32 v80, v80, v40
  v_max_f32 v81, v81, v41
  v_max_f32 v82, v82, v42
  v_max_f32 v83, v83, v43
  v_max_f32 v84, v84, v44
  v_max_f32 v85, v85, v45
  v_max_f32 v86, v86, v46
  v_max_f32 v87, v87, v47
  v_max_f32 v88, v88, v48
  v_max_f32 v89, v89, v49
  v_max_f32 v90, v90, v50
  v_max_f32 v91, v91, v51
  v_max_f32 v92, v92, v52
  v_max_f32 v93, v93, v53
  v_max_f32 v94, v94, v54
  v_max_f32 v95, v95, v55
  v_cvt_pk_bf16_f32 v216, v96, v97
  v_cvt_pk_bf16_f32 v217, v98, v99
  v_cvt_pk_bf16_f32 v218, v100, v101
  v_cvt_pk_bf16_f32 v219, v102, v103
  v_cvt_pk_bf16_f32 v220, v104, v105
  v_cvt_pk_bf16_f32 v221, v106, v107
  v_cvt_pk_bf16_f32 v222, v108, v109
  v_cvt_pk_bf16_f32 v223, v110, v111
  v_cvt_pk_bf16_f32 v208, v80, v81
  v_cvt_pk_bf16_f32 v209, v82, v83
  v_cvt_pk_bf16_f32 v210, v84, v85
  v_cvt_pk_bf16_f32 v211, v86, v87
  v_cvt_pk_bf16_f32 v212, v88, v89
  v_cvt_pk_bf16_f32 v213, v90, v91
  v_cvt_pk_bf16_f32 v214, v92, v93
  v_cvt_pk_bf16_f32 v215, v94, v95
  s_nop 1
  v_mfma_f32_32x32x16_bf16 v[80:95], v[216:219], v[208:211], 0
  v_mfma_f32_32x32x16_bf16 v[96:111], v[224:227], v[208:211], 0
  v_mfma_f32_32x32x16_bf16 v[80:95], v[220:223], v[212:215], v[80:95]
  v_mfma_f32_32x32x16_bf16 v[96:111], v[224:227], v[212:215], v[96:111]
  v_and_b32 v22, 16, v0
  v_cmp_ne_u32 vcc, 0, v22
  v_lshlrev_b32 v19, 2, v0
  v_add_u32 v19, 73728, v19
  v_bfe_u32 v9, v0, 4, 1
  s_movk_i32 s13, 1088
  v_mul_lo_u32 v9, v9, s13
  v_and_b32 v10, 15, v0
  v_lshl_add_u32 v9, v10, 2, v9
  v_lshl_add_u32 v10, v21, 8, v9
  s_lshl_b32 s13, s5, 2
  s_add_u32 s13, s13, 0
  s_mulk_i32 s13, 1088
  s_waitcnt lgkmcnt(0)
  v_and_b32 v124, v124, v125
  v_and_b32 v126, v126, v127
  v_and_b32 v124, v124, v126
  s_nop 0
  v_readfirstlane_b32 s14, v124
  s_nop 3
  s_cmp_lg_u32 s14, 0
  s_cbranch_scc1 k1_d60_ok
  v_mov_b32 v18, 159744
k1_d60:
  ds_read_b128 v[124:127], v18
  s_waitcnt lgkmcnt(0)
  v_and_b32 v124, v124, v125
  v_and_b32 v126, v126, v127
  v_and_b32 v124, v124, v126
  s_nop 0
  v_readfirstlane_b32 s14, v124
  s_nop 3
  s_cmp_eq_u32 s14, 0
  s_cbranch_scc1 k1_d60
k1_d60_ok:
  v_cndmask_b32 v24, v80, v88, vcc
  v_cndmask_b32 v25, v81, v89, vcc
  v_cndmask_b32 v26, v82, v90, vcc
  v_cndmask_b32 v27, v83, v91, vcc
  v_cndmask_b32 v28, v84, v92, vcc
  v_cndmask_b32 v29, v85, v93, vcc
  v_cndmask_b32 v30, v86, v94, vcc
  v_cndmask_b32 v31, v87, v95, vcc
  ds_write_b32 v19, v28 offset:1024
  ds_write_b32 v19, v29 offset:1280
  ds_write_b32 v19, v30 offset:1536
  ds_write_b32 v19, v31 offset:1792
  v_mov_b32 v18, 159776
  v_mov_b32 v123, 1
  ds_write_b32 v18, v123
  v_mov_b32 v18, 159784
k1_sp0c:
  ds_read_b32 v122, v18
  s_waitcnt lgkmcnt(0)
  v_readfirstlane_b32 s14, v122
  s_nop 3
  s_cmp_eq_u32 s14, 0
  s_cbranch_scc1 k1_sp0c
  ds_read_b32 v32, v19 offset:2304
  ds_read_b32 v33, v19 offset:2560
  ds_read_b32 v34, v19 offset:2816
  ds_read_b32 v35, v19 offset:3072
  ds_read_b32 v36, v19 offset:4352
  s_waitcnt vmcnt(0)
  s_waitcnt lgkmcnt(0)
  v_add_f32 v24, v24, v32
  v_add_f32 v25, v25, v33
  v_add_f32 v26, v26, v34
  v_add_f32 v27, v27, v35
  v_add_f32 v36, v36, v96
  s_mov_b32 s15, 0
k1_poll0:
  v_readfirstlane_b32 s14, v121
  s_add_u32 s15, s15, 1
  s_nop 2
  s_cmp_lg_u32 s14, 0
  s_cbranch_scc1 k1_go0
  s_cmp_ge_u32 s15, 0x20000
  s_cbranch_scc1 k1_go0
  s_sleep 2
  buffer_load_dword v121, v120, s[48:51], 0 offen sc1
  s_waitcnt vmcnt(0)
  s_branch k1_poll0
k1_go0:
  buffer_atomic_add_f32 v24, v10, s[44:47], s13 offen offset:0
  buffer_atomic_add_f32 v25, v10, s[44:47], s13 offen offset:64
  buffer_atomic_add_f32 v26, v10, s[44:47], s13 offen offset:128
  buffer_atomic_add_f32 v27, v10, s[44:47], s13 offen offset:192
  s_mov_b64 exec, 0xffffffff
  buffer_atomic_add_f32 v36, v9, s[44:47], s13 offen offset:1024
  s_mov_b64 exec, -1
  v_pk_fma_f32 v[40:41], v[160:161], v[186:187], v[176:177] op_sel_hi:[1,0,1]
  v_pk_fma_f32 v[42:43], v[162:163], v[186:187], v[176:177] op_sel_hi:[1,0,1]
  v_pk_fma_f32 v[44:45], v[164:165], v[186:187], v[176:177] op_sel_hi:[1,0,1]
  v_pk_fma_f32 v[46:47], v[166:167], v[186:187], v[176:177] op_sel_hi:[1,0,1]
  v_pk_fma_f32 v[48:49], v[168:169], v[186:187], v[176:177] op_sel_hi:[1,0,1]
  v_pk_fma_f32 v[50:51], v[170:171], v[186:187], v[176:177] op_sel_hi:[1,0,1]
  v_pk_fma_f32 v[52:53], v[172:173], v[186:187], v[176:177] op_sel_hi:[1,0,1]
  v_pk_fma_f32 v[54:55], v[174:175], v[186:187], v[176:177] op_sel_hi:[1,0,1]
  v_pk_fma_f32 v[64:65], v[64:65], v[184:185], v[40:41] op_sel_hi:[1,0,1]
  v_pk_fma_f32 v[66:67], v[66:67], v[184:185], v[42:43] op_sel_hi:[1,0,1]
  v_pk_fma_f32 v[68:69], v[68:69], v[184:185], v[44:45] op_sel_hi:[1,0,1]
  v_pk_fma_f32 v[70:71], v[70:71], v[184:185], v[46:47] op_sel_hi:[1,0,1]
  v_pk_fma_f32 v[72:73], v[72:73], v[184:185], v[48:49] op_sel_hi:[1,0,1]
  v_pk_fma_f32 v[74:75], v[74:75], v[184:185], v[50:51] op_sel_hi:[1,0,1]
  v_pk_fma_f32 v[76:77], v[76:77], v[184:185], v[52:53] op_sel_hi:[1,0,1]
  v_pk_fma_f32 v[78:79], v[78:79], v[184:185], v[54:55] op_sel_hi:[1,0,1]
  v_pk_fma_f32 v[40:41], v[64:65], v[178:179], v[180:181]
  v_pk_fma_f32 v[42:43], v[66:67], v[178:179], v[180:181]
  v_pk_fma_f32 v[44:45], v[68:69], v[178:179], v[180:181]
  v_pk_fma_f32 v[46:47], v[70:71], v[178:179], v[180:181]
  v_pk_fma_f32 v[48:49], v[72:73], v[178:179], v[180:181]
  v_pk_fma_f32 v[50:51], v[74:75], v[178:179], v[180:181]
  v_pk_fma_f32 v[52:53], v[76:77], v[178:179], v[180:181]
  v_pk_fma_f32 v[54:55], v[78:79], v[178:179], v[180:181]
  v_exp_f32_e64 v40, v40 clamp
  v_exp_f32_e64 v41, v41 clamp
  v_exp_f32_e64 v42, v42 clamp
  v_exp_f32_e64 v43, v43 clamp
  v_exp_f32_e64 v44, v44 clamp
  v_exp_f32_e64 v45, v45 clamp
  v_exp_f32_e64 v46, v46 clamp
  v_exp_f32_e64 v47, v47 clamp
  v_exp_f32_e64 v48, v48 clamp
  v_exp_f32_e64 v49, v49 clamp
  v_exp_f32_e64 v50, v50 clamp
  v_exp_f32_e64 v51, v51 clamp
  v_exp_f32_e64 v52, v52 clamp
  v_exp_f32_e64 v53, v53 clamp
  v_exp_f32_e64 v54, v54 clamp
  v_exp_f32_e64 v55, v55 clamp
  v_pk_add_f32 v[40:41], v[40:41], v[182:183]
  v_pk_add_f32 v[42:43], v[42:43], v[182:183]
  v_pk_add_f32 v[44:45], v[44:45], v[182:183]
  v_pk_add_f32 v[46:47], v[46:47], v[182:183]
  v_pk_add_f32 v[48:49], v[48:49], v[182:183]
  v_pk_add_f32 v[50:51], v[50:51], v[182:183]
  v_pk_add_f32 v[52:53], v[52:53], v[182:183]
  v_pk_add_f32 v[54:55], v[54:55], v[182:183]
  v_max_f32 v64, v64, v40
  v_max_f32 v65, v65, v41
  v_max_f32 v66, v66, v42
  v_max_f32 v67, v67, v43
  v_max_f32 v68, v68, v44
  v_max_f32 v69, v69, v45
  v_max_f32 v70, v70, v46
  v_max_f32 v71, v71, v47
  v_max_f32 v72, v72, v48
  v_max_f32 v73, v73, v49
  v_max_f32 v74, v74, v50
  v_max_f32 v75, v75, v51
  v_max_f32 v76, v76, v52
  v_max_f32 v77, v77, v53
  v_max_f32 v78, v78, v54
  v_max_f32 v79, v79, v55
  v_cvt_pk_bf16_f32 v200, v64, v65
  v_cvt_pk_bf16_f32 v201, v66, v67
  v_cvt_pk_bf16_f32 v202, v68, v69
  v_cvt_pk_bf16_f32 v203, v70, v71
  v_cvt_pk_bf16_f32 v204, v72, v73
  v_cvt_pk_bf16_f32 v205, v74, v75
  v_cvt_pk_bf16_f32 v206, v76, v77
  v_cvt_pk_bf16_f32 v207, v78, v79
  s_add_u32 s52, s34, 1048576
  s_addc_u32 s53, s35, 0
  s_mov_b32 s54, 2097152
  s_mov_b32 s55, 0x20000
  s_lshl_b32 s12, s6, 1
  s_add_u32 s12, s12, 0
  s_lshl_b32 s12, s12, 5
  s_lshl_b32 s13, s5, 2
  s_add_u32 s12, s12, s13
  s_add_u32 s12, s12, 0
  s_lshl_b32 s12, s12, 10
  v_lshlrev_b32 v18, 4, v0
  buffer_store_dwordx4 v[200:203], v18, s[52:55], s12 offen sc1
  buffer_store_dwordx4 v[204:207], v18, s[52:55], s12 offen offset:1024 sc1
  s_branch k1_fin
k1_w1:
  v_and_b32 v20, 31, v0
  v_lshrrev_b32 v21, 5, v0
  v_bfe_u32 v22, v0, 1, 3
  v_xor_b32 v22, v22, v21
  v_lshlrev_b32 v22, 4, v22
  v_lshl_add_u32 v22, v20, 7, v22
  v_add_u32 v8, 0, v22
  v_xor_b32 v9, 32, v8
  v_xor_b32 v10, 64, v8
  v_xor_b32 v11, 96, v8
  v_add_u32 v12, 0x10000, v8
  v_add_u32 v13, 0x10000, v9
  v_add_u32 v14, 0x10000, v10
  v_add_u32 v15, 0x10000, v11
  v_bfe_u32 v22, v0, 2, 2
  v_lshl_add_u32 v23, v21, 3, v22
  v_mul_u32_u24 v23, 384, v23
  v_bfe_u32 v22, v0, 3, 1
  v_xor_b32 v22, 1, v22
  v_lshl_add_u32 v23, v22, 6, v23
  v_bfe_u32 v22, v0, 4, 1
  v_lshl_add_u32 v23, v22, 5, v23
  v_and_b32 v22, 3, v0
  v_lshl_add_u32 v16, v22, 3, v23
  v_add_u32 v17, 0x10000, v16
  v_mov_b32 v112, 0
  v_mov_b32 v113, 0
  v_mov_b32 v114, 0
  v_mov_b32 v115, 0
  v_mov_b32 v116, 0
  v_mov_b32 v117, 0
  v_mov_b32 v118, 0
  v_mov_b32 v232, 0
  v_mov_b32 v233, 0
  v_mov_b32 v234, 0
  v_mov_b32 v235, 0
  v_mov_b32 v236, 0
  v_mov_b32 v237, 0
  v_mov_b32 v238, 0
  v_and_b32 v18, 3, v0
  v_lshlrev_b32 v18, 4, v18
  v_add_u32 v18, 159808, v18
  v_mov_b32 v24, 0
  v_mov_b32 v25, 0
  v_mov_b32 v26, 0
  v_mov_b32 v27, 0
  ds_write_b128 v18, v[24:27]
  v_mov_b32 v119, 159744
  v_mov_b32 v123, 1
  s_mov_b32 s36, s16
  s_mov_b32 s37, s17
  s_mov_b32 s38, 2097152
  s_mov_b32 s39, 0x20000
  s_mov_b32 s40, s18
  s_mov_b32 s41, s19
  s_mov_b32 s42, 1572864
  s_mov_b32 s43, 0x20000
  s_lshr_b32 s12, s2, 3
  s_lshl_b32 s12, s12, 2
  s_add_u32 s12, s12, 1
  s_and_b32 s13, s2, 7
  s_lshr_b32 s15, s13, 1
  s_lshl_b32 s15, s15, 19
  s_lshl_b32 s14, s12, 12
  s_add_u32 s15, s15, s14
  v_lshlrev_b32 v245, 7, v20
  v_min_u32 v22, 47, v0
  v_mul_u32_u24 v23, 43, v22
  v_lshrrev_b32 v23, 9, v23
  v_mul_u32_u24 v24, 12, v23
  v_sub_u32 v24, v22, v24
  v_mul_u32_u24 v23, 3072, v23
  v_lshrrev_b32 v25, 2, v24
  v_lshl_add_u32 v23, v25, 10, v23
  v_and_b32 v24, 3, v24
  v_lshl_add_u32 v23, v24, 7, v23
  s_mul_i32 s14, s12, 12288
  s_and_b32 s13, s13, 1
  s_lshl_b32 s13, s13, 9
  s_add_u32 s14, s14, s13
  s_waitcnt lgkmcnt(0)
  s_barrier
  v_mov_b32 v176, 0x3f800008
  v_mov_b32 v177, 0x3f800008
  v_mov_b32 v178, 0x3fb8aa3b
  v_mov_b32 v179, 0x3fb8aa3b
  v_mov_b32 v180, 0xbfb8aa47
  v_mov_b32 v181, 0xbfb8aa47
  v_mov_b32 v182, 0x358637bd
  v_mov_b32 v183, 0x358637bd
  v_mov_b32 v224, 0x3f803f80
  v_mov_b32 v225, 0x3f803f80
  v_mov_b32 v226, 0x3f803f80
  v_mov_b32 v227, 0x3f803f80
  v_lshlrev_b32 v228, 2, v20
  v_add_u32 v229, 160000, v228
  v_add_u32 v228, 156672, v228
  v_lshlrev_b32 v230, 4, v21
  v_add_u32 v230, 160000, v230
  s_barrier
  buffer_load_dword v240, v245, s[36:39], s15 offen
  ds_read_b128 v[24:27], v8 offset:0
  ds_read_b64_tr_b16 v[32:33], v16 offset:8192
  ds_read_b64_tr_b16 v[34:35], v16 offset:9728
  ds_read_b64_tr_b16 v[36:37], v16 offset:8320
  ds_read_b64_tr_b16 v[38:39], v16 offset:9856
  ds_read_b64_tr_b16 v[40:41], v16 offset:8448
  ds_read_b64_tr_b16 v[42:43], v16 offset:9984
  s_waitcnt lgkmcnt(0)
  v_mfma_f32_32x32x16_bf16 v[64:79], v[32:35], v[24:27], 0
  ds_read_b128 v[28:31], v9 offset:0
  ds_read_b64_tr_b16 v[44:45], v16 offset:14336
  ds_read_b64_tr_b16 v[46:47], v16 offset:15872
  ds_read_b64_tr_b16 v[48:49], v16 offset:14464
  v_mfma_f32_32x32x16_bf16 v[80:95], v[24:27], v[36:39], 0
  ds_read_b64_tr_b16 v[50:51], v16 offset:16000
  ds_read_b64_tr_b16 v[52:53], v16 offset:14592
  ds_read_b64_tr_b16 v[54:55], v16 offset:16128
  v_mfma_f32_32x32x16_bf16 v[96:111], v[24:27], v[40:43], 0
  v_dot2c_f32_bf16 v236, 0x3f803f80, v32
  v_dot2c_f32_bf16 v237, 0x3f803f80, v36
  v_dot2c_f32_bf16 v238, 0x3f803f80, v40
  v_dot2c_f32_bf16 v116, 0x3f803f80, v33
  v_dot2c_f32_bf16 v117, 0x3f803f80, v37
  v_dot2c_f32_bf16 v118, 0x3f803f80, v41
  v_dot2c_f32_bf16 v236, 0x3f803f80, v34
  v_dot2c_f32_bf16 v237, 0x3f803f80, v38
  v_dot2c_f32_bf16 v238, 0x3f803f80, v42
  v_dot2c_f32_bf16 v116, 0x3f803f80, v35
  v_dot2c_f32_bf16 v117, 0x3f803f80, v39
  v_dot2c_f32_bf16 v118, 0x3f803f80, v43
  s_waitcnt lgkmcnt(0)
  v_mfma_f32_32x32x16_bf16 v[64:79], v[44:47], v[28:31], v[64:79]
  ds_read_b128 v[24:27], v10 offset:0
  ds_read_b64_tr_b16 v[32:33], v16 offset:20480
  ds_read_b64_tr_b16 v[34:35], v16 offset:22016
  ds_read_b64_tr_b16 v[36:37], v16 offset:20608
  v_mfma_f32_32x32x16_bf16 v[80:95], v[28:31], v[48:51], v[80:95]
  ds_read_b64_tr_b16 v[38:39], v16 offset:22144
  ds_read_b64_tr_b16 v[40:41], v16 offset:20736
  ds_read_b64_tr_b16 v[42:43], v16 offset:22272
  v_mfma_f32_32x32x16_bf16 v[96:111], v[28:31], v[52:55], v[96:111]
  v_dot2c_f32_bf16 v112, 0x3f803f80, v28
  v_dot2c_f32_bf16 v114, v28, v28
  v_dot2c_f32_bf16 v113, 0x3f803f80, v29
  v_dot2c_f32_bf16 v115, v29, v29
  v_dot2c_f32_bf16 v232, 0x3f803f80, v30
  v_dot2c_f32_bf16 v234, v30, v30
  v_dot2c_f32_bf16 v233, 0x3f803f80, v31
  v_dot2c_f32_bf16 v235, v31, v31
  s_waitcnt lgkmcnt(0)
  v_mfma_f32_32x32x16_bf16 v[64:79], v[32:35], v[24:27], v[64:79]
  ds_read_b128 v[28:31], v11 offset:0
  ds_read_b64_tr_b16 v[44:45], v16 offset:26624
  ds_read_b64_tr_b16 v[46:47], v16 offset:28160
  ds_read_b64_tr_b16 v[48:49], v16 offset:26752
  v_mfma_f32_32x32x16_bf16 v[80:95], v[24:27], v[36:39], v[80:95]
  ds_read_b64_tr_b16 v[50:51], v16 offset:28288
  ds_read_b64_tr_b16 v[52:53], v16 offset:26880
  ds_read_b64_tr_b16 v[54:55], v16 offset:28416
  v_mfma_f32_32x32x16_bf16 v[96:111], v[24:27], v[40:43], v[96:111]
  v_dot2c_f32_bf16 v236, 0x3f803f80, v32
  v_dot2c_f32_bf16 v237, 0x3f803f80, v36
  v_dot2c_f32_bf16 v238, 0x3f803f80, v40
  v_dot2c_f32_bf16 v116, 0x3f803f80, v33
  v_dot2c_f32_bf16 v117, 0x3f803f80, v37
  v_dot2c_f32_bf16 v118, 0x3f803f80, v41
  v_dot2c_f32_bf16 v236, 0x3f803f80, v34
  v_dot2c_f32_bf16 v237, 0x3f803f80, v38
  v_dot2c_f32_bf16 v238, 0x3f803f80, v42
  v_dot2c_f32_bf16 v116, 0x3f803f80, v35
  v_dot2c_f32_bf16 v117, 0x3f803f80, v39
  v_dot2c_f32_bf16 v118, 0x3f803f80, v43
  s_waitcnt lgkmcnt(0)
  s_barrier
  v_mfma_f32_32x32x16_bf16 v[64:79], v[44:47], v[28:31], v[64:79]
  ds_read_b128 v[24:27], v8 offset:32768
  ds_read_b64_tr_b16 v[32:33], v16 offset:40960
  ds_read_b64_tr_b16 v[34:35], v16 offset:42496
  ds_read_b64_tr_b16 v[36:37], v16 offset:41088
  v_mfma_f32_32x32x16_bf16 v[80:95], v[28:31], v[48:51], v[80:95]
  ds_read_b64_tr_b16 v[38:39], v16 offset:42624
  ds_read_b64_tr_b16 v[40:41], v16 offset:41216
  ds_read_b64_tr_b16 v[42:43], v16 offset:42752
  v_mfma_f32_32x32x16_bf16 v[96:111], v[28:31], v[52:55], v[96:111]
  v_dot2c_f32_bf16 v112, 0x3f803f80, v28
  v_dot2c_f32_bf16 v114, v28, v28
  v_dot2c_f32_bf16 v113, 0x3f803f80, v29
  v_dot2c_f32_bf16 v115, v29, v29
  v_dot2c_f32_bf16 v232, 0x3f803f80, v30
  v_dot2c_f32_bf16 v234, v30, v30
  v_dot2c_f32_bf16 v233, 0x3f803f80, v31
  v_dot2c_f32_bf16 v235, v31, v31
  s_waitcnt lgkmcnt(0)
  v_mfma_f32_32x32x16_bf16 v[64:79], v[32:35], v[24:27], v[64:79]
  ds_read_b128 v[28:31], v9 offset:32768
  ds_read_b64_tr_b16 v[44:45], v16 offset:47104
  ds_read_b64_tr_b16 v[46:47], v16 offset:48640
  ds_read_b64_tr_b16 v[48:49], v16 offset:47232
  v_mfma_f32_32x32x16_bf16 v[80:95], v[24:27], v[36:39], v[80:95]
  ds_read_b64_tr_b16 v[50:51], v16 offset:48768
  ds_read_b64_tr_b16 v[52:53], v16 offset:47360
  ds_read_b64_tr_b16 v[54:55], v16 offset:48896
  v_mfma_f32_32x32x16_bf16 v[96:111], v[24:27], v[40:43], v[96:111]
  v_dot2c_f32_bf16 v236, 0x3f803f80, v32
  v_dot2c_f32_bf16 v237, 0x3f803f80, v36
  v_dot2c_f32_bf16 v238, 0x3f803f80, v40
  v_dot2c_f32_bf16 v116, 0x3f803f80, v33
  v_dot2c_f32_bf16 v117, 0x3f803f80, v37
  v_dot2c_f32_bf16 v118, 0x3f803f80, v41
  v_dot2c_f32_bf16 v236, 0x3f803f80, v34
  v_dot2c_f32_bf16 v237, 0x3f803f80, v38
  v_dot2c_f32_bf16 v238, 0x3f803f80, v42
  v_dot2c_f32_bf16 v116, 0x3f803f80, v35
  v_dot2c_f32_bf16 v117, 0x3f803f80, v39
  v_dot2c_f32_bf16 v118, 0x3f803f80, v43
  s_waitcnt lgkmcnt(0)
  v_mfma_f32_32x32x16_bf16 v[64:79], v[44:47], v[28:31], v[64:79]
  ds_read_b128 v[24:27], v10 offset:32768
  ds_read_b64_tr_b16 v[32:33], v16 offset:53248
  ds_read_b64_tr_b16 v[34:35], v16 offset:54784
  ds_read_b64_tr_b16 v[36:37], v16 offset:53376
  v_mfma_f32_32x32x16_bf16 v[80:95], v[28:31], v[48:51], v[80:95]
  ds_read_b64_tr_b16 v[38:39], v16 offset:54912
  ds_read_b64_tr_b16 v[40:41], v16 offset:53504
  ds_read_b64_tr_b16 v[42:43], v16 offset:55040
  v_mfma_f32_32x32x16_bf16 v[96:111], v[28:31], v[52:55], v[96:111]
  v_dot2c_f32_bf16 v112, 0x3f803f80, v28
  v_dot2c_f32_bf16 v114, v28, v28
  v_dot2c_f32_bf16 v113, 0x3f803f80, v29
  v_dot2c_f32_bf16 v115, v29, v29
  v_dot2c_f32_bf16 v232, 0x3f803f80, v30
  v_dot2c_f32_bf16 v234, v30, v30
  v_dot2c_f32_bf16 v233, 0x3f803f80, v31
  v_dot2c_f32_bf16 v235, v31, v31
  s_waitcnt lgkmcnt(0)
  v_mfma_f32_32x32x16_bf16 v[64:79], v[32:35], v[24:27], v[64:79]
  ds_read_b128 v[28:31], v11 offset:32768
  ds_read_b64_tr_b16 v[44:45], v16 offset:59392
  ds_read_b64_tr_b16 v[46:47], v16 offset:60928
  ds_read_b64_tr_b16 v[48:49], v16 offset:59520
  v_mfma_f32_32x32x16_bf16 v[80:95], v[24:27], v[36:39], v[80:95]
  ds_read_b64_tr_b16 v[50:51], v16 offset:61056
  ds_read_b64_tr_b16 v[52:53], v16 offset:59648
  ds_read_b64_tr_b16 v[54:55], v16 offset:61184
  v_mfma_f32_32x32x16_bf16 v[96:111], v[24:27], v[40:43], v[96:111]
  v_dot2c_f32_bf16 v236, 0x3f803f80, v32
  v_dot2c_f32_bf16 v237, 0x3f803f80, v36
  v_dot2c_f32_bf16 v238, 0x3f803f80, v40
  v_dot2c_f32_bf16 v116, 0x3f803f80, v33
  v_dot2c_f32_bf16 v117, 0x3f803f80, v37
  v_dot2c_f32_bf16 v118, 0x3f803f80, v41
  v_dot2c_f32_bf16 v236, 0x3f803f80, v34
  v_dot2c_f32_bf16 v237, 0x3f803f80, v38
  v_dot2c_f32_bf16 v238, 0x3f803f80, v42
  v_dot2c_f32_bf16 v116, 0x3f803f80, v35
  v_dot2c_f32_bf16 v117, 0x3f803f80, v39
  v_dot2c_f32_bf16 v118, 0x3f803f80, v43
  s_waitcnt lgkmcnt(0)
  s_barrier
  v_mfma_f32_32x32x16_bf16 v[64:79], v[44:47], v[28:31], v[64:79]
  ds_read_b128 v[24:27], v12 offset:0
  ds_read_b64_tr_b16 v[32:33], v17 offset:8192
  ds_read_b64_tr_b16 v[34:35], v17 offset:9728
  ds_read_b64_tr_b16 v[36:37], v17 offset:8320
  v_mfma_f32_32x32x16_bf16 v[80:95], v[28:31], v[48:51], v[80:95]
  ds_read_b64_tr_b16 v[38:39], v17 offset:9856
  ds_read_b64_tr_b16 v[40:41], v17 offset:8448
  ds_read_b64_tr_b16 v[42:43], v17 offset:9984
  v_mfma_f32_32x32x16_bf16 v[96:111], v[28:31], v[52:55], v[96:111]
  v_dot2c_f32_bf16 v112, 0x3f803f80, v28
  v_dot2c_f32_bf16 v114, v28, v28
  v_dot2c_f32_bf16 v113, 0x3f803f80, v29
  v_dot2c_f32_bf16 v115, v29, v29
  v_dot2c_f32_bf16 v232, 0x3f803f80, v30
  v_dot2c_f32_bf16 v234, v30, v30
  v_dot2c_f32_bf16 v233, 0x3f803f80, v31
  v_dot2c_f32_bf16 v235, v31, v31
  s_waitcnt lgkmcnt(0)
  v_mfma_f32_32x32x16_bf16 v[64:79], v[32:35], v[24:27], v[64:79]
  ds_read_b128 v[28:31], v13 offset:0
  ds_read_b64_tr_b16 v[44:45], v17 offset:14336
  ds_read_b64_tr_b16 v[46:47], v17 offset:15872
  ds_read_b64_tr_b16 v[48:49], v17 offset:14464
  v_mfma_f32_32x32x16_bf16 v[80:95], v[24:27], v[36:39], v[80:95]
  ds_read_b64_tr_b16 v[50:51], v17 offset:16000
  ds_read_b64_tr_b16 v[52:53], v17 offset:14592
  ds_read_b64_tr_b16 v[54:55], v17 offset:16128
  v_mfma_f32_32x32x16_bf16 v[96:111], v[24:27], v[40:43], v[96:111]
  v_dot2c_f32_bf16 v236, 0x3f803f80, v32
  v_dot2c_f32_bf16 v237, 0x3f803f80, v36
  v_dot2c_f32_bf16 v238, 0x3f803f80, v40
  v_dot2c_f32_bf16 v116, 0x3f803f80, v33
  v_dot2c_f32_bf16 v117, 0x3f803f80, v37
  v_dot2c_f32_bf16 v118, 0x3f803f80, v41
  v_dot2c_f32_bf16 v236, 0x3f803f80, v34
  v_dot2c_f32_bf16 v237, 0x3f803f80, v38
  v_dot2c_f32_bf16 v238, 0x3f803f80, v42
  v_dot2c_f32_bf16 v116, 0x3f803f80, v35
  v_dot2c_f32_bf16 v117, 0x3f803f80, v39
  v_dot2c_f32_bf16 v118, 0x3f803f80, v43
  s_waitcnt lgkmcnt(0)
  v_mfma_f32_32x32x16_bf16 v[64:79], v[44:47], v[28:31], v[64:79]
  ds_read_b128 v[24:27], v14 offset:0
  ds_read_b64_tr_b16 v[32:33], v17 offset:20480
  ds_read_b64_tr_b16 v[34:35], v17 offset:22016
  ds_read_b64_tr_b16 v[36:37], v17 offset:20608
  v_mfma_f32_32x32x16_bf16 v[80:95], v[28:31], v[48:51], v[80:95]
  ds_read_b64_tr_b16 v[38:39], v17 offset:22144
  ds_read_b64_tr_b16 v[40:41], v17 offset:20736
  ds_read_b64_tr_b16 v[42:43], v17 offset:22272
  v_mfma_f32_32x32x16_bf16 v[96:111], v[28:31], v[52:55], v[96:111]
  v_dot2c_f32_bf16 v112, 0x3f803f80, v28
  v_dot2c_f32_bf16 v114, v28, v28
  v_dot2c_f32_bf16 v113, 0x3f803f80, v29
  v_dot2c_f32_bf16 v115, v29, v29
  v_dot2c_f32_bf16 v232, 0x3f803f80, v30
  v_dot2c_f32_bf16 v234, v30, v30
  v_dot2c_f32_bf16 v233, 0x3f803f80, v31
  v_dot2c_f32_bf16 v235, v31, v31
  s_waitcnt lgkmcnt(0)
  v_mfma_f32_32x32x16_bf16 v[64:79], v[32:35], v[24:27], v[64:79]
  ds_read_b128 v[28:31], v15 offset:0
  ds_read_b64_tr_b16 v[44:45], v17 offset:26624
  ds_read_b64_tr_b16 v[46:47], v17 offset:28160
  ds_read_b64_tr_b16 v[48:49], v17 offset:26752
  v_mfma_f32_32x32x16_bf16 v[80:95], v[24:27], v[36:39], v[80:95]
  ds_read_b64_tr_b16 v[50:51], v17 offset:28288
  ds_read_b64_tr_b16 v[52:53], v17 offset:26880
  ds_read_b64_tr_b16 v[54:55], v17 offset:28416
  v_mfma_f32_32x32x16_bf16 v[96:111], v[24:27], v[40:43], v[96:111]
  v_dot2c_f32_bf16 v236, 0x3f803f80, v32
  v_dot2c_f32_bf16 v237, 0x3f803f80, v36
  v_dot2c_f32_bf16 v238, 0x3f803f80, v40
  v_dot2c_f32_bf16 v116, 0x3f803f80, v33
  v_dot2c_f32_bf16 v117, 0x3f803f80, v37
  v_dot2c_f32_bf16 v118, 0x3f803f80, v41
  v_dot2c_f32_bf16 v236, 0x3f803f80, v34
  v_dot2c_f32_bf16 v237, 0x3f803f80, v38
  v_dot2c_f32_bf16 v238, 0x3f803f80, v42
  v_dot2c_f32_bf16 v116, 0x3f803f80, v35
  v_dot2c_f32_bf16 v117, 0x3f803f80, v39
  v_dot2c_f32_bf16 v118, 0x3f803f80, v43
  s_waitcnt lgkmcnt(0)
  s_barrier
  v_mfma_f32_32x32x16_bf16 v[64:79], v[44:47], v[28:31], v[64:79]
  ds_read_b128 v[24:27], v12 offset:32768
  ds_read_b64_tr_b16 v[32:33], v17 offset:40960
  ds_read_b64_tr_b16 v[34:35], v17 offset:42496
  ds_read_b64_tr_b16 v[36:37], v17 offset:41088
  v_mfma_f32_32x32x16_bf16 v[80:95], v[28:31], v[48:51], v[80:95]
  ds_read_b64_tr_b16 v[38:39], v17 offset:42624
  ds_read_b64_tr_b16 v[40:41], v17 offset:41216
  ds_read_b64_tr_b16 v[42:43], v17 offset:42752
  v_mfma_f32_32x32x16_bf16 v[96:111], v[28:31], v[52:55], v[96:111]
  v_dot2c_f32_bf16 v112, 0x3f803f80, v28
  v_dot2c_f32_bf16 v114, v28, v28
  v_dot2c_f32_bf16 v113, 0x3f803f80, v29
  v_dot2c_f32_bf16 v115, v29, v29
  v_dot2c_f32_bf16 v232, 0x3f803f80, v30
  v_dot2c_f32_bf16 v234, v30, v30
  v_dot2c_f32_bf16 v233, 0x3f803f80, v31
  v_dot2c_f32_bf16 v235, v31, v31
  s_waitcnt lgkmcnt(0)
  v_mfma_f32_32x32x16_bf16 v[64:79], v[32:35], v[24:27], v[64:79]
  ds_read_b128 v[28:31], v13 offset:32768
  ds_read_b64_tr_b16 v[44:45], v17 offset:47104
  ds_read_b64_tr_b16 v[46:47], v17 offset:48640
  ds_read_b64_tr_b16 v[48:49], v17 offset:47232
  v_mfma_f32_32x32x16_bf16 v[80:95], v[24:27], v[36:39], v[80:95]
  ds_read_b64_tr_b16 v[50:51], v17 offset:48768
  ds_read_b64_tr_b16 v[52:53], v17 offset:47360
  ds_read_b64_tr_b16 v[54:55], v17 offset:48896
  v_mfma_f32_32x32x16_bf16 v[96:111], v[24:27], v[40:43], v[96:111]
  v_dot2c_f32_bf16 v236, 0x3f803f80, v32
  v_dot2c_f32_bf16 v237, 0x3f803f80, v36
  v_dot2c_f32_bf16 v238, 0x3f803f80, v40
  v_dot2c_f32_bf16 v116, 0x3f803f80, v33
  v_dot2c_f32_bf16 v117, 0x3f803f80, v37
  v_dot2c_f32_bf16 v118, 0x3f803f80, v41
  v_dot2c_f32_bf16 v236, 0x3f803f80, v34
  v_dot2c_f32_bf16 v237, 0x3f803f80, v38
  v_dot2c_f32_bf16 v238, 0x3f803f80, v42
  v_dot2c_f32_bf16 v116, 0x3f803f80, v35
  v_dot2c_f32_bf16 v117, 0x3f803f80, v39
  v_dot2c_f32_bf16 v118, 0x3f803f80, v43
  s_waitcnt lgkmcnt(0)
  v_mfma_f32_32x32x16_bf16 v[64:79], v[44:47], v[28:31], v[64:79]
  ds_read_b128 v[24:27], v14 offset:32768
  ds_read_b64_tr_b16 v[32:33], v17 offset:53248
  ds_read_b64_tr_b16 v[34:35], v17 offset:54784
  ds_read_b64_tr_b16 v[36:37], v17 offset:53376
  v_mfma_f32_32x32x16_bf16 v[80:95], v[28:31], v[48:51], v[80:95]
  ds_read_b64_tr_b16 v[38:39], v17 offset:54912
  ds_read_b64_tr_b16 v[40:41], v17 offset:53504
  ds_read_b64_tr_b16 v[42:43], v17 offset:55040
  v_mfma_f32_32x32x16_bf16 v[96:111], v[28:31], v[52:55], v[96:111]
  v_dot2c_f32_bf16 v112, 0x3f803f80, v28
  v_dot2c_f32_bf16 v114, v28, v28
  v_dot2c_f32_bf16 v113, 0x3f803f80, v29
  v_dot2c_f32_bf16 v115, v29, v29
  v_dot2c_f32_bf16 v232, 0x3f803f80, v30
  v_dot2c_f32_bf16 v234, v30, v30
  v_dot2c_f32_bf16 v233, 0x3f803f80, v31
  v_dot2c_f32_bf16 v235, v31, v31
  s_waitcnt lgkmcnt(0)
  v_mfma_f32_32x32x16_bf16 v[64:79], v[32:35], v[24:27], v[64:79]
  ds_read_b128 v[28:31], v15 offset:32768
  ds_read_b64_tr_b16 v[44:45], v17 offset:59392
  ds_read_b64_tr_b16 v[46:47], v17 offset:60928
  ds_read_b64_tr_b16 v[48:49], v17 offset:59520
  v_mfma_f32_32x32x16_bf16 v[80:95], v[24:27], v[36:39], v[80:95]
  ds_read_b64_tr_b16 v[50:51], v17 offset:61056
  ds_read_b64_tr_b16 v[52:53], v17 offset:59648
  ds_read_b64_tr_b16 v[54:55], v17 offset:61184
  v_mfma_f32_32x32x16_bf16 v[96:111], v[24:27], v[40:43], v[96:111]
  v_dot2c_f32_bf16 v236, 0x3f803f80, v32
  v_dot2c_f32_bf16 v237, 0x3f803f80, v36
  v_dot2c_f32_bf16 v238, 0x3f803f80, v40
  v_dot2c_f32_bf16 v116, 0x3f803f80, v33
  v_dot2c_f32_bf16 v117, 0x3f803f80, v37
  v_dot2c_f32_bf16 v118, 0x3f803f80, v41
  v_dot2c_f32_bf16 v236, 0x3f803f80, v34
  v_dot2c_f32_bf16 v237, 0x3f803f80, v38
  v_dot2c_f32_bf16 v238, 0x3f803f80, v42
  v_dot2c_f32_bf16 v116, 0x3f803f80, v35
  v_dot2c_f32_bf16 v117, 0x3f803f80, v39
  v_dot2c_f32_bf16 v118, 0x3f803f80, v43
  s_waitcnt lgkmcnt(0)
  s_barrier
  v_mfma_f32_32x32x16_bf16 v[64:79], v[44:47], v[28:31], v[64:79]
  ds_read_b128 v[24:27], v8 offset:0
  ds_read_b64_tr_b16 v[32:33], v16 offset:8192
  ds_read_b64_tr_b16 v[34:35], v16 offset:9728
  ds_read_b64_tr_b16 v[36:37], v16 offset:8320
  v_mfma_f32_32x32x16_bf16 v[80:95], v[28:31], v[48:51], v[80:95]
  ds_read_b64_tr_b16 v[38:39], v16 offset:9856
  ds_read_b64_tr_b16 v[40:41], v16 offset:8448
  ds_read_b64_tr_b16 v[42:43], v16 offset:9984
  v_mfma_f32_32x32x16_bf16 v[96:111], v[28:31], v[52:55], v[96:111]
  v_dot2c_f32_bf16 v112, 0x3f803f80, v28
  v_dot2c_f32_bf16 v114, v28, v28
  v_dot2c_f32_bf16 v113, 0x3f803f80, v29
  v_dot2c_f32_bf16 v115, v29, v29
  v_dot2c_f32_bf16 v232, 0x3f803f80, v30
  v_dot2c_f32_bf16 v234, v30, v30
  v_dot2c_f32_bf16 v233, 0x3f803f80, v31
  v_dot2c_f32_bf16 v235, v31, v31
  s_waitcnt lgkmcnt(0)
  v_mfma_f32_32x32x16_bf16 v[64:79], v[32:35], v[24:27], v[64:79]
  ds_read_b128 v[28:31], v9 offset:0
  ds_read_b64_tr_b16 v[44:45], v16 offset:14336
  ds_read_b64_tr_b16 v[46:47], v16 offset:15872
  ds_read_b64_tr_b16 v[48:49], v16 offset:14464
  v_mfma_f32_32x32x16_bf16 v[80:95], v[24:27], v[36:39], v[80:95]
  ds_read_b64_tr_b16 v[50:51], v16 offset:16000
  ds_read_b64_tr_b16 v[52:53], v16 offset:14592
  ds_read_b64_tr_b16 v[54:55], v16 offset:16128
  v_mfma_f32_32x32x16_bf16 v[96:111], v[24:27], v[40:43], v[96:111]
  v_dot2c_f32_bf16 v236, 0x3f803f80, v32
  v_dot2c_f32_bf16 v237, 0x3f803f80, v36
  v_dot2c_f32_bf16 v238, 0x3f803f80, v40
  v_dot2c_f32_bf16 v116, 0x3f803f80, v33
  v_dot2c_f32_bf16 v117, 0x3f803f80, v37
  v_dot2c_f32_bf16 v118, 0x3f803f80, v41
  v_dot2c_f32_bf16 v236, 0x3f803f80, v34
  v_dot2c_f32_bf16 v237, 0x3f803f80, v38
  v_dot2c_f32_bf16 v238, 0x3f803f80, v42
  v_dot2c_f32_bf16 v116, 0x3f803f80, v35
  v_dot2c_f32_bf16 v117, 0x3f803f80, v39
  v_dot2c_f32_bf16 v118, 0x3f803f80, v43
  s_waitcnt lgkmcnt(0)
  v_mfma_f32_32x32x16_bf16 v[64:79], v[44:47], v[28:31], v[64:79]
  ds_read_b128 v[24:27], v10 offset:0
  ds_read_b64_tr_b16 v[32:33], v16 offset:20480
  ds_read_b64_tr_b16 v[34:35], v16 offset:22016
  ds_read_b64_tr_b16 v[36:37], v16 offset:20608
  v_mfma_f32_32x32x16_bf16 v[80:95], v[28:31], v[48:51], v[80:95]
  ds_read_b64_tr_b16 v[38:39], v16 offset:22144
  ds_read_b64_tr_b16 v[40:41], v16 offset:20736
  ds_read_b64_tr_b16 v[42:43], v16 offset:22272
  v_mfma_f32_32x32x16_bf16 v[96:111], v[28:31], v[52:55], v[96:111]
  v_dot2c_f32_bf16 v112, 0x3f803f80, v28
  v_dot2c_f32_bf16 v114, v28, v28
  v_dot2c_f32_bf16 v113, 0x3f803f80, v29
  v_dot2c_f32_bf16 v115, v29, v29
  v_dot2c_f32_bf16 v232, 0x3f803f80, v30
  v_dot2c_f32_bf16 v234, v30, v30
  v_dot2c_f32_bf16 v233, 0x3f803f80, v31
  v_dot2c_f32_bf16 v235, v31, v31
  s_waitcnt lgkmcnt(0)
  v_mfma_f32_32x32x16_bf16 v[64:79], v[32:35], v[24:27], v[64:79]
  ds_read_b128 v[28:31], v11 offset:0
  ds_read_b64_tr_b16 v[44:45], v16 offset:26624
  ds_read_b64_tr_b16 v[46:47], v16 offset:28160
  ds_read_b64_tr_b16 v[48:49], v16 offset:26752
  v_mfma_f32_32x32x16_bf16 v[80:95], v[24:27], v[36:39], v[80:95]
  ds_read_b64_tr_b16 v[50:51], v16 offset:28288
  ds_read_b64_tr_b16 v[52:53], v16 offset:26880
  ds_read_b64_tr_b16 v[54:55], v16 offset:28416
  ds_read_b128 v[124:127], v119 offset:144
  v_mfma_f32_32x32x16_bf16 v[96:111], v[24:27], v[40:43], v[96:111]
  v_dot2c_f32_bf16 v236, 0x3f803f80, v32
  v_dot2c_f32_bf16 v237, 0x3f803f80, v36
  v_dot2c_f32_bf16 v238, 0x3f803f80, v40
  v_dot2c_f32_bf16 v116, 0x3f803f80, v33
  v_dot2c_f32_bf16 v117, 0x3f803f80, v37
  v_dot2c_f32_bf16 v118, 0x3f803f80, v41
  v_dot2c_f32_bf16 v236, 0x3f803f80, v34
  v_dot2c_f32_bf16 v237, 0x3f803f80, v38
  v_dot2c_f32_bf16 v238, 0x3f803f80, v42
  v_dot2c_f32_bf16 v116, 0x3f803f80, v35
  v_dot2c_f32_bf16 v117, 0x3f803f80, v39
  v_dot2c_f32_bf16 v118, 0x3f803f80, v43
  s_waitcnt lgkmcnt(0)
  v_and_b32 v124, v124, v125
  v_and_b32 v126, v126, v127
  v_and_b32 v124, v124, v126
  s_nop 0
  v_readfirstlane_b32 s14, v124
  s_nop 3
  s_cmp_lg_u32 s14, 0
  s_cbranch_scc1 k1_lf1_4_ok
  v_mov_b32 v18, 159888
k1_lf1_4:
  ds_read_b128 v[124:127], v18
  s_waitcnt lgkmcnt(0)
  v_and_b32 v124, v124, v125
  v_and_b32 v126, v126, v127
  v_and_b32 v124, v124, v126
  s_nop 0
  v_readfirstlane_b32 s14, v124
  s_nop 3
  s_cmp_eq_u32 s14, 0
  s_cbranch_scc1 k1_lf1_4
k1_lf1_4_ok:
  v_mfma_f32_32x32x16_bf16 v[64:79], v[44:47], v[28:31], v[64:79]
  ds_read_b128 v[24:27], v8 offset:32768
  ds_read_b64_tr_b16 v[32:33], v16 offset:40960
  ds_read_b64_tr_b16 v[34:35], v16 offset:42496
  ds_read_b64_tr_b16 v[36:37], v16 offset:41088
  v_mfma_f32_32x32x16_bf16 v[80:95], v[28:31], v[48:51], v[80:95]
  ds_read_b64_tr_b16 v[38:39], v16 offset:42624
  ds_read_b64_tr_b16 v[40:41], v16 offset:41216
  ds_read_b64_tr_b16 v[42:43], v16 offset:42752
  v_mfma_f32_32x32x16_bf16 v[96:111], v[28:31], v[52:55], v[96:111]
  v_dot2c_f32_bf16 v112, 0x3f803f80, v28
  v_dot2c_f32_bf16 v114, v28, v28
  v_dot2c_f32_bf16 v113, 0x3f803f80, v29
  v_dot2c_f32_bf16 v115, v29, v29
  v_dot2c_f32_bf16 v232, 0x3f803f80, v30
  v_dot2c_f32_bf16 v234, v30, v30
  v_dot2c_f32_bf16 v233, 0x3f803f80, v31
  v_dot2c_f32_bf16 v235, v31, v31
  s_waitcnt lgkmcnt(0)
  v_mfma_f32_32x32x16_bf16 v[64:79], v[32:35], v[24:27], v[64:79]
  ds_read_b128 v[28:31], v9 offset:32768
  ds_read_b64_tr_b16 v[44:45], v16 offset:47104
  ds_read_b64_tr_b16 v[46:47], v16 offset:48640
  ds_read_b64_tr_b16 v[48:49], v16 offset:47232
  v_mfma_f32_32x32x16_bf16 v[80:95], v[24:27], v[36:39], v[80:95]
  ds_read_b64_tr_b16 v[50:51], v16 offset:48768
  ds_read_b64_tr_b16 v[52:53], v16 offset:47360
  ds_read_b64_tr_b16 v[54:55], v16 offset:48896
  v_mfma_f32_32x32x16_bf16 v[96:111], v[24:27], v[40:43], v[96:111]
  v_dot2c_f32_bf16 v236, 0x3f803f80, v32
  v_dot2c_f32_bf16 v237, 0x3f803f80, v36
  v_dot2c_f32_bf16 v238, 0x3f803f80, v40
  v_dot2c_f32_bf16 v116, 0x3f803f80, v33
  v_dot2c_f32_bf16 v117, 0x3f803f80, v37
  v_dot2c_f32_bf16 v118, 0x3f803f80, v41
  v_dot2c_f32_bf16 v236, 0x3f803f80, v34
  v_dot2c_f32_bf16 v237, 0x3f803f80, v38
  v_dot2c_f32_bf16 v238, 0x3f803f80, v42
  v_dot2c_f32_bf16 v116, 0x3f803f80, v35
  v_dot2c_f32_bf16 v117, 0x3f803f80, v39
  v_dot2c_f32_bf16 v118, 0x3f803f80, v43
  s_waitcnt lgkmcnt(0)
  v_mfma_f32_32x32x16_bf16 v[64:79], v[44:47], v[28:31], v[64:79]
  ds_read_b128 v[24:27], v10 offset:32768
  ds_read_b64_tr_b16 v[32:33], v16 offset:53248
  ds_read_b64_tr_b16 v[34:35], v16 offset:54784
  ds_read_b64_tr_b16 v[36:37], v16 offset:53376
  v_mfma_f32_32x32x16_bf16 v[80:95], v[28:31], v[48:51], v[80:95]
  ds_read_b64_tr_b16 v[38:39], v16 offset:54912
  ds_read_b64_tr_b16 v[40:41], v16 offset:53504
  ds_read_b64_tr_b16 v[42:43], v16 offset:55040
  v_mfma_f32_32x32x16_bf16 v[96:111], v[28:31], v[52:55], v[96:111]
  v_dot2c_f32_bf16 v112, 0x3f803f80, v28
  v_dot2c_f32_bf16 v114, v28, v28
  v_dot2c_f32_bf16 v113, 0x3f803f80, v29
  v_dot2c_f32_bf16 v115, v29, v29
  v_dot2c_f32_bf16 v232, 0x3f803f80, v30
  v_dot2c_f32_bf16 v234, v30, v30
  v_dot2c_f32_bf16 v233, 0x3f803f80, v31
  v_dot2c_f32_bf16 v235, v31, v31
  s_waitcnt lgkmcnt(0)
  v_mfma_f32_32x32x16_bf16 v[64:79], v[32:35], v[24:27], v[64:79]
  ds_read_b128 v[28:31], v11 offset:32768
  ds_read_b64_tr_b16 v[44:45], v16 offset:59392
  ds_read_b64_tr_b16 v[46:47], v16 offset:60928
  ds_read_b64_tr_b16 v[48:49], v16 offset:59520
  v_mfma_f32_32x32x16_bf16 v[80:95], v[24:27], v[36:39], v[80:95]
  ds_read_b64_tr_b16 v[50:51], v16 offset:61056
  ds_read_b64_tr_b16 v[52:53], v16 offset:59648
  ds_read_b64_tr_b16 v[54:55], v16 offset:61184
  ds_read_b128 v[124:127], v119 offset:160
  v_mfma_f32_32x32x16_bf16 v[96:111], v[24:27], v[40:43], v[96:111]
  v_dot2c_f32_bf16 v236, 0x3f803f80, v32
  v_dot2c_f32_bf16 v237, 0x3f803f80, v36
  v_dot2c_f32_bf16 v238, 0x3f803f80, v40
  v_dot2c_f32_bf16 v116, 0x3f803f80, v33
  v_dot2c_f32_bf16 v117, 0x3f803f80, v37
  v_dot2c_f32_bf16 v118, 0x3f803f80, v41
  v_dot2c_f32_bf16 v236, 0x3f803f80, v34
  v_dot2c_f32_bf16 v237, 0x3f803f80, v38
  v_dot2c_f32_bf16 v238, 0x3f803f80, v42
  v_dot2c_f32_bf16 v116, 0x3f803f80, v35
  v_dot2c_f32_bf16 v117, 0x3f803f80, v39
  v_dot2c_f32_bf16 v118, 0x3f803f80, v43
  s_waitcnt lgkmcnt(0)
  v_and_b32 v124, v124, v125
  v_and_b32 v126, v126, v127
  v_and_b32 v124, v124, v126
  s_nop 0
  v_readfirstlane_b32 s14, v124
  s_nop 3
  s_cmp_lg_u32 s14, 0
  s_cbranch_scc1 k1_lf1_5_ok
  v_mov_b32 v18, 159904
k1_lf1_5:
  ds_read_b128 v[124:127], v18
  s_waitcnt lgkmcnt(0)
  v_and_b32 v124, v124, v125
  v_and_b32 v126, v126, v127
  v_and_b32 v124, v124, v126
  s_nop 0
  v_readfirstlane_b32 s14, v124
  s_nop 3
  s_cmp_eq_u32 s14, 0
  s_cbranch_scc1 k1_lf1_5
k1_lf1_5_ok:
  v_mfma_f32_32x32x16_bf16 v[64:79], v[44:47], v[28:31], v[64:79]
  ds_read_b128 v[24:27], v12 offset:0
  ds_read_b64_tr_b16 v[32:33], v17 offset:8192
  ds_read_b64_tr_b16 v[34:35], v17 offset:9728
  ds_read_b64_tr_b16 v[36:37], v17 offset:8320
  v_mfma_f32_32x32x16_bf16 v[80:95], v[28:31], v[48:51], v[80:95]
  ds_read_b64_tr_b16 v[38:39], v17 offset:9856
  ds_read_b64_tr_b16 v[40:41], v17 offset:8448
  ds_read_b64_tr_b16 v[42:43], v17 offset:9984
  v_mfma_f32_32x32x16_bf16 v[96:111], v[28:31], v[52:55], v[96:111]
  v_dot2c_f32_bf16 v112, 0x3f803f80, v28
  v_dot2c_f32_bf16 v114, v28, v28
  v_dot2c_f32_bf16 v113, 0x3f803f80, v29
  v_dot2c_f32_bf16 v115, v29, v29
  v_dot2c_f32_bf16 v232, 0x3f803f80, v30
  v_dot2c_f32_bf16 v234, v30, v30
  v_dot2c_f32_bf16 v233, 0x3f803f80, v31
  v_dot2c_f32_bf16 v235, v31, v31
  s_waitcnt lgkmcnt(0)
  s_lshl_b32 s14, s5, 2
  v_mov_b32 v120, s14
  buffer_load_dword v121, v120, s[48:51], 0 offen sc1
  v_mfma_f32_32x32x16_bf16 v[64:79], v[32:35], v[24:27], v[64:79]
  ds_read_b128 v[28:31], v13 offset:0
  ds_read_b64_tr_b16 v[44:45], v17 offset:14336
  ds_read_b64_tr_b16 v[46:47], v17 offset:15872
  ds_read_b64_tr_b16 v[48:49], v17 offset:14464
  v_mfma_f32_32x32x16_bf16 v[80:95], v[24:27], v[36:39], v[80:95]
  ds_read_b64_tr_b16 v[50:51], v17 offset:16000
  ds_read_b64_tr_b16 v[52:53], v17 offset:14592
  ds_read_b64_tr_b16 v[54:55], v17 offset:16128
  v_mfma_f32_32x32x16_bf16 v[96:111], v[24:27], v[40:43], v[96:111]
  v_dot2c_f32_bf16 v236, 0x3f803f80, v32
  v_dot2c_f32_bf16 v237, 0x3f803f80, v36
  v_dot2c_f32_bf16 v238, 0x3f803f80, v40
  v_dot2c_f32_bf16 v116, 0x3f803f80, v33
  v_dot2c_f32_bf16 v117, 0x3f803f80, v37
  v_dot2c_f32_bf16 v118, 0x3f803f80, v41
  v_dot2c_f32_bf16 v236, 0x3f803f80, v34
  v_dot2c_f32_bf16 v237, 0x3f803f80, v38
  v_dot2c_f32_bf16 v238, 0x3f803f80, v42
  v_dot2c_f32_bf16 v116, 0x3f803f80, v35
  v_dot2c_f32_bf16 v117, 0x3f803f80, v39
  v_dot2c_f32_bf16 v118, 0x3f803f80, v43
  s_waitcnt lgkmcnt(0)
  v_mfma_f32_32x32x16_bf16 v[64:79], v[44:47], v[28:31], v[64:79]
  ds_read_b128 v[24:27], v14 offset:0
  ds_read_b64_tr_b16 v[32:33], v17 offset:20480
  ds_read_b64_tr_b16 v[34:35], v17 offset:22016
  ds_read_b64_tr_b16 v[36:37], v17 offset:20608
  v_mfma_f32_32x32x16_bf16 v[80:95], v[28:31], v[48:51], v[80:95]
  ds_read_b64_tr_b16 v[38:39], v17 offset:22144
  ds_read_b64_tr_b16 v[40:41], v17 offset:20736
  ds_read_b64_tr_b16 v[42:43], v17 offset:22272
  v_mfma_f32_32x32x16_bf16 v[96:111], v[28:31], v[52:55], v[96:111]
  v_dot2c_f32_bf16 v112, 0x3f803f80, v28
  v_dot2c_f32_bf16 v114, v28, v28
  v_dot2c_f32_bf16 v113, 0x3f803f80, v29
  v_dot2c_f32_bf16 v115, v29, v29
  v_dot2c_f32_bf16 v232, 0x3f803f80, v30
  v_dot2c_f32_bf16 v234, v30, v30
  v_dot2c_f32_bf16 v233, 0x3f803f80, v31
  v_dot2c_f32_bf16 v235, v31, v31
  s_waitcnt lgkmcnt(0)
  v_mfma_f32_32x32x16_bf16 v[64:79], v[32:35], v[24:27], v[64:79]
  ds_read_b128 v[28:31], v15 offset:0
  ds_read_b64_tr_b16 v[44:45], v17 offset:26624
  ds_read_b64_tr_b16 v[46:47], v17 offset:28160
  ds_read_b64_tr_b16 v[48:49], v17 offset:26752
  v_mfma_f32_32x32x16_bf16 v[80:95], v[24:27], v[36:39], v[80:95]
  ds_read_b64_tr_b16 v[50:51], v17 offset:28288
  ds_read_b64_tr_b16 v[52:53], v17 offset:26880
  ds_read_b64_tr_b16 v[54:55], v17 offset:28416
  ds_read_b128 v[124:127], v119 offset:176
  v_mfma_f32_32x32x16_bf16 v[96:111], v[24:27], v[40:43], v[96:111]
  v_dot2c_f32_bf16 v236, 0x3f803f80, v32
  v_dot2c_f32_bf16 v237, 0x3f803f80, v36
  v_dot2c_f32_bf16 v238, 0x3f803f80, v40
  v_dot2c_f32_bf16 v116, 0x3f803f80, v33
  v_dot2c_f32_bf16 v117, 0x3f803f80, v37
  v_dot2c_f32_bf16 v118, 0x3f803f80, v41
  v_dot2c_f32_bf16 v236, 0x3f803f80, v34
  v_dot2c_f32_bf16 v237, 0x3f803f80, v38
  v_dot2c_f32_bf16 v238, 0x3f803f80, v42
  v_dot2c_f32_bf16 v116, 0x3f803f80, v35
  v_dot2c_f32_bf16 v117, 0x3f803f80, v39
  v_dot2c_f32_bf16 v118, 0x3f803f80, v43
  s_waitcnt lgkmcnt(0)
  v_and_b32 v124, v124, v125
  v_and_b32 v126, v126, v127
  v_and_b32 v124, v124, v126
  s_nop 0
  v_readfirstlane_b32 s14, v124
  s_nop 3
  s_cmp_lg_u32 s14, 0
  s_cbranch_scc1 k1_lf1_6_ok
  v_mov_b32 v18, 159920
k1_lf1_6:
  ds_read_b128 v[124:127], v18
  s_waitcnt lgkmcnt(0)
  v_and_b32 v124, v124, v125
  v_and_b32 v126, v126, v127
  v_and_b32 v124, v124, v126
  s_nop 0
  v_readfirstlane_b32 s14, v124
  s_nop 3
  s_cmp_eq_u32 s14, 0
  s_cbranch_scc1 k1_lf1_6
k1_lf1_6_ok:
  v_mfma_f32_32x32x16_bf16 v[64:79], v[44:47], v[28:31], v[64:79]
  ds_read_b128 v[24:27], v12 offset:32768
  ds_read_b64_tr_b16 v[32:33], v17 offset:40960
  ds_read_b64_tr_b16 v[34:35], v17 offset:42496
  ds_read_b64_tr_b16 v[36:37], v17 offset:41088
  v_mfma_f32_32x32x16_bf16 v[80:95], v[28:31], v[48:51], v[80:95]
  ds_read_b64_tr_b16 v[38:39], v17 offset:42624
  ds_read_b64_tr_b16 v[40:41], v17 offset:41216
  ds_read_b64_tr_b16 v[42:43], v17 offset:42752
  v_mfma_f32_32x32x16_bf16 v[96:111], v[28:31], v[52:55], v[96:111]
  v_dot2c_f32_bf16 v112, 0x3f803f80, v28
  v_dot2c_f32_bf16 v114, v28, v28
  v_dot2c_f32_bf16 v113, 0x3f803f80, v29
  v_dot2c_f32_bf16 v115, v29, v29
  v_dot2c_f32_bf16 v232, 0x3f803f80, v30
  v_dot2c_f32_bf16 v234, v30, v30
  v_dot2c_f32_bf16 v233, 0x3f803f80, v31
  v_dot2c_f32_bf16 v235, v31, v31
  s_waitcnt lgkmcnt(0)
  v_mov_b32 v18, 159748
  v_mov_b32 v123, 1
  ds_write_b32 v18, v123
  v_mfma_f32_32x32x16_bf16 v[64:79], v[32:35], v[24:27], v[64:79]
  ds_read_b128 v[28:31], v13 offset:32768
  ds_read_b64_tr_b16 v[44:45], v17 offset:47104
  ds_read_b64_tr_b16 v[46:47], v17 offset:48640
  ds_read_b64_tr_b16 v[48:49], v17 offset:47232
  v_mfma_f32_32x32x16_bf16 v[80:95], v[24:27], v[36:39], v[80:95]
  ds_read_b64_tr_b16 v[50:51], v17 offset:48768
  ds_read_b64_tr_b16 v[52:53], v17 offset:47360
  ds_read_b64_tr_b16 v[54:55], v17 offset:48896
  v_mfma_f32_32x32x16_bf16 v[96:111], v[24:27], v[40:43], v[96:111]
  v_dot2c_f32_bf16 v236, 0x3f803f80, v32
  v_dot2c_f32_bf16 v237, 0x3f803f80, v36
  v_dot2c_f32_bf16 v238, 0x3f803f80, v40
  v_dot2c_f32_bf16 v116, 0x3f803f80, v33
  v_dot2c_f32_bf16 v117, 0x3f803f80, v37
  v_dot2c_f32_bf16 v118, 0x3f803f80, v41
  v_dot2c_f32_bf16 v236, 0x3f803f80, v34
  v_dot2c_f32_bf16 v237, 0x3f803f80, v38
  v_dot2c_f32_bf16 v238, 0x3f803f80, v42
  v_dot2c_f32_bf16 v116, 0x3f803f80, v35
  v_dot2c_f32_bf16 v117, 0x3f803f80, v39
  v_dot2c_f32_bf16 v118, 0x3f803f80, v43
  s_waitcnt lgkmcnt(0)
  v_mfma_f32_32x32x16_bf16 v[64:79], v[44:47], v[28:31], v[64:79]
  ds_read_b128 v[24:27], v14 offset:32768
  ds_read_b64_tr_b16 v[32:33], v17 offset:53248
  ds_read_b64_tr_b16 v[34:35], v17 offset:54784
  ds_read_b64_tr_b16 v[36:37], v17 offset:53376
  v_mfma_f32_32x32x16_bf16 v[80:95], v[28:31], v[48:51], v[80:95]
  ds_read_b64_tr_b16 v[38:39], v17 offset:54912
  ds_read_b64_tr_b16 v[40:41], v17 offset:53504
  ds_read_b64_tr_b16 v[42:43], v17 offset:55040
  v_mfma_f32_32x32x16_bf16 v[96:111], v[28:31], v[52:55], v[96:111]
  v_dot2c_f32_bf16 v112, 0x3f803f80, v28
  v_dot2c_f32_bf16 v114, v28, v28
  v_dot2c_f32_bf16 v113, 0x3f803f80, v29
  v_dot2c_f32_bf16 v115, v29, v29
  v_dot2c_f32_bf16 v232, 0x3f803f80, v30
  v_dot2c_f32_bf16 v234, v30, v30
  v_dot2c_f32_bf16 v233, 0x3f803f80, v31
  v_dot2c_f32_bf16 v235, v31, v31
  s_waitcnt lgkmcnt(0)
  v_mfma_f32_32x32x16_bf16 v[64:79], v[32:35], v[24:27], v[64:79]
  ds_read_b128 v[28:31], v15 offset:32768
  ds_read_b64_tr_b16 v[44:45], v17 offset:59392
  ds_read_b64_tr_b16 v[46:47], v17 offset:60928
  ds_read_b64_tr_b16 v[48:49], v17 offset:59520
  v_mfma_f32_32x32x16_bf16 v[80:95], v[24:27], v[36:39], v[80:95]
  ds_read_b64_tr_b16 v[50:51], v17 offset:61056
  ds_read_b64_tr_b16 v[52:53], v17 offset:59648
  ds_read_b64_tr_b16 v[54:55], v17 offset:61184
  v_mfma_f32_32x32x16_bf16 v[96:111], v[24:27], v[40:43], v[96:111]
  v_dot2c_f32_bf16 v236, 0x3f803f80, v32
  v_dot2c_f32_bf16 v237, 0x3f803f80, v36
  v_dot2c_f32_bf16 v238, 0x3f803f80, v40
  v_dot2c_f32_bf16 v116, 0x3f803f80, v33
  v_dot2c_f32_bf16 v117, 0x3f803f80, v37
  v_dot2c_f32_bf16 v118, 0x3f803f80, v41
  v_dot2c_f32_bf16 v236, 0x3f803f80, v34
  v_dot2c_f32_bf16 v237, 0x3f803f80, v38
  v_dot2c_f32_bf16 v238, 0x3f803f80, v42
  v_dot2c_f32_bf16 v116, 0x3f803f80, v35
  v_dot2c_f32_bf16 v117, 0x3f803f80, v39
  v_dot2c_f32_bf16 v118, 0x3f803f80, v43
  s_waitcnt lgkmcnt(0)
  v_mfma_f32_32x32x16_bf16 v[64:79], v[44:47], v[28:31], v[64:79]
  v_mfma_f32_32x32x16_bf16 v[80:95], v[28:31], v[48:51], v[80:95]
  v_mfma_f32_32x32x16_bf16 v[96:111], v[28:31], v[52:55], v[96:111]
  v_dot2c_f32_bf16 v112, 0x3f803f80, v28
  v_dot2c_f32_bf16 v114, v28, v28
  v_dot2c_f32_bf16 v113, 0x3f803f80, v29
  v_dot2c_f32_bf16 v115, v29, v29
  v_dot2c_f32_bf16 v232, 0x3f803f80, v30
  v_dot2c_f32_bf16 v234, v30, v30
  v_dot2c_f32_bf16 v233, 0x3f803f80, v31
  v_dot2c_f32_bf16 v235, v31, v31
  s_waitcnt lgkmcnt(0)
  s_nop 2
  v_add_f32 v112, v112, v113
  v_add_f32 v232, v232, v233
  v_add_f32 v114, v114, v115
  v_add_f32 v234, v234, v235
  v_add_f32 v116, v116, v236
  v_add_f32 v117, v117, v237
  v_add_f32 v118, v118, v238
  v_add_f32 v112, v112, v232
  v_add_f32 v114, v114, v234
  v_mov_b32 v24, v112
  v_mov_b32 v25, v114
  v_mov_b32 v26, v116
  v_mov_b32 v27, v117
  v_mov_b32 v28, v118
  s_nop 1
  v_permlane32_swap_b32 v112, v24
  v_permlane32_swap_b32 v114, v25
  v_permlane32_swap_b32 v116, v26
  v_permlane32_swap_b32 v117, v27
  v_permlane32_swap_b32 v118, v28
  s_nop 1
  v_add_f32 v112, v112, v24
  v_add_f32 v114, v114, v25
  v_add_f32 v116, v116, v26
  v_add_f32 v117, v117, v27
  v_add_f32 v118, v118, v28
  ds_write_b32 v228, v112 offset:256
  ds_write_b32 v228, v114 offset:384
  ds_write_b32 v228, v116 offset:1792
  ds_write_b32 v228, v117 offset:1920
  ds_write_b32 v228, v118 offset:2048
  v_mov_b32 v18, 159764
  v_mov_b32 v123, 1
  ds_write_b32 v18, v123
  v_mov_b32 v18, 159760
k1_sp1a:
  ds_read_b128 v[124:127], v18
  s_waitcnt lgkmcnt(0)
  v_and_b32 v124, v124, v125
  v_and_b32 v126, v126, v127
  v_and_b32 v124, v124, v126
  s_nop 0
  v_readfirstlane_b32 s14, v124
  s_nop 3
  s_cmp_eq_u32 s14, 0
  s_cbranch_scc1 k1_sp1a
  ds_read_b32 v24, v228 offset:0
  ds_read_b32 v25, v228 offset:128
  ds_read_b32 v26, v228 offset:2176
  ds_read_b32 v27, v228 offset:2304
  ds_read_b32 v28, v228 offset:2432
  s_waitcnt lgkmcnt(0)
  v_add_f32 v112, v112, v24
  v_add_f32 v114, v114, v25
  v_add_f32 v116, v116, v26
  v_add_f32 v117, v117, v27
  v_add_f32 v118, v118, v28
  ds_write_b32 v229, v116 offset:768
  v_mul_f32 v112, 0x3b000000, v112
  v_mul_f32 v114, 0x3b000000, v114
  v_fma_f32 v114, -v112, v112, v114
  v_max_f32 v114, 0, v114
  v_add_f32 v114, 0x3727c5ac, v114
  v_rsq_f32 v114, v114
  s_nop 0
  v_mul_f32 v112, v112, v114
  v_sub_f32 v112, 0, v112
  ds_write_b32 v229, v114 offset:512
  ds_write_b32 v229, v112 offset:640
  v_mov_b32 v184, v114
  v_mov_b32 v186, v112
  v_mov_b32 v188, v117
  v_mov_b32 v190, v118
  s_waitcnt lgkmcnt(0)
  ds_read_b128 v[128:131], v230 offset:512
  ds_read_b128 v[144:147], v230 offset:640
  ds_read_b128 v[132:135], v230 offset:544
  ds_read_b128 v[148:151], v230 offset:672
  ds_read_b128 v[136:139], v230 offset:576
  ds_read_b128 v[152:155], v230 offset:704
  ds_read_b128 v[140:143], v230 offset:608
  ds_read_b128 v[156:159], v230 offset:736
  ds_read_b128 v[160:163], v230 offset:768
  ds_read_b128 v[164:167], v230 offset:800
  ds_read_b128 v[168:171], v230 offset:832
  ds_read_b128 v[172:175], v230 offset:864
  ds_read_b128 v[124:127], v119
  s_waitcnt lgkmcnt(5)
  v_pk_mul_f32 v[24:25], v[144:145], v[190:191] op_sel_hi:[1,0]
  v_pk_mul_f32 v[26:27], v[146:147], v[190:191] op_sel_hi:[1,0]
  v_pk_mul_f32 v[28:29], v[148:149], v[190:191] op_sel_hi:[1,0]
  v_pk_mul_f32 v[30:31], v[150:151], v[190:191] op_sel_hi:[1,0]
  v_pk_mul_f32 v[32:33], v[152:153], v[190:191] op_sel_hi:[1,0]
  v_pk_mul_f32 v[34:35], v[154:155], v[190:191] op_sel_hi:[1,0]
  v_pk_mul_f32 v[36:37], v[156:157], v[190:191] op_sel_hi:[1,0]
  v_pk_mul_f32 v[38:39], v[158:159], v[190:191] op_sel_hi:[1,0]
  v_pk_fma_f32 v[96:97], v[96:97], v[128:129], v[24:25]
  v_pk_fma_f32 v[98:99], v[98:99], v[130:131], v[26:27]
  v_pk_fma_f32 v[100:101], v[100:101], v[132:133], v[28:29]
  v_pk_fma_f32 v[102:103], v[102:103], v[134:135], v[30:31]
  v_pk_fma_f32 v[104:105], v[104:105], v[136:137], v[32:33]
  v_pk_fma_f32 v[106:107], v[106:107], v[138:139], v[34:35]
  v_pk_fma_f32 v[108:109], v[108:109], v[140:141], v[36:37]
  v_pk_fma_f32 v[110:111], v[110:111], v[142:143], v[38:39]
  v_pk_fma_f32 v[40:41], v[144:145], v[188:189], v[176:177] op_sel_hi:[1,0,1]
  v_pk_fma_f32 v[42:43], v[146:147], v[188:189], v[176:177] op_sel_hi:[1,0,1]
  v_pk_fma_f32 v[44:45], v[148:149], v[188:189], v[176:177] op_sel_hi:[1,0,1]
  v_pk_fma_f32 v[46:47], v[150:151], v[188:189], v[176:177] op_sel_hi:[1,0,1]
  v_pk_fma_f32 v[48:49], v[152:153], v[188:189], v[176:177] op_sel_hi:[1,0,1]
  v_pk_fma_f32 v[50:51], v[154:155], v[188:189], v[176:177] op_sel_hi:[1,0,1]
  v_pk_fma_f32 v[52:53], v[156:157], v[188:189], v[176:177] op_sel_hi:[1,0,1]
  v_pk_fma_f32 v[54:55], v[158:159], v[188:189], v[176:177] op_sel_hi:[1,0,1]
  v_pk_fma_f32 v[80:81], v[80:81], v[128:129], v[40:41]
  v_pk_fma_f32 v[82:83], v[82:83], v[130:131], v[42:43]
  v_pk_fma_f32 v[84:85], v[84:85], v[132:133], v[44:45]
  v_pk_fma_f32 v[86:87], v[86:87], v[134:135], v[46:47]
  v_pk_fma_f32 v[88:89], v[88:89], v[136:137], v[48:49]
  v_pk_fma_f32 v[90:91], v[90:91], v[138:139], v[50:51]
  v_pk_fma_f32 v[92:93], v[92:93], v[140:141], v[52:53]
  v_pk_fma_f32 v[94:95], v[94:95], v[142:143], v[54:55]
  v_pk_fma_f32 v[40:41], v[80:81], v[178:179], v[180:181]
  v_pk_fma_f32 v[42:43], v[82:83], v[178:179], v[180:181]
  v_pk_fma_f32 v[44:45], v[84:85], v[178:179], v[180:181]
  v_pk_fma_f32 v[46:47], v[86:87], v[178:179], v[180:181]
  v_pk_fma_f32 v[48:49], v[88:89], v[178:179], v[180:181]
  v_pk_fma_f32 v[50:51], v[90:91], v[178:179], v[180:181]
  v_pk_fma_f32 v[52:53], v[92:93], v[178:179], v[180:181]
  v_pk_fma_f32 v[54:55], v[94:95], v[178:179], v[180:181]
  v_exp_f32_e64 v40, v40 clamp
  v_exp_f32_e64 v41, v41 clamp
  v_exp_f32_e64 v42, v42 clamp
  v_exp_f32_e64 v43, v43 clamp
  v_exp_f32_e64 v44, v44 clamp
  v_exp_f32_e64 v45, v45 clamp
  v_exp_f32_e64 v46, v46 clamp
  v_exp_f32_e64 v47, v47 clamp
  v_exp_f32_e64 v48, v48 clamp
  v_exp_f32_e64 v49, v49 clamp
  v_exp_f32_e64 v50, v50 clamp
  v_exp_f32_e64 v51, v51 clamp
  v_exp_f32_e64 v52, v52 clamp
  v_exp_f32_e64 v53, v53 clamp
  v_exp_f32_e64 v54, v54 clamp
  v_exp_f32_e64 v55, v55 clamp
  v_pk_add_f32 v[40:41], v[40:41], v[182:183]
  v_pk_add_f32 v[42:43], v[42:43], v[182:183]
  v_pk_add_f32 v[44:45], v[44:45], v[182:183]
  v_pk_add_f32 v[46:47], v[46:47], v[182:183]
  v_pk_add_f32 v[48:49], v[48:49], v[182:183]
  v_pk_add_f32 v[50:51], v[50:51], v[182:183]
  v_pk_add_f32 v[52:53], v[52:53], v[182:183]
  v_pk_add_f32 v[54:55], v[54:55], v[182:183]
  v_max_f32 v80, v80, v40
  v_max_f32 v81, v81, v41
  v_max_f32 v82, v82, v42
  v_max_f32 v83, v83, v43
  v_max_f32 v84, v84, v44
  v_max_f32 v85, v85, v45
  v_max_f32 v86, v86, v46
  v_max_f32 v87, v87, v47
  v_max_f32 v88, v88, v48
  v_max_f32 v89, v89, v49
  v_max_f32 v90, v90, v50
  v_max_f32 v91, v91, v51
  v_max_f32 v92, v92, v52
  v_max_f32 v93, v93, v53
  v_max_f32 v94, v94, v54
  v_max_f32 v95, v95, v55
  v_cvt_pk_bf16_f32 v216, v96, v97
  v_cvt_pk_bf16_f32 v217, v98, v99
  v_cvt_pk_bf16_f32 v218, v100, v101
  v_cvt_pk_bf16_f32 v219, v102, v103
  v_cvt_pk_bf16_f32 v220, v104, v105
  v_cvt_pk_bf16_f32 v221, v106, v107
  v_cvt_pk_bf16_f32 v222, v108, v109
  v_cvt_pk_bf16_f32 v223, v110, v111
  v_cvt_pk_bf16_f32 v208, v80, v81
  v_cvt_pk_bf16_f32 v209, v82, v83
  v_cvt_pk_bf16_f32 v210, v84, v85
  v_cvt_pk_bf16_f32 v211, v86, v87
  v_cvt_pk_bf16_f32 v212, v88, v89
  v_cvt_pk_bf16_f32 v213, v90, v91
  v_cvt_pk_bf16_f32 v214, v92, v93
  v_cvt_pk_bf16_f32 v215, v94, v95
  s_nop 1
  v_mfma_f32_32x32x16_bf16 v[80:95], v[216:219], v[208:211], 0
  v_mfma_f32_32x32x16_bf16 v[96:111], v[224:227], v[208:211], 0
  v_mfma_f32_32x32x16_bf16 v[80:95], v[220:223], v[212:215], v[80:95]
  v_mfma_f32_32x32x16_bf16 v[96:111], v[224:227], v[212:215], v[96:111]
  v_and_b32 v22, 16, v0
  v_cmp_ne_u32 vcc, 0, v22
  v_lshlrev_b32 v19, 2, v0
  v_add_u32 v19, 73728, v19
  v_bfe_u32 v9, v0, 4, 1
  s_movk_i32 s13, 1088
  v_mul_lo_u32 v9, v9, s13
  v_and_b32 v10, 15, v0
  v_lshl_add_u32 v9, v10, 2, v9
  v_lshl_add_u32 v10, v21, 8, v9
  s_lshl_b32 s13, s5, 2
  s_add_u32 s13, s13, 2
  s_mulk_i32 s13, 1088
  s_waitcnt lgkmcnt(0)
  v_and_b32 v124, v124, v125
  v_and_b32 v126, v126, v127
  v_and_b32 v124, v124, v126
  s_nop 0
  v_readfirstlane_b32 s14, v124
  s_nop 3
  s_cmp_lg_u32 s14, 0
  s_cbranch_scc1 k1_d61_ok
  v_mov_b32 v18, 159744
k1_d61:
  ds_read_b128 v[124:127], v18
  s_waitcnt lgkmcnt(0)
  v_and_b32 v124, v124, v125
  v_and_b32 v126, v126, v127
  v_and_b32 v124, v124, v126
  s_nop 0
  v_readfirstlane_b32 s14, v124
  s_nop 3
  s_cmp_eq_u32 s14, 0
  s_cbranch_scc1 k1_d61
k1_d61_ok:
  v_cndmask_b32 v24, v80, v88, vcc
  v_cndmask_b32 v25, v81, v89, vcc
  v_cndmask_b32 v26, v82, v90, vcc
  v_cndmask_b32 v27, v83, v91, vcc
  v_cndmask_b32 v28, v84, v92, vcc
  v_cndmask_b32 v29, v85, v93, vcc
  v_cndmask_b32 v30, v86, v94, vcc
  v_cndmask_b32 v31, v87, v95, vcc
  ds_write_b32 v19, v28 offset:5632
  ds_write_b32 v19, v29 offset:5888
  ds_write_b32 v19, v30 offset:6144
  ds_write_b32 v19, v31 offset:6400
  v_mov_b32 v18, 159780
  v_mov_b32 v123, 1
  ds_write_b32 v18, v123
  v_mov_b32 v18, 159788
k1_sp1c:
  ds_read_b32 v122, v18
  s_waitcnt lgkmcnt(0)
  v_readfirstlane_b32 s14, v122
  s_nop 3
  s_cmp_eq_u32 s14, 0
  s_cbranch_scc1 k1_sp1c
  ds_read_b32 v32, v19 offset:6912
  ds_read_b32 v33, v19 offset:7168
  ds_read_b32 v34, v19 offset:7424
  ds_read_b32 v35, v19 offset:7680
  ds_read_b32 v36, v19 offset:8960
  s_waitcnt vmcnt(0)
  s_waitcnt lgkmcnt(0)
  v_add_f32 v24, v24, v32
  v_add_f32 v25, v25, v33
  v_add_f32 v26, v26, v34
  v_add_f32 v27, v27, v35
  v_add_f32 v36, v36, v96
  s_mov_b32 s15, 0
k1_poll1:
  v_readfirstlane_b32 s14, v121
  s_add_u32 s15, s15, 1
  s_nop 2
  s_cmp_lg_u32 s14, 0
  s_cbranch_scc1 k1_go1
  s_cmp_ge_u32 s15, 0x20000
  s_cbranch_scc1 k1_go1
  s_sleep 2
  buffer_load_dword v121, v120, s[48:51], 0 offen sc1
  s_waitcnt vmcnt(0)
  s_branch k1_poll1
k1_go1:
  buffer_atomic_add_f32 v24, v10, s[44:47], s13 offen offset:0
  buffer_atomic_add_f32 v25, v10, s[44:47], s13 offen offset:64
  buffer_atomic_add_f32 v26, v10, s[44:47], s13 offen offset:128
  buffer_atomic_add_f32 v27, v10, s[44:47], s13 offen offset:192
  s_mov_b64 exec, 0xffffffff
  buffer_atomic_add_f32 v36, v9, s[44:47], s13 offen offset:1024
  s_mov_b64 exec, -1
  v_pk_fma_f32 v[40:41], v[160:161], v[186:187], v[176:177] op_sel_hi:[1,0,1]
  v_pk_fma_f32 v[42:43], v[162:163], v[186:187], v[176:177] op_sel_hi:[1,0,1]
  v_pk_fma_f32 v[44:45], v[164:165], v[186:187], v[176:177] op_sel_hi:[1,0,1]
  v_pk_fma_f32 v[46:47], v[166:167], v[186:187], v[176:177] op_sel_hi:[1,0,1]
  v_pk_fma_f32 v[48:49], v[168:169], v[186:187], v[176:177] op_sel_hi:[1,0,1]
  v_pk_fma_f32 v[50:51], v[170:171], v[186:187], v[176:177] op_sel_hi:[1,0,1]
  v_pk_fma_f32 v[52:53], v[172:173], v[186:187], v[176:177] op_sel_hi:[1,0,1]
  v_pk_fma_f32 v[54:55], v[174:175], v[186:187], v[176:177] op_sel_hi:[1,0,1]
  v_pk_fma_f32 v[64:65], v[64:65], v[184:185], v[40:41] op_sel_hi:[1,0,1]
  v_pk_fma_f32 v[66:67], v[66:67], v[184:185], v[42:43] op_sel_hi:[1,0,1]
  v_pk_fma_f32 v[68:69], v[68:69], v[184:185], v[44:45] op_sel_hi:[1,0,1]
  v_pk_fma_f32 v[70:71], v[70:71], v[184:185], v[46:47] op_sel_hi:[1,0,1]
  v_pk_fma_f32 v[72:73], v[72:73], v[184:185], v[48:49] op_sel_hi:[1,0,1]
  v_pk_fma_f32 v[74:75], v[74:75], v[184:185], v[50:51] op_sel_hi:[1,0,1]
  v_pk_fma_f32 v[76:77], v[76:77], v[184:185], v[52:53] op_sel_hi:[1,0,1]
  v_pk_fma_f32 v[78:79], v[78:79], v[184:185], v[54:55] op_sel_hi:[1,0,1]
  v_pk_fma_f32 v[40:41], v[64:65], v[178:179], v[180:181]
  v_pk_fma_f32 v[42:43], v[66:67], v[178:179], v[180:181]
  v_pk_fma_f32 v[44:45], v[68:69], v[178:179], v[180:181]
  v_pk_fma_f32 v[46:47], v[70:71], v[178:179], v[180:181]
  v_pk_fma_f32 v[48:49], v[72:73], v[178:179], v[180:181]
  v_pk_fma_f32 v[50:51], v[74:75], v[178:179], v[180:181]
  v_pk_fma_f32 v[52:53], v[76:77], v[178:179], v[180:181]
  v_pk_fma_f32 v[54:55], v[78:79], v[178:179], v[180:181]
  v_exp_f32_e64 v40, v40 clamp
  v_exp_f32_e64 v41, v41 clamp
  v_exp_f32_e64 v42, v42 clamp
  v_exp_f32_e64 v43, v43 clamp
  v_exp_f32_e64 v44, v44 clamp
  v_exp_f32_e64 v45, v45 clamp
  v_exp_f32_e64 v46, v46 clamp
  v_exp_f32_e64 v47, v47 clamp
  v_exp_f32_e64 v48, v48 clamp
  v_exp_f32_e64 v49, v49 clamp
  v_exp_f32_e64 v50, v50 clamp
  v_exp_f32_e64 v51, v51 clamp
  v_exp_f32_e64 v52, v52 clamp
  v_exp_f32_e64 v53, v53 clamp
  v_exp_f32_e64 v54, v54 clamp
  v_exp_f32_e64 v55, v55 clamp
  v_pk_add_f32 v[40:41], v[40:41], v[182:183]
  v_pk_add_f32 v[42:43], v[42:43], v[182:183]
  v_pk_add_f32 v[44:45], v[44:45], v[182:183]
  v_pk_add_f32 v[46:47], v[46:47], v[182:183]
  v_pk_add_f32 v[48:49], v[48:49], v[182:183]
  v_pk_add_f32 v[50:51], v[50:51], v[182:183]
  v_pk_add_f32 v[52:53], v[52:53], v[182:183]
  v_pk_add_f32 v[54:55], v[54:55], v[182:183]
  v_max_f32 v64, v64, v40
  v_max_f32 v65, v65, v41
  v_max_f32 v66, v66, v42
  v_max_f32 v67, v67, v43
  v_max_f32 v68, v68, v44
  v_max_f32 v69, v69, v45
  v_max_f32 v70, v70, v46
  v_max_f32 v71, v71, v47
  v_max_f32 v72, v72, v48
  v_max_f32 v73, v73, v49
  v_max_f32 v74, v74, v50
  v_max_f32 v75, v75, v51
  v_max_f32 v76, v76, v52
  v_max_f32 v77, v77, v53
  v_max_f32 v78, v78, v54
  v_max_f32 v79, v79, v55
  v_cvt_pk_bf16_f32 v200, v64, v65
  v_cvt_pk_bf16_f32 v201, v66, v67
  v_cvt_pk_bf16_f32 v202, v68, v69
  v_cvt_pk_bf16_f32 v203, v70, v71
  v_cvt_pk_bf16_f32 v204, v72, v73
  v_cvt_pk_bf16_f32 v205, v74, v75
  v_cvt_pk_bf16_f32 v206, v76, v77
  v_cvt_pk_bf16_f32 v207, v78, v79
  s_add_u32 s52, s34, 1048576
  s_addc_u32 s53, s35, 0
  s_mov_b32 s54, 2097152
  s_mov_b32 s55, 0x20000
  s_lshl_b32 s12, s6, 1
  s_add_u32 s12, s12, 0
  s_lshl_b32 s12, s12, 5
  s_lshl_b32 s13, s5, 2
  s_add_u32 s12, s12, s13
  s_add_u32 s12, s12, 2
  s_lshl_b32 s12, s12, 10
  v_lshlrev_b32 v18, 4, v0
  buffer_store_dwordx4 v[200:203], v18, s[52:55], s12 offen sc1
  buffer_store_dwordx4 v[204:207], v18, s[52:55], s12 offen offset:1024 sc1
  s_branch k1_fin
k1_w2:
  v_and_b32 v20, 31, v0
  v_lshrrev_b32 v21, 5, v0
  v_bfe_u32 v22, v0, 1, 3
  v_xor_b32 v22, v22, v21
  v_lshlrev_b32 v22, 4, v22
  v_lshl_add_u32 v22, v20, 7, v22
  v_add_u32 v8, 4096, v22
  v_xor_b32 v9, 32, v8
  v_xor_b32 v10, 64, v8
  v_xor_b32 v11, 96, v8
  v_add_u32 v12, 0x10000, v8
  v_add_u32 v13, 0x10000, v9
  v_add_u32 v14, 0x10000, v10
  v_add_u32 v15, 0x10000, v11
  v_bfe_u32 v22, v0, 2, 2
  v_lshl_add_u32 v23, v21, 3, v22
  v_mul_u32_u24 v23, 384, v23
  v_bfe_u32 v22, v0, 3, 1
  v_lshl_add_u32 v23, v22, 6, v23
  v_bfe_u32 v22, v0, 4, 1
  v_lshl_add_u32 v23, v22, 5, v23
  v_and_b32 v22, 3, v0
  v_lshl_add_u32 v16, v22, 3, v23
  v_add_u32 v17, 0x10000, v16
  v_mov_b32 v112, 0
  v_mov_b32 v113, 0
  v_mov_b32 v114, 0
  v_mov_b32 v115, 0
  v_mov_b32 v116, 0
  v_mov_b32 v117, 0
  v_mov_b32 v118, 0
  v_mov_b32 v232, 0
  v_mov_b32 v233, 0
  v_mov_b32 v234, 0
  v_mov_b32 v235, 0
  v_mov_b32 v236, 0
  v_mov_b32 v237, 0
  v_mov_b32 v238, 0
  v_and_b32 v18, 3, v0
  v_lshlrev_b32 v18, 4, v18
  v_add_u32 v18, 159872, v18
  v_mov_b32 v24, 0
  v_mov_b32 v25, 0
  v_mov_b32 v26, 0
  v_mov_b32 v27, 0
  ds_write_b128 v18, v[24:27]
  v_mov_b32 v119, 159744
  v_mov_b32 v123, 1
  s_mov_b32 s36, s16
  s_mov_b32 s37, s17
  s_mov_b32 s38, 2097152
  s_mov_b32 s39, 0x20000
  s_mov_b32 s40, s18
  s_mov_b32 s41, s19
  s_mov_b32 s42, 1572864
  s_mov_b32 s43, 0x20000
  s_lshr_b32 s12, s2, 3
  s_lshl_b32 s12, s12, 2
  s_add_u32 s12, s12, 2
  s_and_b32 s13, s2, 7
  s_lshr_b32 s15, s13, 1
  s_lshl_b32 s15, s15, 19
  s_lshl_b32 s14, s12, 12
  s_add_u32 s15, s15, s14
  v_lshlrev_b32 v245, 7, v20
  v_min_u32 v22, 47, v0
  v_mul_u32_u24 v23, 43, v22
  v_lshrrev_b32 v23, 9, v23
  v_mul_u32_u24 v24, 12, v23
  v_sub_u32 v24, v22, v24
  v_mul_u32_u24 v23, 3072, v23
  v_lshrrev_b32 v25, 2, v24
  v_lshl_add_u32 v23, v25, 10, v23
  v_and_b32 v24, 3, v24
  v_lshl_add_u32 v23, v24, 7, v23
  s_mul_i32 s14, s12, 12288
  s_and_b32 s13, s13, 1
  s_lshl_b32 s13, s13, 9
  s_add_u32 s14, s14, s13
  s_waitcnt lgkmcnt(0)
  s_barrier
  v_mov_b32 v176, 0x3f800008
  v_mov_b32 v177, 0x3f800008
  v_mov_b32 v178, 0x3fb8aa3b
  v_mov_b32 v179, 0x3fb8aa3b
  v_mov_b32 v180, 0xbfb8aa47
  v_mov_b32 v181, 0xbfb8aa47
  v_mov_b32 v182, 0x358637bd
  v_mov_b32 v183, 0x358637bd
  v_mov_b32 v224, 0x3f803f80
  v_mov_b32 v225, 0x3f803f80
  v_mov_b32 v226, 0x3f803f80
  v_mov_b32 v227, 0x3f803f80
  v_lshlrev_b32 v228, 2, v20
  v_add_u32 v229, 160000, v228
  v_add_u32 v228, 156672, v228
  v_lshlrev_b32 v230, 4, v21
  v_add_u32 v230, 160000, v230
  s_barrier
  buffer_load_dword v240, v245, s[36:39], s15 offen
  ds_read_b128 v[24:27], v8 offset:0
  ds_read_b64_tr_b16 v[32:33], v16 offset:8192
  ds_read_b64_tr_b16 v[34:35], v16 offset:9728
  ds_read_b64_tr_b16 v[36:37], v16 offset:8320
  ds_read_b64_tr_b16 v[38:39], v16 offset:9856
  ds_read_b64_tr_b16 v[40:41], v16 offset:8448
  ds_read_b64_tr_b16 v[42:43], v16 offset:9984
  s_waitcnt lgkmcnt(0)
  v_mfma_f32_32x32x16_bf16 v[64:79], v[32:35], v[24:27], 0
  ds_read_b128 v[28:31], v9 offset:0
  ds_read_b64_tr_b16 v[44:45], v16 offset:14336
  ds_read_b64_tr_b16 v[46:47], v16 offset:15872
  ds_read_b64_tr_b16 v[48:49], v16 offset:14464
  v_mfma_f32_32x32x16_bf16 v[80:95], v[24:27], v[36:39], 0
  ds_read_b64_tr_b16 v[50:51], v16 offset:16000
  ds_read_b64_tr_b16 v[52:53], v16 offset:14592
  ds_read_b64_tr_b16 v[54:55], v16 offset:16128
  v_mfma_f32_32x32x16_bf16 v[96:111], v[24:27], v[40:43], 0
  v_dot2c_f32_bf16 v112, 0x3f803f80, v24
  v_dot2c_f32_bf16 v114, v24, v24
  v_dot2c_f32_bf16 v113, 0x3f803f80, v25
  v_dot2c_f32_bf16 v115, v25, v25
  v_dot2c_f32_bf16 v232, 0x3f803f80, v26
  v_dot2c_f32_bf16 v234, v26, v26
  v_dot2c_f32_bf16 v233, 0x3f803f80, v27
  v_dot2c_f32_bf16 v235, v27, v27
  s_waitcnt lgkmcnt(0)
  v_mfma_f32_32x32x16_bf16 v[64:79], v[44:47], v[28:31], v[64:79]
  ds_read_b128 v[24:27], v10 offset:0
  ds_read_b64_tr_b16 v[32:33], v16 offset:20480
  ds_read_b64_tr_b16 v[34:35], v16 offset:22016
  ds_read_b64_tr_b16 v[36:37], v16 offset:20608
  v_mfma_f32_32x32x16_bf16 v[80:95], v[28:31], v[48:51], v[80:95]
  ds_read_b64_tr_b16 v[38:39], v16 offset:22144
  ds_read_b64_tr_b16 v[40:41], v16 offset:20736
  ds_read_b64_tr_b16 v[42:43], v16 offset:22272
  v_mfma_f32_32x32x16_bf16 v[96:111], v[28:31], v[52:55], v[96:111]
  v_dot2c_f32_bf16 v236, 0x3f803f80, v44
  v_dot2c_f32_bf16 v237, 0x3f803f80, v48
  v_dot2c_f32_bf16 v238, 0x3f803f80, v52
  v_dot2c_f32_bf16 v116, 0x3f803f80, v45
  v_dot2c_f32_bf16 v117, 0x3f803f80, v49
  v_dot2c_f32_bf16 v118, 0x3f803f80, v53
  v_dot2c_f32_bf16 v236, 0x3f803f80, v46
  v_dot2c_f32_bf16 v237, 0x3f803f80, v50
  v_dot2c_f32_bf16 v238, 0x3f803f80, v54
  v_dot2c_f32_bf16 v116, 0x3f803f80, v47
  v_dot2c_f32_bf16 v117, 0x3f803f80, v51
  v_dot2c_f32_bf16 v118, 0x3f803f80, v55
  s_waitcnt lgkmcnt(0)
  v_mfma_f32_32x32x16_bf16 v[64:79], v[32:35], v[24:27], v[64:79]
  ds_read_b128 v[28:31], v11 offset:0
  ds_read_b64_tr_b16 v[44:45], v16 offset:26624
  ds_read_b64_tr_b16 v[46:47], v16 offset:28160
  ds_read_b64_tr_b16 v[48:49], v16 offset:26752
  v_mfma_f32_32x32x16_bf16 v[80:95], v[24:27], v[36:39], v[80:95]
  ds_read_b64_tr_b16 v[50:51], v16 offset:28288
  ds_read_b64_tr_b16 v[52:53], v16 offset:26880
  ds_read_b64_tr_b16 v[54:55], v16 offset:28416
  v_mfma_f32_32x32x16_bf16 v[96:111], v[24:27], v[40:43], v[96:111]
  v_dot2c_f32_bf16 v112, 0x3f803f80, v24
  v_dot2c_f32_bf16 v114, v24, v24
  v_dot2c_f32_bf16 v113, 0x3f803f80, v25
  v_dot2c_f32_bf16 v115, v25, v25
  v_dot2c_f32_bf16 v232, 0x3f803f80, v26
  v_dot2c_f32_bf16 v234, v26, v26
  v_dot2c_f32_bf16 v233, 0x3f803f80, v27
  v_dot2c_f32_bf16 v235, v27, v27
  s_waitcnt lgkmcnt(0)
  s_barrier
  v_mfma_f32_32x32x16_bf16 v[64:79], v[44:47], v[28:31], v[64:79]
  ds_read_b128 v[24:27], v8 offset:32768
  ds_read_b64_tr_b16 v[32:33], v16 offset:40960
  ds_read_b64_tr_b16 v[34:35], v16 offset:42496
  ds_read_b64_tr_b16 v[36:37], v16 offset:41088
  v_mfma_f32_32x32x16_bf16 v[80:95], v[28:31], v[48:51], v[80:95]
  ds_read_b64_tr_b16 v[38:39], v16 offset:42624
  ds_read_b64_tr_b16 v[40:41], v16 offset:41216
  ds_read_b64_tr_b16 v[42:43], v16 offset:42752
  v_mfma_f32_32x32x16_bf16 v[96:111], v[28:31], v[52:55], v[96:111]
  v_dot2c_f32_bf16 v236, 0x3f803f80, v44
  v_dot2c_f32_bf16 v237, 0x3f803f80, v48
  v_dot2c_f32_bf16 v238, 0x3f803f80, v52
  v_dot2c_f32_bf16 v116, 0x3f803f80, v45
  v_dot2c_f32_bf16 v117, 0x3f803f80, v49
  v_dot2c_f32_bf16 v118, 0x3f803f80, v53
  v_dot2c_f32_bf16 v236, 0x3f803f80, v46
  v_dot2c_f32_bf16 v237, 0x3f803f80, v50
  v_dot2c_f32_bf16 v238, 0x3f803f80, v54
  v_dot2c_f32_bf16 v116, 0x3f803f80, v47
  v_dot2c_f32_bf16 v117, 0x3f803f80, v51
  v_dot2c_f32_bf16 v118, 0x3f803f80, v55
  s_waitcnt lgkmcnt(0)
  v_mfma_f32_32x32x16_bf16 v[64:79], v[32:35], v[24:27], v[64:79]
  ds_read_b128 v[28:31], v9 offset:32768
  ds_read_b64_tr_b16 v[44:45], v16 offset:47104
  ds_read_b64_tr_b16 v[46:47], v16 offset:48640
  ds_read_b64_tr_b16 v[48:49], v16 offset:47232
  v_mfma_f32_32x32x16_bf16 v[80:95], v[24:27], v[36:39], v[80:95]
  ds_read_b64_tr_b16 v[50:51], v16 offset:48768
  ds_read_b64_tr_b16 v[52:53], v16 offset:47360
  ds_read_b64_tr_b16 v[54:55], v16 offset:48896
  v_mfma_f32_32x32x16_bf16 v[96:111], v[24:27], v[40:43], v[96:111]
  v_dot2c_f32_bf16 v112, 0x3f803f80, v24
  v_dot2c_f32_bf16 v114, v24, v24
  v_dot2c_f32_bf16 v113, 0x3f803f80, v25
  v_dot2c_f32_bf16 v115, v25, v25
  v_dot2c_f32_bf16 v232, 0x3f803f80, v26
  v_dot2c_f32_bf16 v234, v26, v26
  v_dot2c_f32_bf16 v233, 0x3f803f80, v27
  v_dot2c_f32_bf16 v235, v27, v27
  s_waitcnt lgkmcnt(0)
  v_mfma_f32_32x32x16_bf16 v[64:79], v[44:47], v[28:31], v[64:79]
  ds_read_b128 v[24:27], v10 offset:32768
  ds_read_b64_tr_b16 v[32:33], v16 offset:53248
  ds_read_b64_tr_b16 v[34:35], v16 offset:54784
  ds_read_b64_tr_b16 v[36:37], v16 offset:53376
  v_mfma_f32_32x32x16_bf16 v[80:95], v[28:31], v[48:51], v[80:95]
  ds_read_b64_tr_b16 v[38:39], v16 offset:54912
  ds_read_b64_tr_b16 v[40:41], v16 offset:53504
  ds_read_b64_tr_b16 v[42:43], v16 offset:55040
  v_mfma_f32_32x32x16_bf16 v[96:111], v[28:31], v[52:55], v[96:111]
  v_dot2c_f32_bf16 v236, 0x3f803f80, v44
  v_dot2c_f32_bf16 v237, 0x3f803f80, v48
  v_dot2c_f32_bf16 v238, 0x3f803f80, v52
  v_dot2c_f32_bf16 v116, 0x3f803f80, v45
  v_dot2c_f32_bf16 v117, 0x3f803f80, v49
  v_dot2c_f32_bf16 v118, 0x3f803f80, v53
  v_dot2c_f32_bf16 v236, 0x3f803f80, v46
  v_dot2c_f32_bf16 v237, 0x3f803f80, v50
  v_dot2c_f32_bf16 v238, 0x3f803f80, v54
  v_dot2c_f32_bf16 v116, 0x3f803f80, v47
  v_dot2c_f32_bf16 v117, 0x3f803f80, v51
  v_dot2c_f32_bf16 v118, 0x3f803f80, v55
  s_waitcnt lgkmcnt(0)
  v_mfma_f32_32x32x16_bf16 v[64:79], v[32:35], v[24:27], v[64:79]
  ds_read_b128 v[28:31], v11 offset:32768
  ds_read_b64_tr_b16 v[44:45], v16 offset:59392
  ds_read_b64_tr_b16 v[46:47], v16 offset:60928
  ds_read_b64_tr_b16 v[48:49], v16 offset:59520
  v_mfma_f32_32x32x16_bf16 v[80:95], v[24:27], v[36:39], v[80:95]
  ds_read_b64_tr_b16 v[50:51], v16 offset:61056
  ds_read_b64_tr_b16 v[52:53], v16 offset:59648
  ds_read_b64_tr_b16 v[54:55], v16 offset:61184
  v_mfma_f32_32x32x16_bf16 v[96:111], v[24:27], v[40:43], v[96:111]
  v_dot2c_f32_bf16 v112, 0x3f803f80, v24
  v_dot2c_f32_bf16 v114, v24, v24
  v_dot2c_f32_bf16 v113, 0x3f803f80, v25
  v_dot2c_f32_bf16 v115, v25, v25
  v_dot2c_f32_bf16 v232, 0x3f803f80, v26
  v_dot2c_f32_bf16 v234, v26, v26
  v_dot2c_f32_bf16 v233, 0x3f803f80, v27
  v_dot2c_f32_bf16 v235, v27, v27
  s_waitcnt lgkmcnt(0)
  s_barrier
  v_mfma_f32_32x32x16_bf16 v[64:79], v[44:47], v[28:31], v[64:79]
  ds_read_b128 v[24:27], v12 offset:0
  ds_read_b64_tr_b16 v[32:33], v17 offset:8192
  ds_read_b64_tr_b16 v[34:35], v17 offset:9728
  ds_read_b64_tr_b16 v[36:37], v17 offset:8320
  v_mfma_f32_32x32x16_bf16 v[80:95], v[28:31], v[48:51], v[80:95]
  ds_read_b64_tr_b16 v[38:39], v17 offset:9856
  ds_read_b64_tr_b16 v[40:41], v17 offset:8448
  ds_read_b64_tr_b16 v[42:43], v17 offset:9984
  v_mfma_f32_32x32x16_bf16 v[96:111], v[28:31], v[52:55], v[96:111]
  v_dot2c_f32_bf16 v236, 0x3f803f80, v44
  v_dot2c_f32_bf16 v237, 0x3f803f80, v48
  v_dot2c_f32_bf16 v238, 0x3f803f80, v52
  v_dot2c_f32_bf16 v116, 0x3f803f80, v45
  v_dot2c_f32_bf16 v117, 0x3f803f80, v49
  v_dot2c_f32_bf16 v118, 0x3f803f80, v53
  v_dot2c_f32_bf16 v236, 0x3f803f80, v46
  v_dot2c_f32_bf16 v237, 0x3f803f80, v50
  v_dot2c_f32_bf16 v238, 0x3f803f80, v54
  v_dot2c_f32_bf16 v116, 0x3f803f80, v47
  v_dot2c_f32_bf16 v117, 0x3f803f80, v51
  v_dot2c_f32_bf16 v118, 0x3f803f80, v55
  s_waitcnt lgkmcnt(0)
  v_mfma_f32_32x32x16_bf16 v[64:79], v[32:35], v[24:27], v[64:79]
  ds_read_b128 v[28:31], v13 offset:0
  ds_read_b64_tr_b16 v[44:45], v17 offset:14336
  ds_read_b64_tr_b16 v[46:47], v17 offset:15872
  ds_read_b64_tr_b16 v[48:49], v17 offset:14464
  v_mfma_f32_32x32x16_bf16 v[80:95], v[24:27], v[36:39], v[80:95]
  ds_read_b64_tr_b16 v[50:51], v17 offset:16000
  ds_read_b64_tr_b16 v[52:53], v17 offset:14592
  ds_read_b64_tr_b16 v[54:55], v17 offset:16128
  v_mfma_f32_32x32x16_bf16 v[96:111], v[24:27], v[40:43], v[96:111]
  v_dot2c_f32_bf16 v112, 0x3f803f80, v24
  v_dot2c_f32_bf16 v114, v24, v24
  v_dot2c_f32_bf16 v113, 0x3f803f80, v25
  v_dot2c_f32_bf16 v115, v25, v25
  v_dot2c_f32_bf16 v232, 0x3f803f80, v26
  v_dot2c_f32_bf16 v234, v26, v26
  v_dot2c_f32_bf16 v233, 0x3f803f80, v27
  v_dot2c_f32_bf16 v235, v27, v27
  s_waitcnt lgkmcnt(0)
  v_mfma_f32_32x32x16_bf16 v[64:79], v[44:47], v[28:31], v[64:79]
  ds_read_b128 v[24:27], v14 offset:0
  ds_read_b64_tr_b16 v[32:33], v17 offset:20480
  ds_read_b64_tr_b16 v[34:35], v17 offset:22016
  ds_read_b64_tr_b16 v[36:37], v17 offset:20608
  v_mfma_f32_32x32x16_bf16 v[80:95], v[28:31], v[48:51], v[80:95]
  ds_read_b64_tr_b16 v[38:39], v17 offset:22144
  ds_read_b64_tr_b16 v[40:41], v17 offset:20736
  ds_read_b64_tr_b16 v[42:43], v17 offset:22272
  v_mfma_f32_32x32x16_bf16 v[96:111], v[28:31], v[52:55], v[96:111]
  v_dot2c_f32_bf16 v236, 0x3f803f80, v44
  v_dot2c_f32_bf16 v237, 0x3f803f80, v48
  v_dot2c_f32_bf16 v238, 0x3f803f80, v52
  v_dot2c_f32_bf16 v116, 0x3f803f80, v45
  v_dot2c_f32_bf16 v117, 0x3f803f80, v49
  v_dot2c_f32_bf16 v118, 0x3f803f80, v53
  v_dot2c_f32_bf16 v236, 0x3f803f80, v46
  v_dot2c_f32_bf16 v237, 0x3f803f80, v50
  v_dot2c_f32_bf16 v238, 0x3f803f80, v54
  v_dot2c_f32_bf16 v116, 0x3f803f80, v47
  v_dot2c_f32_bf16 v117, 0x3f803f80, v51
  v_dot2c_f32_bf16 v118, 0x3f803f80, v55
  s_waitcnt lgkmcnt(0)
  v_mfma_f32_32x32x16_bf16 v[64:79], v[32:35], v[24:27], v[64:79]
  ds_read_b128 v[28:31], v15 offset:0
  ds_read_b64_tr_b16 v[44:45], v17 offset:26624
  ds_read_b64_tr_b16 v[46:47], v17 offset:28160
  ds_read_b64_tr_b16 v[48:49], v17 offset:26752
  v_mfma_f32_32x32x16_bf16 v[80:95], v[24:27], v[36:39], v[80:95]
  ds_read_b64_tr_b16 v[50:51], v17 offset:28288
  ds_read_b64_tr_b16 v[52:53], v17 offset:26880
  ds_read_b64_tr_b16 v[54:55], v17 offset:28416
  v_mfma_f32_32x32x16_bf16 v[96:111], v[24:27], v[40:43], v[96:111]
  v_dot2c_f32_bf16 v112, 0x3f803f80, v24
  v_dot2c_f32_bf16 v114, v24, v24
  v_dot2c_f32_bf16 v113, 0x3f803f80, v25
  v_dot2c_f32_bf16 v115, v25, v25
  v_dot2c_f32_bf16 v232, 0x3f803f80, v26
  v_dot2c_f32_bf16 v234, v26, v26
  v_dot2c_f32_bf16 v233, 0x3f803f80, v27
  v_dot2c_f32_bf16 v235, v27, v27
  s_waitcnt lgkmcnt(0)
  s_barrier
  v_mfma_f32_32x32x16_bf16 v[64:79], v[44:47], v[28:31], v[64:79]
  ds_read_b128 v[24:27], v12 offset:32768
  ds_read_b64_tr_b16 v[32:33], v17 offset:40960
  ds_read_b64_tr_b16 v[34:35], v17 offset:42496
  ds_read_b64_tr_b16 v[36:37], v17 offset:41088
  v_mfma_f32_32x32x16_bf16 v[80:95], v[28:31], v[48:51], v[80:95]
  ds_read_b64_tr_b16 v[38:39], v17 offset:42624
  ds_read_b64_tr_b16 v[40:41], v17 offset:41216
  ds_read_b64_tr_b16 v[42:43], v17 offset:42752
  v_mfma_f32_32x32x16_bf16 v[96:111], v[28:31], v[52:55], v[96:111]
  v_dot2c_f32_bf16 v236, 0x3f803f80, v44
  v_dot2c_f32_bf16 v237, 0x3f803f80, v48
  v_dot2c_f32_bf16 v238, 0x3f803f80, v52
  v_dot2c_f32_bf16 v116, 0x3f803f80, v45
  v_dot2c_f32_bf16 v117, 0x3f803f80, v49
  v_dot2c_f32_bf16 v118, 0x3f803f80, v53
  v_dot2c_f32_bf16 v236, 0x3f803f80, v46
  v_dot2c_f32_bf16 v237, 0x3f803f80, v50
  v_dot2c_f32_bf16 v238, 0x3f803f80, v54
  v_dot2c_f32_bf16 v116, 0x3f803f80, v47
  v_dot2c_f32_bf16 v117, 0x3f803f80, v51
  v_dot2c_f32_bf16 v118, 0x3f803f80, v55
  s_waitcnt lgkmcnt(0)
  v_mfma_f32_32x32x16_bf16 v[64:79], v[32:35], v[24:27], v[64:79]
  ds_read_b128 v[28:31], v13 offset:32768
  ds_read_b64_tr_b16 v[44:45], v17 offset:47104
  ds_read_b64_tr_b16 v[46:47], v17 offset:48640
  ds_read_b64_tr_b16 v[48:49], v17 offset:47232
  v_mfma_f32_32x32x16_bf16 v[80:95], v[24:27], v[36:39], v[80:95]
  ds_read_b64_tr_b16 v[50:51], v17 offset:48768
  ds_read_b64_tr_b16 v[52:53], v17 offset:47360
  ds_read_b64_tr_b16 v[54:55], v17 offset:48896
  v_mfma_f32_32x32x16_bf16 v[96:111], v[24:27], v[40:43], v[96:111]
  v_dot2c_f32_bf16 v112, 0x3f803f80, v24
  v_dot2c_f32_bf16 v114, v24, v24
  v_dot2c_f32_bf16 v113, 0x3f803f80, v25
  v_dot2c_f32_bf16 v115, v25, v25
  v_dot2c_f32_bf16 v232, 0x3f803f80, v26
  v_dot2c_f32_bf16 v234, v26, v26
  v_dot2c_f32_bf16 v233, 0x3f803f80, v27
  v_dot2c_f32_bf16 v235, v27, v27
  s_waitcnt lgkmcnt(0)
  v_mfma_f32_32x32x16_bf16 v[64:79], v[44:47], v[28:31], v[64:79]
  ds_read_b128 v[24:27], v14 offset:32768
  ds_read_b64_tr_b16 v[32:33], v17 offset:53248
  ds_read_b64_tr_b16 v[34:35], v17 offset:54784
  ds_read_b64_tr_b16 v[36:37], v17 offset:53376
  v_mfma_f32_32x32x16_bf16 v[80:95], v[28:31], v[48:51], v[80:95]
  ds_read_b64_tr_b16 v[38:39], v17 offset:54912
  ds_read_b64_tr_b16 v[40:41], v17 offset:53504
  ds_read_b64_tr_b16 v[42:43], v17 offset:55040
  v_mfma_f32_32x32x16_bf16 v[96:111], v[28:31], v[52:55], v[96:111]
  v_dot2c_f32_bf16 v236, 0x3f803f80, v44
  v_dot2c_f32_bf16 v237, 0x3f803f80, v48
  v_dot2c_f32_bf16 v238, 0x3f803f80, v52
  v_dot2c_f32_bf16 v116, 0x3f803f80, v45
  v_dot2c_f32_bf16 v117, 0x3f803f80, v49
  v_dot2c_f32_bf16 v118, 0x3f803f80, v53
  v_dot2c_f32_bf16 v236, 0x3f803f80, v46
  v_dot2c_f32_bf16 v237, 0x3f803f80, v50
  v_dot2c_f32_bf16 v238, 0x3f803f80, v54
  v_dot2c_f32_bf16 v116, 0x3f803f80, v47
  v_dot2c_f32_bf16 v117, 0x3f803f80, v51
  v_dot2c_f32_bf16 v118, 0x3f803f80, v55
  s_waitcnt lgkmcnt(0)
  v_mfma_f32_32x32x16_bf16 v[64:79], v[32:35], v[24:27], v[64:79]
  ds_read_b128 v[28:31], v15 offset:32768
  ds_read_b64_tr_b16 v[44:45], v17 offset:59392
  ds_read_b64_tr_b16 v[46:47], v17 offset:60928
  ds_read_b64_tr_b16 v[48:49], v17 offset:59520
  v_mfma_f32_32x32x16_bf16 v[80:95], v[24:27], v[36:39], v[80:95]
  ds_read_b64_tr_b16 v[50:51], v17 offset:61056
  ds_read_b64_tr_b16 v[52:53], v17 offset:59648
  ds_read_b64_tr_b16 v[54:55], v17 offset:61184
  v_mfma_f32_32x32x16_bf16 v[96:111], v[24:27], v[40:43], v[96:111]
  v_dot2c_f32_bf16 v112, 0x3f803f80, v24
  v_dot2c_f32_bf16 v114, v24, v24
  v_dot2c_f32_bf16 v113, 0x3f803f80, v25
  v_dot2c_f32_bf16 v115, v25, v25
  v_dot2c_f32_bf16 v232, 0x3f803f80, v26
  v_dot2c_f32_bf16 v234, v26, v26
  v_dot2c_f32_bf16 v233, 0x3f803f80, v27
  v_dot2c_f32_bf16 v235, v27, v27
  s_waitcnt lgkmcnt(0)
  s_barrier
  v_mfma_f32_32x32x16_bf16 v[64:79], v[44:47], v[28:31], v[64:79]
  ds_read_b128 v[24:27], v8 offset:0
  ds_read_b64_tr_b16 v[32:33], v16 offset:8192
  ds_read_b64_tr_b16 v[34:35], v16 offset:9728
  ds_read_b64_tr_b16 v[36:37], v16 offset:8320
  v_mfma_f32_32x32x16_bf16 v[80:95], v[28:31], v[48:51], v[80:95]
  ds_read_b64_tr_b16 v[38:39], v16 offset:9856
  ds_read_b64_tr_b16 v[40:41], v16 offset:8448
  ds_read_b64_tr_b16 v[42:43], v16 offset:9984
  v_mfma_f32_32x32x16_bf16 v[96:111], v[28:31], v[52:55], v[96:111]
  v_dot2c_f32_bf16 v236, 0x3f803f80, v44
  v_dot2c_f32_bf16 v237, 0x3f803f80, v48
  v_dot2c_f32_bf16 v238, 0x3f803f80, v52
  v_dot2c_f32_bf16 v116, 0x3f803f80, v45
  v_dot2c_f32_bf16 v117, 0x3f803f80, v49
  v_dot2c_f32_bf16 v118, 0x3f803f80, v53
  v_dot2c_f32_bf16 v236, 0x3f803f80, v46
  v_dot2c_f32_bf16 v237, 0x3f803f80, v50
  v_dot2c_f32_bf16 v238, 0x3f803f80, v54
  v_dot2c_f32_bf16 v116, 0x3f803f80, v47
  v_dot2c_f32_bf16 v117, 0x3f803f80, v51
  v_dot2c_f32_bf16 v118, 0x3f803f80, v55
  s_waitcnt lgkmcnt(0)
  v_mfma_f32_32x32x16_bf16 v[64:79], v[32:35], v[24:27], v[64:79]
  ds_read_b128 v[28:31], v9 offset:0
  ds_read_b64_tr_b16 v[44:45], v16 offset:14336
  ds_read_b64_tr_b16 v[46:47], v16 offset:15872
  ds_read_b64_tr_b16 v[48:49], v16 offset:14464
  v_mfma_f32_32x32x16_bf16 v[80:95], v[24:27], v[36:39], v[80:95]
  ds_read_b64_tr_b16 v[50:51], v16 offset:16000
  ds_read_b64_tr_b16 v[52:53], v16 offset:14592
  ds_read_b64_tr_b16 v[54:55], v16 offset:16128
  v_mfma_f32_32x32x16_bf16 v[96:111], v[24:27], v[40:43], v[96:111]
  v_dot2c_f32_bf16 v112, 0x3f803f80, v24
  v_dot2c_f32_bf16 v114, v24, v24
  v_dot2c_f32_bf16 v113, 0x3f803f80, v25
  v_dot2c_f32_bf16 v115, v25, v25
  v_dot2c_f32_bf16 v232, 0x3f803f80, v26
  v_dot2c_f32_bf16 v234, v26, v26
  v_dot2c_f32_bf16 v233, 0x3f803f80, v27
  v_dot2c_f32_bf16 v235, v27, v27
  s_waitcnt lgkmcnt(0)
  v_mfma_f32_32x32x16_bf16 v[64:79], v[44:47], v[28:31], v[64:79]
  ds_read_b128 v[24:27], v10 offset:0
  ds_read_b64_tr_b16 v[32:33], v16 offset:20480
  ds_read_b64_tr_b16 v[34:35], v16 offset:22016
  ds_read_b64_tr_b16 v[36:37], v16 offset:20608
  v_mfma_f32_32x32x16_bf16 v[80:95], v[28:31], v[48:51], v[80:95]
  ds_read_b64_tr_b16 v[38:39], v16 offset:22144
  ds_read_b64_tr_b16 v[40:41], v16 offset:20736
  ds_read_b64_tr_b16 v[42:43], v16 offset:22272
  v_mfma_f32_32x32x16_bf16 v[96:111], v[28:31], v[52:55], v[96:111]
  v_dot2c_f32_bf16 v236, 0x3f803f80, v44
  v_dot2c_f32_bf16 v237, 0x3f803f80, v48
  v_dot2c_f32_bf16 v238, 0x3f803f80, v52
  v_dot2c_f32_bf16 v116, 0x3f803f80, v45
  v_dot2c_f32_bf16 v117, 0x3f803f80, v49
  v_dot2c_f32_bf16 v118, 0x3f803f80, v53
  v_dot2c_f32_bf16 v236, 0x3f803f80, v46
  v_dot2c_f32_bf16 v237, 0x3f803f80, v50
  v_dot2c_f32_bf16 v238, 0x3f803f80, v54
  v_dot2c_f32_bf16 v116, 0x3f803f80, v47
  v_dot2c_f32_bf16 v117, 0x3f803f80, v51
  v_dot2c_f32_bf16 v118, 0x3f803f80, v55
  s_waitcnt lgkmcnt(0)
  v_mfma_f32_32x32x16_bf16 v[64:79], v[32:35], v[24:27], v[64:79]
  ds_read_b128 v[28:31], v11 offset:0
  ds_read_b64_tr_b16 v[44:45], v16 offset:26624
  ds_read_b64_tr_b16 v[46:47], v16 offset:28160
  ds_read_b64_tr_b16 v[48:49], v16 offset:26752
  v_mfma_f32_32x32x16_bf16 v[80:95], v[24:27], v[36:39], v[80:95]
  ds_read_b64_tr_b16 v[50:51], v16 offset:28288
  ds_read_b64_tr_b16 v[52:53], v16 offset:26880
  ds_read_b64_tr_b16 v[54:55], v16 offset:28416
  ds_read_b128 v[124:127], v119 offset:144
  v_mfma_f32_32x32x16_bf16 v[96:111], v[24:27], v[40:43], v[96:111]
  v_dot2c_f32_bf16 v112, 0x3f803f80, v24
  v_dot2c_f32_bf16 v114, v24, v24
  v_dot2c_f32_bf16 v113, 0x3f803f80, v25
  v_dot2c_f32_bf16 v115, v25, v25
  v_dot2c_f32_bf16 v232, 0x3f803f80, v26
  v_dot2c_f32_bf16 v234, v26, v26
  v_dot2c_f32_bf16 v233, 0x3f803f80, v27
  v_dot2c_f32_bf16 v235, v27, v27
  s_waitcnt lgkmcnt(0)
  v_and_b32 v124, v124, v125
  v_and_b32 v126, v126, v127
  v_and_b32 v124, v124, v126
  s_nop 0
  v_readfirstlane_b32 s14, v124
  s_nop 3
  s_cmp_lg_u32 s14, 0
  s_cbranch_scc1 k1_lf2_4_ok
  v_mov_b32 v18, 159888
k1_lf2_4:
  ds_read_b128 v[124:127], v18
  s_waitcnt lgkmcnt(0)
  v_and_b32 v124, v124, v125
  v_and_b32 v126, v126, v127
  v_and_b32 v124, v124, v126
  s_nop 0
  v_readfirstlane_b32 s14, v124
  s_nop 3
  s_cmp_eq_u32 s14, 0
  s_cbranch_scc1 k1_lf2_4
k1_lf2_4_ok:
  v_mfma_f32_32x32x16_bf16 v[64:79], v[44:47], v[28:31], v[64:79]
  ds_read_b128 v[24:27], v8 offset:32768
  ds_read_b64_tr_b16 v[32:33], v16 offset:40960
  ds_read_b64_tr_b16 v[34:35], v16 offset:42496
  ds_read_b64_tr_b16 v[36:37], v16 offset:41088
  v_mfma_f32_32x32x16_bf16 v[80:95], v[28:31], v[48:51], v[80:95]
  ds_read_b64_tr_b16 v[38:39], v16 offset:42624
  ds_read_b64_tr_b16 v[40:41], v16 offset:41216
  ds_read_b64_tr_b16 v[42:43], v16 offset:42752
  v_mfma_f32_32x32x16_bf16 v[96:111], v[28:31], v[52:55], v[96:111]
  v_dot2c_f32_bf16 v236, 0x3f803f80, v44
  v_dot2c_f32_bf16 v237, 0x3f803f80, v48
  v_dot2c_f32_bf16 v238, 0x3f803f80, v52
  v_dot2c_f32_bf16 v116, 0x3f803f80, v45
  v_dot2c_f32_bf16 v117, 0x3f803f80, v49
  v_dot2c_f32_bf16 v118, 0x3f803f80, v53
  v_dot2c_f32_bf16 v236, 0x3f803f80, v46
  v_dot2c_f32_bf16 v237, 0x3f803f80, v50
  v_dot2c_f32_bf16 v238, 0x3f803f80, v54
  v_dot2c_f32_bf16 v116, 0x3f803f80, v47
  v_dot2c_f32_bf16 v117, 0x3f803f80, v51
  v_dot2c_f32_bf16 v118, 0x3f803f80, v55
  s_waitcnt lgkmcnt(0)
  v_mfma_f32_32x32x16_bf16 v[64:79], v[32:35], v[24:27], v[64:79]
  ds_read_b128 v[28:31], v9 offset:32768
  ds_read_b64_tr_b16 v[44:45], v16 offset:47104
  ds_read_b64_tr_b16 v[46:47], v16 offset:48640
  ds_read_b64_tr_b16 v[48:49], v16 offset:47232
  v_mfma_f32_32x32x16_bf16 v[80:95], v[24:27], v[36:39], v[80:95]
  ds_read_b64_tr_b16 v[50:51], v16 offset:48768
  ds_read_b64_tr_b16 v[52:53], v16 offset:47360
  ds_read_b64_tr_b16 v[54:55], v16 offset:48896
  v_mfma_f32_32x32x16_bf16 v[96:111], v[24:27], v[40:43], v[96:111]
  v_dot2c_f32_bf16 v112, 0x3f803f80, v24
  v_dot2c_f32_bf16 v114, v24, v24
  v_dot2c_f32_bf16 v113, 0x3f803f80, v25
  v_dot2c_f32_bf16 v115, v25, v25
  v_dot2c_f32_bf16 v232, 0x3f803f80, v26
  v_dot2c_f32_bf16 v234, v26, v26
  v_dot2c_f32_bf16 v233, 0x3f803f80, v27
  v_dot2c_f32_bf16 v235, v27, v27
  s_waitcnt lgkmcnt(0)
  v_mfma_f32_32x32x16_bf16 v[64:79], v[44:47], v[28:31], v[64:79]
  ds_read_b128 v[24:27], v10 offset:32768
  ds_read_b64_tr_b16 v[32:33], v16 offset:53248
  ds_read_b64_tr_b16 v[34:35], v16 offset:54784
  ds_read_b64_tr_b16 v[36:37], v16 offset:53376
  v_mfma_f32_32x32x16_bf16 v[80:95], v[28:31], v[48:51], v[80:95]
  ds_read_b64_tr_b16 v[38:39], v16 offset:54912
  ds_read_b64_tr_b16 v[40:41], v16 offset:53504
  ds_read_b64_tr_b16 v[42:43], v16 offset:55040
  v_mfma_f32_32x32x16_bf16 v[96:111], v[28:31], v[52:55], v[96:111]
  v_dot2c_f32_bf16 v236, 0x3f803f80, v44
  v_dot2c_f32_bf16 v237, 0x3f803f80, v48
  v_dot2c_f32_bf16 v238, 0x3f803f80, v52
  v_dot2c_f32_bf16 v116, 0x3f803f80, v45
  v_dot2c_f32_bf16 v117, 0x3f803f80, v49
  v_dot2c_f32_bf16 v118, 0x3f803f80, v53
  v_dot2c_f32_bf16 v236, 0x3f803f80, v46
  v_dot2c_f32_bf16 v237, 0x3f803f80, v50
  v_dot2c_f32_bf16 v238, 0x3f803f80, v54
  v_dot2c_f32_bf16 v116, 0x3f803f80, v47
  v_dot2c_f32_bf16 v117, 0x3f803f80, v51
  v_dot2c_f32_bf16 v118, 0x3f803f80, v55
  s_waitcnt lgkmcnt(0)
  v_mfma_f32_32x32x16_bf16 v[64:79], v[32:35], v[24:27], v[64:79]
  ds_read_b128 v[28:31], v11 offset:32768
  ds_read_b64_tr_b16 v[44:45], v16 offset:59392
  ds_read_b64_tr_b16 v[46:47], v16 offset:60928
  ds_read_b64_tr_b16 v[48:49], v16 offset:59520
  v_mfma_f32_32x32x16_bf16 v[80:95], v[24:27], v[36:39], v[80:95]
  ds_read_b64_tr_b16 v[50:51], v16 offset:61056
  ds_read_b64_tr_b16 v[52:53], v16 offset:59648
  ds_read_b64_tr_b16 v[54:55], v16 offset:61184
  ds_read_b128 v[124:127], v119 offset:160
  v_mfma_f32_32x32x16_bf16 v[96:111], v[24:27], v[40:43], v[96:111]
  v_dot2c_f32_bf16 v112, 0x3f803f80, v24
  v_dot2c_f32_bf16 v114, v24, v24
  v_dot2c_f32_bf16 v113, 0x3f803f80, v25
  v_dot2c_f32_bf16 v115, v25, v25
  v_dot2c_f32_bf16 v232, 0x3f803f80, v26
  v_dot2c_f32_bf16 v234, v26, v26
  v_dot2c_f32_bf16 v233, 0x3f803f80, v27
  v_dot2c_f32_bf16 v235, v27, v27
  s_waitcnt lgkmcnt(0)
  v_and_b32 v124, v124, v125
  v_and_b32 v126, v126, v127
  v_and_b32 v124, v124, v126
  s_nop 0
  v_readfirstlane_b32 s14, v124
  s_nop 3
  s_cmp_lg_u32 s14, 0
  s_cbranch_scc1 k1_lf2_5_ok
  v_mov_b32 v18, 159904
k1_lf2_5:
  ds_read_b128 v[124:127], v18
  s_waitcnt lgkmcnt(0)
  v_and_b32 v124, v124, v125
  v_and_b32 v126, v126, v127
  v_and_b32 v124, v124, v126
  s_nop 0
  v_readfirstlane_b32 s14, v124
  s_nop 3
  s_cmp_eq_u32 s14, 0
  s_cbranch_scc1 k1_lf2_5
k1_lf2_5_ok:
  v_mfma_f32_32x32x16_bf16 v[64:79], v[44:47], v[28:31], v[64:79]
  ds_read_b128 v[24:27], v12 offset:0
  ds_read_b64_tr_b16 v[32:33], v17 offset:8192
  ds_read_b64_tr_b16 v[34:35], v17 offset:9728
  ds_read_b64_tr_b16 v[36:37], v17 offset:8320
  v_mfma_f32_32x32x16_bf16 v[80:95], v[28:31], v[48:51], v[80:95]
  ds_read_b64_tr_b16 v[38:39], v17 offset:9856
  ds_read_b64_tr_b16 v[40:41], v17 offset:8448
  ds_read_b64_tr_b16 v[42:43], v17 offset:9984
  v_mfma_f32_32x32x16_bf16 v[96:111], v[28:31], v[52:55], v[96:111]
  v_dot2c_f32_bf16 v236, 0x3f803f80, v44
  v_dot2c_f32_bf16 v237, 0x3f803f80, v48
  v_dot2c_f32_bf16 v238, 0x3f803f80, v52
  v_dot2c_f32_bf16 v116, 0x3f803f80, v45
  v_dot2c_f32_bf16 v117, 0x3f803f80, v49
  v_dot2c_f32_bf16 v118, 0x3f803f80, v53
  v_dot2c_f32_bf16 v236, 0x3f803f80, v46
  v_dot2c_f32_bf16 v237, 0x3f803f80, v50
  v_dot2c_f32_bf16 v238, 0x3f803f80, v54
  v_dot2c_f32_bf16 v116, 0x3f803f80, v47
  v_dot2c_f32_bf16 v117, 0x3f803f80, v51
  v_dot2c_f32_bf16 v118, 0x3f803f80, v55
  s_waitcnt lgkmcnt(0)
  s_lshl_b32 s14, s5, 2
  v_mov_b32 v120, s14
  buffer_load_dword v121, v120, s[48:51], 0 offen sc1
  v_mfma_f32_32x32x16_bf16 v[64:79], v[32:35], v[24:27], v[64:79]
  ds_read_b128 v[28:31], v13 offset:0
  ds_read_b64_tr_b16 v[44:45], v17 offset:14336
  ds_read_b64_tr_b16 v[46:47], v17 offset:15872
  ds_read_b64_tr_b16 v[48:49], v17 offset:14464
  v_mfma_f32_32x32x16_bf16 v[80:95], v[24:27], v[36:39], v[80:95]
  ds_read_b64_tr_b16 v[50:51], v17 offset:16000
  ds_read_b64_tr_b16 v[52:53], v17 offset:14592
  ds_read_b64_tr_b16 v[54:55], v17 offset:16128
  v_mfma_f32_32x32x16_bf16 v[96:111], v[24:27], v[40:43], v[96:111]
  v_dot2c_f32_bf16 v112, 0x3f803f80, v24
  v_dot2c_f32_bf16 v114, v24, v24
  v_dot2c_f32_bf16 v113, 0x3f803f80, v25
  v_dot2c_f32_bf16 v115, v25, v25
  v_dot2c_f32_bf16 v232, 0x3f803f80, v26
  v_dot2c_f32_bf16 v234, v26, v26
  v_dot2c_f32_bf16 v233, 0x3f803f80, v27
  v_dot2c_f32_bf16 v235, v27, v27
  s_waitcnt lgkmcnt(0)
  v_mfma_f32_32x32x16_bf16 v[64:79], v[44:47], v[28:31], v[64:79]
  ds_read_b128 v[24:27], v14 offset:0
  ds_read_b64_tr_b16 v[32:33], v17 offset:20480
  ds_read_b64_tr_b16 v[34:35], v17 offset:22016
  ds_read_b64_tr_b16 v[36:37], v17 offset:20608
  v_mfma_f32_32x32x16_bf16 v[80:95], v[28:31], v[48:51], v[80:95]
  ds_read_b64_tr_b16 v[38:39], v17 offset:22144
  ds_read_b64_tr_b16 v[40:41], v17 offset:20736
  ds_read_b64_tr_b16 v[42:43], v17 offset:22272
  v_mfma_f32_32x32x16_bf16 v[96:111], v[28:31], v[52:55], v[96:111]
  v_dot2c_f32_bf16 v236, 0x3f803f80, v44
  v_dot2c_f32_bf16 v237, 0x3f803f80, v48
  v_dot2c_f32_bf16 v238, 0x3f803f80, v52
  v_dot2c_f32_bf16 v116, 0x3f803f80, v45
  v_dot2c_f32_bf16 v117, 0x3f803f80, v49
  v_dot2c_f32_bf16 v118, 0x3f803f80, v53
  v_dot2c_f32_bf16 v236, 0x3f803f80, v46
  v_dot2c_f32_bf16 v237, 0x3f803f80, v50
  v_dot2c_f32_bf16 v238, 0x3f803f80, v54
  v_dot2c_f32_bf16 v116, 0x3f803f80, v47
  v_dot2c_f32_bf16 v117, 0x3f803f80, v51
  v_dot2c_f32_bf16 v118, 0x3f803f80, v55
  s_waitcnt lgkmcnt(0)
  v_mfma_f32_32x32x16_bf16 v[64:79], v[32:35], v[24:27], v[64:79]
  ds_read_b128 v[28:31], v15 offset:0
  ds_read_b64_tr_b16 v[44:45], v17 offset:26624
  ds_read_b64_tr_b16 v[46:47], v17 offset:28160
  ds_read_b64_tr_b16 v[48:49], v17 offset:26752
  v_mfma_f32_32x32x16_bf16 v[80:95], v[24:27], v[36:39], v[80:95]
  ds_read_b64_tr_b16 v[50:51], v17 offset:28288
  ds_read_b64_tr_b16 v[52:53], v17 offset:26880
  ds_read_b64_tr_b16 v[54:55], v17 offset:28416
  ds_read_b128 v[124:127], v119 offset:176
  v_mfma_f32_32x32x16_bf16 v[96:111], v[24:27], v[40:43], v[96:111]
  v_dot2c_f32_bf16 v112, 0x3f803f80, v24
  v_dot2c_f32_bf16 v114, v24, v24
  v_dot2c_f32_bf16 v113, 0x3f803f80, v25
  v_dot2c_f32_bf16 v115, v25, v25
  v_dot2c_f32_bf16 v232, 0x3f803f80, v26
  v_dot2c_f32_bf16 v234, v26, v26
  v_dot2c_f32_bf16 v233, 0x3f803f80, v27
  v_dot2c_f32_bf16 v235, v27, v27
  s_waitcnt lgkmcnt(0)
  v_and_b32 v124, v124, v125
  v_and_b32 v126, v126, v127
  v_and_b32 v124, v124, v126
  s_nop 0
  v_readfirstlane_b32 s14, v124
  s_nop 3
  s_cmp_lg_u32 s14, 0
  s_cbranch_scc1 k1_lf2_6_ok
  v_mov_b32 v18, 159920
k1_lf2_6:
  ds_read_b128 v[124:127], v18
  s_waitcnt lgkmcnt(0)
  v_and_b32 v124, v124, v125
  v_and_b32 v126, v126, v127
  v_and_b32 v124, v124, v126
  s_nop 0
  v_readfirstlane_b32 s14, v124
  s_nop 3
  s_cmp_eq_u32 s14, 0
  s_cbranch_scc1 k1_lf2_6
k1_lf2_6_ok:
  v_mfma_f32_32x32x16_bf16 v[64:79], v[44:47], v[28:31], v[64:79]
  ds_read_b128 v[24:27], v12 offset:32768
  ds_read_b64_tr_b16 v[32:33], v17 offset:40960
  ds_read_b64_tr_b16 v[34:35], v17 offset:42496
  ds_read_b64_tr_b16 v[36:37], v17 offset:41088
  v_mfma_f32_32x32x16_bf16 v[80:95], v[28:31], v[48:51], v[80:95]
  ds_read_b64_tr_b16 v[38:39], v17 offset:42624
  ds_read_b64_tr_b16 v[40:41], v17 offset:41216
  ds_read_b64_tr_b16 v[42:43], v17 offset:42752
  v_mfma_f32_32x32x16_bf16 v[96:111], v[28:31], v[52:55], v[96:111]
  v_dot2c_f32_bf16 v236, 0x3f803f80, v44
  v_dot2c_f32_bf16 v237, 0x3f803f80, v48
  v_dot2c_f32_bf16 v238, 0x3f803f80, v52
  v_dot2c_f32_bf16 v116, 0x3f803f80, v45
  v_dot2c_f32_bf16 v117, 0x3f803f80, v49
  v_dot2c_f32_bf16 v118, 0x3f803f80, v53
  v_dot2c_f32_bf16 v236, 0x3f803f80, v46
  v_dot2c_f32_bf16 v237, 0x3f803f80, v50
  v_dot2c_f32_bf16 v238, 0x3f803f80, v54
  v_dot2c_f32_bf16 v116, 0x3f803f80, v47
  v_dot2c_f32_bf16 v117, 0x3f803f80, v51
  v_dot2c_f32_bf16 v118, 0x3f803f80, v55
  s_waitcnt lgkmcnt(0)
  v_mov_b32 v18, 159752
  v_mov_b32 v123, 1
  ds_write_b32 v18, v123
  v_mfma_f32_32x32x16_bf16 v[64:79], v[32:35], v[24:27], v[64:79]
  ds_read_b128 v[28:31], v13 offset:32768
  ds_read_b64_tr_b16 v[44:45], v17 offset:47104
  ds_read_b64_tr_b16 v[46:47], v17 offset:48640
  ds_read_b64_tr_b16 v[48:49], v17 offset:47232
  v_mfma_f32_32x32x16_bf16 v[80:95], v[24:27], v[36:39], v[80:95]
  ds_read_b64_tr_b16 v[50:51], v17 offset:48768
  ds_read_b64_tr_b16 v[52:53], v17 offset:47360
  ds_read_b64_tr_b16 v[54:55], v17 offset:48896
  v_mfma_f32_32x32x16_bf16 v[96:111], v[24:27], v[40:43], v[96:111]
  v_dot2c_f32_bf16 v112, 0x3f803f80, v24
  v_dot2c_f32_bf16 v114, v24, v24
  v_dot2c_f32_bf16 v113, 0x3f803f80, v25
  v_dot2c_f32_bf16 v115, v25, v25
  v_dot2c_f32_bf16 v232, 0x3f803f80, v26
  v_dot2c_f32_bf16 v234, v26, v26
  v_dot2c_f32_bf16 v233, 0x3f803f80, v27
  v_dot2c_f32_bf16 v235, v27, v27
  s_waitcnt lgkmcnt(0)
  v_mfma_f32_32x32x16_bf16 v[64:79], v[44:47], v[28:31], v[64:79]
  ds_read_b128 v[24:27], v14 offset:32768
  ds_read_b64_tr_b16 v[32:33], v17 offset:53248
  ds_read_b64_tr_b16 v[34:35], v17 offset:54784
  ds_read_b64_tr_b16 v[36:37], v17 offset:53376
  v_mfma_f32_32x32x16_bf16 v[80:95], v[28:31], v[48:51], v[80:95]
  ds_read_b64_tr_b16 v[38:39], v17 offset:54912
  ds_read_b64_tr_b16 v[40:41], v17 offset:53504
  ds_read_b64_tr_b16 v[42:43], v17 offset:55040
  v_mfma_f32_32x32x16_bf16 v[96:111], v[28:31], v[52:55], v[96:111]
  v_dot2c_f32_bf16 v236, 0x3f803f80, v44
  v_dot2c_f32_bf16 v237, 0x3f803f80, v48
  v_dot2c_f32_bf16 v238, 0x3f803f80, v52
  v_dot2c_f32_bf16 v116, 0x3f803f80, v45
  v_dot2c_f32_bf16 v117, 0x3f803f80, v49
  v_dot2c_f32_bf16 v118, 0x3f803f80, v53
  v_dot2c_f32_bf16 v236, 0x3f803f80, v46
  v_dot2c_f32_bf16 v237, 0x3f803f80, v50
  v_dot2c_f32_bf16 v238, 0x3f803f80, v54
  v_dot2c_f32_bf16 v116, 0x3f803f80, v47
  v_dot2c_f32_bf16 v117, 0x3f803f80, v51
  v_dot2c_f32_bf16 v118, 0x3f803f80, v55
  s_waitcnt lgkmcnt(0)
  v_mfma_f32_32x32x16_bf16 v[64:79], v[32:35], v[24:27], v[64:79]
  ds_read_b128 v[28:31], v15 offset:32768
  ds_read_b64_tr_b16 v[44:45], v17 offset:59392
  ds_read_b64_tr_b16 v[46:47], v17 offset:60928
  ds_read_b64_tr_b16 v[48:49], v17 offset:59520
  v_mfma_f32_32x32x16_bf16 v[80:95], v[24:27], v[36:39], v[80:95]
  ds_read_b64_tr_b16 v[50:51], v17 offset:61056
  ds_read_b64_tr_b16 v[52:53], v17 offset:59648
  ds_read_b64_tr_b16 v[54:55], v17 offset:61184
  v_mfma_f32_32x32x16_bf16 v[96:111], v[24:27], v[40:43], v[96:111]
  v_dot2c_f32_bf16 v112, 0x3f803f80, v24
  v_dot2c_f32_bf16 v114, v24, v24
  v_dot2c_f32_bf16 v113, 0x3f803f80, v25
  v_dot2c_f32_bf16 v115, v25, v25
  v_dot2c_f32_bf16 v232, 0x3f803f80, v26
  v_dot2c_f32_bf16 v234, v26, v26
  v_dot2c_f32_bf16 v233, 0x3f803f80, v27
  v_dot2c_f32_bf16 v235, v27, v27
  s_waitcnt lgkmcnt(0)
  v_mfma_f32_32x32x16_bf16 v[64:79], v[44:47], v[28:31], v[64:79]
  v_mfma_f32_32x32x16_bf16 v[80:95], v[28:31], v[48:51], v[80:95]
  v_mfma_f32_32x32x16_bf16 v[96:111], v[28:31], v[52:55], v[96:111]
  v_dot2c_f32_bf16 v236, 0x3f803f80, v44
  v_dot2c_f32_bf16 v237, 0x3f803f80, v48
  v_dot2c_f32_bf16 v238, 0x3f803f80, v52
  v_dot2c_f32_bf16 v116, 0x3f803f80, v45
  v_dot2c_f32_bf16 v117, 0x3f803f80, v49
  v_dot2c_f32_bf16 v118, 0x3f803f80, v53
  v_dot2c_f32_bf16 v236, 0x3f803f80, v46
  v_dot2c_f32_bf16 v237, 0x3f803f80, v50
  v_dot2c_f32_bf16 v238, 0x3f803f80, v54
  v_dot2c_f32_bf16 v116, 0x3f803f80, v47
  v_dot2c_f32_bf16 v117, 0x3f803f80, v51
  v_dot2c_f32_bf16 v118, 0x3f803f80, v55
  s_waitcnt lgkmcnt(0)
  s_nop 2
  v_add_f32 v112, v112, v113
  v_add_f32 v232, v232, v233
  v_add_f32 v114, v114, v115
  v_add_f32 v234, v234, v235
  v_add_f32 v116, v116, v236
  v_add_f32 v117, v117, v237
  v_add_f32 v118, v118, v238
  v_add_f32 v112, v112, v232
  v_add_f32 v114, v114, v234
  v_mov_b32 v24, v112
  v_mov_b32 v25, v114
  v_mov_b32 v26, v116
  v_mov_b32 v27, v117
  v_mov_b32 v28, v118
  s_nop 1
  v_permlane32_swap_b32 v112, v24
  v_permlane32_swap_b32 v114, v25
  v_permlane32_swap_b32 v116, v26
  v_permlane32_swap_b32 v117, v27
  v_permlane32_swap_b32 v118, v28
  s_nop 1
  v_add_f32 v112, v112, v24
  v_add_f32 v114, v114, v25
  v_add_f32 v116, v116, v26
  v_add_f32 v117, v117, v27
  v_add_f32 v118, v118, v28
  ds_write_b32 v228, v112 offset:512
  ds_write_b32 v228, v114 offset:640
  ds_write_b32 v228, v116 offset:1408
  ds_write_b32 v228, v117 offset:1536
  ds_write_b32 v228, v118 offset:1664
  v_mov_b32 v18, 159768
  v_mov_b32 v123, 1
  ds_write_b32 v18, v123
  v_mov_b32 v18, 159760
k1_sp2a:
  ds_read_b128 v[124:127], v18
  s_waitcnt lgkmcnt(0)
  v_and_b32 v124, v124, v125
  v_and_b32 v126, v126, v127
  v_and_b32 v124, v124, v126
  s_nop 0
  v_readfirstlane_b32 s14, v124
  s_nop 3
  s_cmp_eq_u32 s14, 0
  s_cbranch_scc1 k1_sp2a
  ds_read_b32 v24, v228 offset:768
  ds_read_b32 v25, v228 offset:896
  ds_read_b32 v26, v228 offset:1024
  ds_read_b32 v27, v228 offset:1152
  ds_read_b32 v28, v228 offset:1280
  s_waitcnt lgkmcnt(0)
  v_add_f32 v112, v112, v24
  v_add_f32 v114, v114, v25
  v_add_f32 v116, v116, v26
  v_add_f32 v117, v117, v27
  v_add_f32 v118, v118, v28
  ds_write_b32 v229, v116 offset:1280
  v_mul_f32 v112, 0x3b000000, v112
  v_mul_f32 v114, 0x3b000000, v114
  v_fma_f32 v114, -v112, v112, v114
  v_max_f32 v114, 0, v114
  v_add_f32 v114, 0x3727c5ac, v114
  v_rsq_f32 v114, v114
  s_nop 0
  v_mul_f32 v112, v112, v114
  v_sub_f32 v112, 0, v112
  ds_write_b32 v229, v114 offset:1024
  ds_write_b32 v229, v112 offset:1152
  v_mov_b32 v184, v114
  v_mov_b32 v186, v112
  v_mov_b32 v188, v117
  v_mov_b32 v190, v118
  s_waitcnt lgkmcnt(0)
  ds_read_b128 v[128:131], v230 offset:1024
  ds_read_b128 v[144:147], v230 offset:1152
  ds_read_b128 v[132:135], v230 offset:1056
  ds_read_b128 v[148:151], v230 offset:1184
  ds_read_b128 v[136:139], v230 offset:1088
  ds_read_b128 v[152:155], v230 offset:1216
  ds_read_b128 v[140:143], v230 offset:1120
  ds_read_b128 v[156:159], v230 offset:1248
  ds_read_b128 v[160:163], v230 offset:1280
  ds_read_b128 v[164:167], v230 offset:1312
  ds_read_b128 v[168:171], v230 offset:1344
  ds_read_b128 v[172:175], v230 offset:1376
  ds_read_b128 v[124:127], v119
  s_waitcnt lgkmcnt(5)
  v_pk_mul_f32 v[24:25], v[144:145], v[190:191] op_sel_hi:[1,0]
  v_pk_mul_f32 v[26:27], v[146:147], v[190:191] op_sel_hi:[1,0]
  v_pk_mul_f32 v[28:29], v[148:149], v[190:191] op_sel_hi:[1,0]
  v_pk_mul_f32 v[30:31], v[150:151], v[190:191] op_sel_hi:[1,0]
  v_pk_mul_f32 v[32:33], v[152:153], v[190:191] op_sel_hi:[1,0]
  v_pk_mul_f32 v[34:35], v[154:155], v[190:191] op_sel_hi:[1,0]
  v_pk_mul_f32 v[36:37], v[156:157], v[190:191] op_sel_hi:[1,0]
  v_pk_mul_f32 v[38:39], v[158:159], v[190:191] op_sel_hi:[1,0]
  v_pk_fma_f32 v[96:97], v[96:97], v[128:129], v[24:25]
  v_pk_fma_f32 v[98:99], v[98:99], v[130:131], v[26:27]
  v_pk_fma_f32 v[100:101], v[100:101], v[132:133], v[28:29]
  v_pk_fma_f32 v[102:103], v[102:103], v[134:135], v[30:31]
  v_pk_fma_f32 v[104:105], v[104:105], v[136:137], v[32:33]
  v_pk_fma_f32 v[106:107], v[106:107], v[138:139], v[34:35]
  v_pk_fma_f32 v[108:109], v[108:109], v[140:141], v[36:37]
  v_pk_fma_f32 v[110:111], v[110:111], v[142:143], v[38:39]
  v_pk_fma_f32 v[40:41], v[144:145], v[188:189], v[176:177] op_sel_hi:[1,0,1]
  v_pk_fma_f32 v[42:43], v[146:147], v[188:189], v[176:177] op_sel_hi:[1,0,1]
  v_pk_fma_f32 v[44:45], v[148:149], v[188:189], v[176:177] op_sel_hi:[1,0,1]
  v_pk_fma_f32 v[46:47], v[150:151], v[188:189], v[176:177] op_sel_hi:[1,0,1]
  v_pk_fma_f32 v[48:49], v[152:153], v[188:189], v[176:177] op_sel_hi:[1,0,1]
  v_pk_fma_f32 v[50:51], v[154:155], v[188:189], v[176:177] op_sel_hi:[1,0,1]
  v_pk_fma_f32 v[52:53], v[156:157], v[188:189], v[176:177] op_sel_hi:[1,0,1]
  v_pk_fma_f32 v[54:55], v[158:159], v[188:189], v[176:177] op_sel_hi:[1,0,1]
  v_pk_fma_f32 v[80:81], v[80:81], v[128:129], v[40:41]
  v_pk_fma_f32 v[82:83], v[82:83], v[130:131], v[42:43]
  v_pk_fma_f32 v[84:85], v[84:85], v[132:133], v[44:45]
  v_pk_fma_f32 v[86:87], v[86:87], v[134:135], v[46:47]
  v_pk_fma_f32 v[88:89], v[88:89], v[136:137], v[48:49]
  v_pk_fma_f32 v[90:91], v[90:91], v[138:139], v[50:51]
  v_pk_fma_f32 v[92:93], v[92:93], v[140:141], v[52:53]
  v_pk_fma_f32 v[94:95], v[94:95], v[142:143], v[54:55]
  v_pk_fma_f32 v[40:41], v[80:81], v[178:179], v[180:181]
  v_pk_fma_f32 v[42:43], v[82:83], v[178:179], v[180:181]
  v_pk_fma_f32 v[44:45], v[84:85], v[178:179], v[180:181]
  v_pk_fma_f32 v[46:47], v[86:87], v[178:179], v[180:181]
  v_pk_fma_f32 v[48:49], v[88:89], v[178:179], v[180:181]
  v_pk_fma_f32 v[50:51], v[90:91], v[178:179], v[180:181]
  v_pk_fma_f32 v[52:53], v[92:93], v[178:179], v[180:181]
  v_pk_fma_f32 v[54:55], v[94:95], v[178:179], v[180:181]
  v_exp_f32_e64 v40, v40 clamp
  v_exp_f32_e64 v41, v41 clamp
  v_exp_f32_e64 v42, v42 clamp
  v_exp_f32_e64 v43, v43 clamp
  v_exp_f32_e64 v44, v44 clamp
  v_exp_f32_e64 v45, v45 clamp
  v_exp_f32_e64 v46, v46 clamp
  v_exp_f32_e64 v47, v47 clamp
  v_exp_f32_e64 v48, v48 clamp
  v_exp_f32_e64 v49, v49 clamp
  v_exp_f32_e64 v50, v50 clamp
  v_exp_f32_e64 v51, v51 clamp
  v_exp_f32_e64 v52, v52 clamp
  v_exp_f32_e64 v53, v53 clamp
  v_exp_f32_e64 v54, v54 clamp
  v_exp_f32_e64 v55, v55 clamp
  v_pk_add_f32 v[40:41], v[40:41], v[182:183]
  v_pk_add_f32 v[42:43], v[42:43], v[182:183]
  v_pk_add_f32 v[44:45], v[44:45], v[182:183]
  v_pk_add_f32 v[46:47], v[46:47], v[182:183]
  v_pk_add_f32 v[48:49], v[48:49], v[182:183]
  v_pk_add_f32 v[50:51], v[50:51], v[182:183]
  v_pk_add_f32 v[52:53], v[52:53], v[182:183]
  v_pk_add_f32 v[54:55], v[54:55], v[182:183]
  v_max_f32 v80, v80, v40
  v_max_f32 v81, v81, v41
  v_max_f32 v82, v82, v42
  v_max_f32 v83, v83, v43
  v_max_f32 v84, v84, v44
  v_max_f32 v85, v85, v45
  v_max_f32 v86, v86, v46
  v_max_f32 v87, v87, v47
  v_max_f32 v88, v88, v48
  v_max_f32 v89, v89, v49
  v_max_f32 v90, v90, v50
  v_max_f32 v91, v91, v51
  v_max_f32 v92, v92, v52
  v_max_f32 v93, v93, v53
  v_max_f32 v94, v94, v54
  v_max_f32 v95, v95, v55
  v_cvt_pk_bf16_f32 v216, v96, v97
  v_cvt_pk_bf16_f32 v217, v98, v99
  v_cvt_pk_bf16_f32 v218, v100, v101
  v_cvt_pk_bf16_f32 v219, v102, v103
  v_cvt_pk_bf16_f32 v220, v104, v105
  v_cvt_pk_bf16_f32 v221, v106, v107
  v_cvt_pk_bf16_f32 v222, v108, v109
  v_cvt_pk_bf16_f32 v223, v110, v111
  v_cvt_pk_bf16_f32 v208, v80, v81
  v_cvt_pk_bf16_f32 v209, v82, v83
  v_cvt_pk_bf16_f32 v210, v84, v85
  v_cvt_pk_bf16_f32 v211, v86, v87
  v_cvt_pk_bf16_f32 v212, v88, v89
  v_cvt_pk_bf16_f32 v213, v90, v91
  v_cvt_pk_bf16_f32 v214, v92, v93
  v_cvt_pk_bf16_f32 v215, v94, v95
  s_nop 1
  v_mfma_f32_32x32x16_bf16 v[80:95], v[216:219], v[208:211], 0
  v_mfma_f32_32x32x16_bf16 v[96:111], v[224:227], v[208:211], 0
  v_mfma_f32_32x32x16_bf16 v[80:95], v[220:223], v[212:215], v[80:95]
  v_mfma_f32_32x32x16_bf16 v[96:111], v[224:227], v[212:215], v[96:111]
  v_and_b32 v22, 16, v0
  v_cmp_ne_u32 vcc, 0, v22
  v_lshlrev_b32 v19, 2, v0
  v_add_u32 v19, 73728, v19
  v_bfe_u32 v9, v0, 4, 1
  s_movk_i32 s13, 1088
  v_mul_lo_u32 v9, v9, s13
  v_and_b32 v10, 15, v0
  v_lshl_add_u32 v9, v10, 2, v9
  v_lshl_add_u32 v10, v21, 8, v9
  s_lshl_b32 s13, s5, 2
  s_add_u32 s13, s13, 0
  s_mulk_i32 s13, 1088
  s_waitcnt lgkmcnt(0)
  v_and_b32 v124, v124, v125
  v_and_b32 v126, v126, v127
  v_and_b32 v124, v124, v126
  s_nop 0
  v_readfirstlane_b32 s14, v124
  s_nop 3
  s_cmp_lg_u32 s14, 0
  s_cbranch_scc1 k1_d62_ok
  v_mov_b32 v18, 159744
k1_d62:
  ds_read_b128 v[124:127], v18
  s_waitcnt lgkmcnt(0)
  v_and_b32 v124, v124, v125
  v_and_b32 v126, v126, v127
  v_and_b32 v124, v124, v126
  s_nop 0
  v_readfirstlane_b32 s14, v124
  s_nop 3
  s_cmp_eq_u32 s14, 0
  s_cbranch_scc1 k1_d62
k1_d62_ok:
  v_cndmask_b32 v24, v80, v88, vcc
  v_cndmask_b32 v25, v81, v89, vcc
  v_cndmask_b32 v26, v82, v90, vcc
  v_cndmask_b32 v27, v83, v91, vcc
  v_cndmask_b32 v28, v84, v92, vcc
  v_cndmask_b32 v29, v85, v93, vcc
  v_cndmask_b32 v30, v86, v94, vcc
  v_cndmask_b32 v31, v87, v95, vcc
  ds_write_b32 v19, v24 offset:2304
  ds_write_b32 v19, v25 offset:2560
  ds_write_b32 v19, v26 offset:2816
  ds_write_b32 v19, v27 offset:3072
  ds_write_b32 v19, v96 offset:4352
  v_mov_b32 v18, 159784
  v_mov_b32 v123, 1
  ds_write_b32 v18, v123
  v_mov_b32 v18, 159776
k1_sp2c:
  ds_read_b32 v122, v18
  s_waitcnt lgkmcnt(0)
  v_readfirstlane_b32 s14, v122
  s_nop 3
  s_cmp_eq_u32 s14, 0
  s_cbranch_scc1 k1_sp2c
  ds_read_b32 v32, v19 offset:1024
  ds_read_b32 v33, v19 offset:1280
  ds_read_b32 v34, v19 offset:1536
  ds_read_b32 v35, v19 offset:1792
  s_waitcnt vmcnt(0)
  s_waitcnt lgkmcnt(0)
  v_add_f32 v28, v28, v32
  v_add_f32 v29, v29, v33
  v_add_f32 v30, v30, v34
  v_add_f32 v31, v31, v35
  s_mov_b32 s15, 0
k1_poll2:
  v_readfirstlane_b32 s14, v121
  s_add_u32 s15, s15, 1
  s_nop 2
  s_cmp_lg_u32 s14, 0
  s_cbranch_scc1 k1_go2
  s_cmp_ge_u32 s15, 0x20000
  s_cbranch_scc1 k1_go2
  s_sleep 2
  buffer_load_dword v121, v120, s[48:51], 0 offen sc1
  s_waitcnt vmcnt(0)
  s_branch k1_poll2
k1_go2:
  buffer_atomic_add_f32 v28, v10, s[44:47], s13 offen offset:512
  buffer_atomic_add_f32 v29, v10, s[44:47], s13 offen offset:576
  buffer_atomic_add_f32 v30, v10, s[44:47], s13 offen offset:640
  buffer_atomic_add_f32 v31, v10, s[44:47], s13 offen offset:704
  v_pk_fma_f32 v[40:41], v[160:161], v[186:187], v[176:177] op_sel_hi:[1,0,1]
  v_pk_fma_f32 v[42:43], v[162:163], v[186:187], v[176:177] op_sel_hi:[1,0,1]
  v_pk_fma_f32 v[44:45], v[164:165], v[186:187], v[176:177] op_sel_hi:[1,0,1]
  v_pk_fma_f32 v[46:47], v[166:167], v[186:187], v[176:177] op_sel_hi:[1,0,1]
  v_pk_fma_f32 v[48:49], v[168:169], v[186:187], v[176:177] op_sel_hi:[1,0,1]
  v_pk_fma_f32 v[50:51], v[170:171], v[186:187], v[176:177] op_sel_hi:[1,0,1]
  v_pk_fma_f32 v[52:53], v[172:173], v[186:187], v[176:177] op_sel_hi:[1,0,1]
  v_pk_fma_f32 v[54:55], v[174:175], v[186:187], v[176:177] op_sel_hi:[1,0,1]
  v_pk_fma_f32 v[64:65], v[64:65], v[184:185], v[40:41] op_sel_hi:[1,0,1]
  v_pk_fma_f32 v[66:67], v[66:67], v[184:185], v[42:43] op_sel_hi:[1,0,1]
  v_pk_fma_f32 v[68:69], v[68:69], v[184:185], v[44:45] op_sel_hi:[1,0,1]
  v_pk_fma_f32 v[70:71], v[70:71], v[184:185], v[46:47] op_sel_hi:[1,0,1]
  v_pk_fma_f32 v[72:73], v[72:73], v[184:185], v[48:49] op_sel_hi:[1,0,1]
  v_pk_fma_f32 v[74:75], v[74:75], v[184:185], v[50:51] op_sel_hi:[1,0,1]
  v_pk_fma_f32 v[76:77], v[76:77], v[184:185], v[52:53] op_sel_hi:[1,0,1]
  v_pk_fma_f32 v[78:79], v[78:79], v[184:185], v[54:55] op_sel_hi:[1,0,1]
  v_pk_fma_f32 v[40:41], v[64:65], v[178:179], v[180:181]
  v_pk_fma_f32 v[42:43], v[66:67], v[178:179], v[180:181]
  v_pk_fma_f32 v[44:45], v[68:69], v[178:179], v[180:181]
  v_pk_fma_f32 v[46:47], v[70:71], v[178:179], v[180:181]
  v_pk_fma_f32 v[48:49], v[72:73], v[178:179], v[180:181]
  v_pk_fma_f32 v[50:51], v[74:75], v[178:179], v[180:181]
  v_pk_fma_f32 v[52:53], v[76:77], v[178:179], v[180:181]
  v_pk_fma_f32 v[54:55], v[78:79], v[178:179], v[180:181]
  v_exp_f32_e64 v40, v40 clamp
  v_exp_f32_e64 v41, v41 clamp
  v_exp_f32_e64 v42, v42 clamp
  v_exp_f32_e64 v43, v43 clamp
  v_exp_f32_e64 v44, v44 clamp
  v_exp_f32_e64 v45, v45 clamp
  v_exp_f32_e64 v46, v46 clamp
  v_exp_f32_e64 v47, v47 clamp
  v_exp_f32_e64 v48, v48 clamp
  v_exp_f32_e64 v49, v49 clamp
  v_exp_f32_e64 v50, v50 clamp
  v_exp_f32_e64 v51, v51 clamp
  v_exp_f32_e64 v52, v52 clamp
  v_exp_f32_e64 v53, v53 clamp
  v_exp_f32_e64 v54, v54 clamp
  v_exp_f32_e64 v55, v55 clamp
  v_pk_add_f32 v[40:41], v[40:41], v[182:183]
  v_pk_add_f32 v[42:43], v[42:43], v[182:183]
  v_pk_add_f32 v[44:45], v[44:45], v[182:183]
  v_pk_add_f32 v[46:47], v[46:47], v[182:183]
  v_pk_add_f32 v[48:49], v[48:49], v[182:183]
  v_pk_add_f32 v[50:51], v[50:51], v[182:183]
  v_pk_add_f32 v[52:53], v[52:53], v[182:183]
  v_pk_add_f32 v[54:55], v[54:55], v[182:183]
  v_max_f32 v64, v64, v40
  v_max_f32 v65, v65, v41
  v_max_f32 v66, v66, v42
  v_max_f32 v67, v67, v43
  v_max_f32 v68, v68, v44
  v_max_f32 v69, v69, v45
  v_max_f32 v70, v70, v46
  v_max_f32 v71, v71, v47
  v_max_f32 v72, v72, v48
  v_max_f32 v73, v73, v49
  v_max_f32 v74, v74, v50
  v_max_f32 v75, v75, v51
  v_max_f32 v76, v76, v52
  v_max_f32 v77, v77, v53
  v_max_f32 v78, v78, v54
  v_max_f32 v79, v79, v55
  v_cvt_pk_bf16_f32 v200, v64, v65
  v_cvt_pk_bf16_f32 v201, v66, v67
  v_cvt_pk_bf16_f32 v202, v68, v69
  v_cvt_pk_bf16_f32 v203, v70, v71
  v_cvt_pk_bf16_f32 v204, v72, v73
  v_cvt_pk_bf16_f32 v205, v74, v75
  v_cvt_pk_bf16_f32 v206, v76, v77
  v_cvt_pk_bf16_f32 v207, v78, v79
  s_add_u32 s52, s34, 1048576
  s_addc_u32 s53, s35, 0
  s_mov_b32 s54, 2097152
  s_mov_b32 s55, 0x20000
  s_lshl_b32 s12, s6, 1
  s_add_u32 s12, s12, 1
  s_lshl_b32 s12, s12, 5
  s_lshl_b32 s13, s5, 2
  s_add_u32 s12, s12, s13
  s_add_u32 s12, s12, 0
  s_lshl_b32 s12, s12, 10
  v_lshlrev_b32 v18, 4, v0
  buffer_store_dwordx4 v[200:203], v18, s[52:55], s12 offen sc1
  buffer_store_dwordx4 v[204:207], v18, s[52:55], s12 offen offset:1024 sc1
  s_branch k1_fin
k1_loader:
  s_mov_b32 s36, s16
  s_mov_b32 s37, s17
  s_mov_b32 s38, 2097152
  s_mov_b32 s39, 0x20000
  s_mov_b32 s40, s18
  s_mov_b32 s41, s19
  s_mov_b32 s42, 1572864
  s_mov_b32 s43, 0x20000
  s_cmp_lg_u32 s6, 0
  s_cbranch_scc1 k1_nozero
  v_lshl_add_u32 v8, v1, 6, v0
  v_lshlrev_b32 v8, 4, v8
  v_mov_b32 v12, 0
  v_mov_b32 v13, 0
  v_mov_b32 v14, 0
  v_mov_b32 v15, 0
  s_mul_i32 s12, s5, 4352
  buffer_store_dwordx4 v[12:15], v8, s[44:47], s12 offen sc1
  v_add_u32 v8, 4096, v8
  v_cmp_gt_u32 vcc, 4352, v8
  s_and_saveexec_b64 s[14:15], vcc
  s_cbranch_execz k1_z2
  buffer_store_dwordx4 v[12:15], v8, s[44:47], s12 offen sc1
k1_z2:
  s_mov_b64 exec, s[14:15]
k1_nozero:
  s_cmp_lg_u32 s2, 2
  s_cbranch_scc1 k1_nocz
  s_cmp_lg_u32 s3, 0
  s_cbranch_scc1 k1_nocz
  s_add_u32 s52, s34, 491520
  s_addc_u32 s53, s35, 0
  s_mov_b32 s54, 4096
  s_mov_b32 s55, 0x20000
  v_lshlrev_b32 v8, 7, v0
  v_mov_b32 v12, 0
  buffer_store_dword v12, v8, s[52:55], 0 offen sc1
k1_nocz:
  v_lshrrev_b32 v4, 3, v0
  v_and_b32 v5, 7, v0
  v_lshrrev_b32 v6, 4, v0
  v_xor_b32 v5, v5, v6
  v_lshlrev_b32 v5, 4, v5
  v_lshl_add_u32 v2, v4, 10, v5
  v_xor_b32 v3, 64, v2
  s_lshl_b32 s7, s6, 16
  s_lshl_b32 s12, s3, 14
  s_add_u32 s7, s7, s12
  s_mul_i32 s8, s3, 49152
  s_lshl_b32 s12, s5, 7
  s_add_u32 s8, s8, s12
  s_lshl_b32 s9, s3, 11
  s_mul_i32 s10, s3, 6144
  s_add_u32 s10, s10, 8192
  s_and_b32 s58, s6, 7
  s_add_u32 s57, s58, 0
  s_and_b32 s57, s57, 7
  s_mul_i32 s57, s57, 128
  s_add_u32 s57, s57, s7
  s_add_u32 m0, s9, 0
  s_add_u32 s13, s57, 0
  buffer_load_dwordx4 v2, s[36:39], s13 offen lds
  s_add_u32 m0, s9, 1024
  s_add_u32 s13, s57, 8192
  buffer_load_dwordx4 v3, s[36:39], s13 offen lds
  s_movk_i32 s12, 2731
  s_movk_i32 s13, 3072
  v_add_u32 v8, 0, v0
  v_mul_lo_u32 v9, v8, s12
  v_lshrrev_b32 v9, 16, v9
  v_mul_u32_u24 v10, 24, v9
  v_sub_u32 v10, v8, v10
  v_mul_lo_u32 v4, v9, s13
  v_lshrrev_b32 v11, 3, v10
  v_lshl_add_u32 v4, v11, 10, v4
  v_bfe_u32 v11, v10, 2, 1
  v_bfe_u32 v12, v9, 1, 1
  v_xor_b32 v11, v11, v12
  v_lshl_add_u32 v4, v11, 6, v4
  v_and_b32 v11, 3, v10
  v_lshl_add_u32 v4, v11, 4, v4
  v_add_u32 v8, 64, v0
  v_mul_lo_u32 v9, v8, s12
  v_lshrrev_b32 v9, 16, v9
  v_mul_u32_u24 v10, 24, v9
  v_sub_u32 v10, v8, v10
  v_mul_lo_u32 v5, v9, s13
  v_lshrrev_b32 v11, 3, v10
  v_lshl_add_u32 v5, v11, 10, v5
  v_bfe_u32 v11, v10, 2, 1
  v_bfe_u32 v12, v9, 1, 1
  v_xor_b32 v11, v11, v12
  v_lshl_add_u32 v5, v11, 6, v5
  v_and_b32 v11, 3, v10
  v_lshl_add_u32 v5, v11, 4, v5
  v_add_u32 v8, 128, v0
  v_mul_lo_u32 v9, v8, s12
  v_lshrrev_b32 v9, 16, v9
  v_mul_u32_u24 v10, 24, v9
  v_sub_u32 v10, v8, v10
  v_mul_lo_u32 v6, v9, s13
  v_lshrrev_b32 v11, 3, v10
  v_lshl_add_u32 v6, v11, 10, v6
  v_bfe_u32 v11, v10, 2, 1
  v_bfe_u32 v12, v9, 1, 1
  v_xor_b32 v11, v11, v12
  v_lshl_add_u32 v6, v11, 6, v6
  v_and_b32 v11, 3, v10
  v_lshl_add_u32 v6, v11, 4, v6
  s_add_u32 s56, s58, 0
  s_and_b32 s56, s56, 7
  s_mul_i32 s56, s56, 196608
  s_add_u32 s56, s56, s8
  s_add_u32 m0, s10, 0
  s_add_u32 s12, s56, 0
  buffer_load_dwordx4 v4, s[40:43], s12 offen lds
  s_add_u32 m0, s10, 1024
  s_nop 0
  buffer_load_dwordx4 v5, s[40:43], s12 offen lds
  s_add_u32 m0, s10, 2048
  s_nop 0
  buffer_load_dwordx4 v6, s[40:43], s12 offen lds
  s_add_u32 m0, s10, 3072
  s_add_u32 s12, s56, 24576
  buffer_load_dwordx4 v4, s[40:43], s12 offen lds
  s_add_u32 m0, s10, 4096
  s_nop 0
  buffer_load_dwordx4 v5, s[40:43], s12 offen lds
  s_add_u32 m0, s10, 5120
  s_nop 0
  buffer_load_dwordx4 v6, s[40:43], s12 offen lds
  s_add_u32 s57, s58, 1
  s_and_b32 s57, s57, 7
  s_mul_i32 s57, s57, 128
  s_add_u32 s57, s57, s7
  s_add_u32 m0, s9, 32768
  s_add_u32 s13, s57, 0
  buffer_load_dwordx4 v2, s[36:39], s13 offen lds
  s_add_u32 m0, s9, 33792
  s_add_u32 s13, s57, 8192
  buffer_load_dwordx4 v3, s[36:39], s13 offen lds
  s_add_u32 s56, s58, 1
  s_and_b32 s56, s56, 7
  s_mul_i32 s56, s56, 196608
  s_add_u32 s56, s56, s8
  s_add_u32 m0, s10, 32768
  s_add_u32 s12, s56, 0
  buffer_load_dwordx4 v4, s[40:43], s12 offen lds
  s_add_u32 m0, s10, 33792
  s_nop 0
  buffer_load_dwordx4 v5, s[40:43], s12 offen lds
  s_add_u32 m0, s10, 34816
  s_nop 0
  buffer_load_dwordx4 v6, s[40:43], s12 offen lds
  s_add_u32 m0, s10, 35840
  s_add_u32 s12, s56, 24576
  buffer_load_dwordx4 v4, s[40:43], s12 offen lds
  s_add_u32 m0, s10, 36864
  s_nop 0
  buffer_load_dwordx4 v5, s[40:43], s12 offen lds
  s_add_u32 m0, s10, 37888
  s_nop 0
  buffer_load_dwordx4 v6, s[40:43], s12 offen lds
  s_barrier
  s_lshl_b32 s12, s3, 2
  s_add_u32 s12, s12, 159808
  v_mov_b32 v22, s12
  v_mov_b32 v23, 1
  s_add_u32 s57, s58, 2
  s_and_b32 s57, s57, 7
  s_mul_i32 s57, s57, 128
  s_add_u32 s57, s57, s7
  s_add_u32 m0, s9, 65536
  s_add_u32 s13, s57, 0
  buffer_load_dwordx4 v2, s[36:39], s13 offen lds
  s_add_u32 m0, s9, 66560
  s_add_u32 s13, s57, 8192
  buffer_load_dwordx4 v3, s[36:39], s13 offen lds
  s_add_u32 s56, s58, 2
  s_and_b32 s56, s56, 7
  s_mul_i32 s56, s56, 196608
  s_add_u32 s56, s56, s8
  s_add_u32 m0, s10, 65536
  s_add_u32 s12, s56, 0
  buffer_load_dwordx4 v4, s[40:43], s12 offen lds
  s_add_u32 m0, s10, 66560
  s_nop 0
  buffer_load_dwordx4 v5, s[40:43], s12 offen lds
  s_add_u32 m0, s10, 67584
  s_nop 0
  buffer_load_dwordx4 v6, s[40:43], s12 offen lds
  s_add_u32 m0, s10, 68608
  s_add_u32 s12, s56, 24576
  buffer_load_dwordx4 v4, s[40:43], s12 offen lds
  s_add_u32 m0, s10, 69632
  s_nop 0
  buffer_load_dwordx4 v5, s[40:43], s12 offen lds
  s_add_u32 m0, s10, 70656
  s_nop 0
  buffer_load_dwordx4 v6, s[40:43], s12 offen lds
  s_waitcnt vmcnt(16)
  s_barrier
  s_cmp_lg_u32 s6, 0
  s_cbranch_scc1 k1_noflag
  s_cmp_lg_u32 s3, 0
  s_cbranch_scc1 k1_noflag
  v_mov_b32 v20, 1
  s_lshl_b32 s12, s5, 2
  v_mov_b32 v21, s12
  s_mov_b64 exec, 1
  buffer_store_dword v20, v21, s[48:51], 0 offen sc1
  s_mov_b64 exec, -1
k1_noflag:
  s_add_u32 s57, s58, 3
  s_and_b32 s57, s57, 7
  s_mul_i32 s57, s57, 128
  s_add_u32 s57, s57, s7
  s_add_u32 m0, s9, 98304
  s_add_u32 s13, s57, 0
  buffer_load_dwordx4 v2, s[36:39], s13 offen lds
  s_add_u32 m0, s9, 99328
  s_add_u32 s13, s57, 8192
  buffer_load_dwordx4 v3, s[36:39], s13 offen lds
  s_add_u32 s56, s58, 3
  s_and_b32 s56, s56, 7
  s_mul_i32 s56, s56, 196608
  s_add_u32 s56, s56, s8
  s_add_u32 m0, s10, 98304
  s_add_u32 s12, s56, 0
  buffer_load_dwordx4 v4, s[40:43], s12 offen lds
  s_add_u32 m0, s10, 99328
  s_nop 0
  buffer_load_dwordx4 v5, s[40:43], s12 offen lds
  s_add_u32 m0, s10, 100352
  s_nop 0
  buffer_load_dwordx4 v6, s[40:43], s12 offen lds
  s_add_u32 m0, s10, 101376
  s_add_u32 s12, s56, 24576
  buffer_load_dwordx4 v4, s[40:43], s12 offen lds
  s_add_u32 m0, s10, 102400
  s_nop 0
  buffer_load_dwordx4 v5, s[40:43], s12 offen lds
  s_add_u32 m0, s10, 103424
  s_nop 0
  buffer_load_dwordx4 v6, s[40:43], s12 offen lds
  s_waitcnt vmcnt(16)
  s_barrier
  s_add_u32 s57, s58, 4
  s_and_b32 s57, s57, 7
  s_mul_i32 s57, s57, 128
  s_add_u32 s57, s57, s7
  s_add_u32 m0, s9, 0
  s_add_u32 s13, s57, 0
  buffer_load_dwordx4 v2, s[36:39], s13 offen lds
  s_add_u32 m0, s9, 1024
  s_add_u32 s13, s57, 8192
  buffer_load_dwordx4 v3, s[36:39], s13 offen lds
  s_add_u32 s56, s58, 4
  s_and_b32 s56, s56, 7
  s_mul_i32 s56, s56, 196608
  s_add_u32 s56, s56, s8
  s_add_u32 m0, s10, 0
  s_add_u32 s12, s56, 0
  buffer_load_dwordx4 v4, s[40:43], s12 offen lds
  s_add_u32 m0, s10, 1024
  s_nop 0
  buffer_load_dwordx4 v5, s[40:43], s12 offen lds
  s_add_u32 m0, s10, 2048
  s_nop 0
  buffer_load_dwordx4 v6, s[40:43], s12 offen lds
  s_add_u32 m0, s10, 3072
  s_add_u32 s12, s56, 24576
  buffer_load_dwordx4 v4, s[40:43], s12 offen lds
  s_add_u32 m0, s10, 4096
  s_nop 0
  buffer_load_dwordx4 v5, s[40:43], s12 offen lds
  s_add_u32 m0, s10, 5120
  s_nop 0
  buffer_load_dwordx4 v6, s[40:43], s12 offen lds
  s_waitcnt vmcnt(16)
  s_barrier
  s_add_u32 s57, s58, 5
  s_and_b32 s57, s57, 7
  s_mul_i32 s57, s57, 128
  s_add_u32 s57, s57, s7
  s_add_u32 m0, s9, 32768
  s_add_u32 s13, s57, 0
  buffer_load_dwordx4 v2, s[36:39], s13 offen lds
  s_add_u32 m0, s9, 33792
  s_add_u32 s13, s57, 8192
  buffer_load_dwordx4 v3, s[36:39], s13 offen lds
  s_add_u32 s56, s58, 5
  s_and_b32 s56, s56, 7
  s_mul_i32 s56, s56, 196608
  s_add_u32 s56, s56, s8
  s_add_u32 m0, s10, 32768
  s_add_u32 s12, s56, 0
  buffer_load_dwordx4 v4, s[40:43], s12 offen lds
  s_add_u32 m0, s10, 33792
  s_nop 0
  buffer_load_dwordx4 v5, s[40:43], s12 offen lds
  s_add_u32 m0, s10, 34816
  s_nop 0
  buffer_load_dwordx4 v6, s[40:43], s12 offen lds
  s_add_u32 m0, s10, 35840
  s_add_u32 s12, s56, 24576
  buffer_load_dwordx4 v4, s[40:43], s12 offen lds
  s_add_u32 m0, s10, 36864
  s_nop 0
  buffer_load_dwordx4 v5, s[40:43], s12 offen lds
  s_add_u32 m0, s10, 37888
  s_nop 0
  buffer_load_dwordx4 v6, s[40:43], s12 offen lds
  s_waitcnt vmcnt(16)
  s_barrier
  s_add_u32 s57, s58, 6
  s_and_b32 s57, s57, 7
  s_mul_i32 s57, s57, 128
  s_add_u32 s57, s57, s7
  s_add_u32 m0, s9, 65536
  s_add_u32 s13, s57, 0
  buffer_load_dwordx4 v2, s[36:39], s13 offen lds
  s_add_u32 m0, s9, 66560
  s_add_u32 s13, s57, 8192
  buffer_load_dwordx4 v3, s[36:39], s13 offen lds
  s_add_u32 s56, s58, 6
  s_and_b32 s56, s56, 7
  s_mul_i32 s56, s56, 196608
  s_add_u32 s56, s56, s8
  s_add_u32 m0, s10, 65536
  s_add_u32 s12, s56, 0
  buffer_load_dwordx4 v4, s[40:43], s12 offen lds
  s_add_u32 m0, s10, 66560
  s_nop 0
  buffer_load_dwordx4 v5, s[40:43], s12 offen lds
  s_add_u32 m0, s10, 67584
  s_nop 0
  buffer_load_dwordx4 v6, s[40:43], s12 offen lds
  s_add_u32 m0, s10, 68608
  s_add_u32 s12, s56, 24576
  buffer_load_dwordx4 v4, s[40:43], s12 offen lds
  s_add_u32 m0, s10, 69632
  s_nop 0
  buffer_load_dwordx4 v5, s[40:43], s12 offen lds
  s_add_u32 m0, s10, 70656
  s_nop 0
  buffer_load_dwordx4 v6, s[40:43], s12 offen lds
  s_waitcnt vmcnt(16)
  s_barrier
  s_add_u32 s57, s58, 7
  s_and_b32 s57, s57, 7
  s_mul_i32 s57, s57, 128
  s_add_u32 s57, s57, s7
  s_add_u32 m0, s9, 98304
  s_add_u32 s13, s57, 0
  buffer_load_dwordx4 v2, s[36:39], s13 offen lds
  s_add_u32 m0, s9, 99328
  s_add_u32 s13, s57, 8192
  buffer_load_dwordx4 v3, s[36:39], s13 offen lds
  s_add_u32 s56, s58, 7
  s_and_b32 s56, s56, 7
  s_mul_i32 s56, s56, 196608
  s_add_u32 s56, s56, s8
  s_add_u32 m0, s10, 98304
  s_add_u32 s12, s56, 0
  buffer_load_dwordx4 v4, s[40:43], s12 offen lds
  s_add_u32 m0, s10, 99328
  s_nop 0
  buffer_load_dwordx4 v5, s[40:43], s12 offen lds
  s_add_u32 m0, s10, 100352
  s_nop 0
  buffer_load_dwordx4 v6, s[40:43], s12 offen lds
  s_add_u32 m0, s10, 101376
  s_add_u32 s12, s56, 24576
  buffer_load_dwordx4 v4, s[40:43], s12 offen lds
  s_add_u32 m0, s10, 102400
  s_nop 0
  buffer_load_dwordx4 v5, s[40:43], s12 offen lds
  s_add_u32 m0, s10, 103424
  s_nop 0
  buffer_load_dwordx4 v6, s[40:43], s12 offen lds
  s_lshl_b32 s70, s3, 8
  s_add_u32 s70, s70, s2
  s_lshl_b32 s71, s3, 13
  s_add_u32 s71, s71, 131072
  v_lshrrev_b32 v28, 3, v0
  v_and_b32 v29, 7, v0
  v_lshlrev_b32 v29, 4, v29
  v_lshl_add_u32 v30, v28, 10, v29
  s_mov_b32 s72, 3
  s_mov_b32 s76, s20
  s_mov_b32 s77, s21
  s_mov_b32 s78, 0
  s_mov_b32 s79, 0x20000
  s_mov_b32 s80, s20
  s_mov_b32 s81, s21
  s_mov_b32 s82, 0
  s_mov_b32 s83, 0x20000
  s_mov_b32 s88, 0
  s_mov_b32 s90, 0
  s_mov_b32 s91, 0
  s_mov_b32 s62, 0
  s_mov_b32 s63, 155648
  s_cmp_ge_u32 s70, 736
  s_cbranch_scc1 k1_js_done
  s_movk_i32 s62, 1024
  s_mov_b32 s63, s71
  s_cmp_lt_u32 s70, 448
  s_cbranch_scc1 k1_js_gu
  s_mov_b32 s72, 1
  s_cmp_lt_u32 s70, 672
  s_cbranch_scc1 k1_js_wd
  s_mov_b32 s76, s20
  s_mov_b32 s77, s21
  s_mov_b32 s78, 524288
  s_mov_b32 s79, 0x20000
  s_mov_b32 s80, s20
  s_mov_b32 s81, s21
  s_mov_b32 s82, 524288
  s_mov_b32 s83, 0x20000
  s_add_u32 s84, s34, 19922944
  s_addc_u32 s85, s35, 0
  s_mov_b32 s86, 524288
  s_mov_b32 s87, 0x20000
  s_mov_b32 s73, 32
  s_sub_u32 s70, s70, 672
  s_branch k1_js_dd
k1_js_wd:
  s_mov_b32 s76, s28
  s_mov_b32 s77, s29
  s_mov_b32 s78, 1835008
  s_mov_b32 s79, 0x20000
  s_mov_b32 s80, s28
  s_mov_b32 s81, s29
  s_mov_b32 s82, 1835008
  s_mov_b32 s83, 0x20000
  s_add_u32 s84, s34, 17825792
  s_addc_u32 s85, s35, 0
  s_mov_b32 s86, 1835008
  s_mov_b32 s87, 0x20000
  s_mov_b32 s73, 112
  s_sub_u32 s70, s70, 448
k1_js_dd:
  s_lshr_b32 s74, s70, 3
  s_and_b32 s75, s70, 7
  s_lshl_b32 s88, s74, 16
  s_lshl_b32 s89, s75, 7
  s_add_u32 s88, s88, s89
  s_movk_i32 s90, 8192
  s_add_u32 s91, s88, 32768
  s_branch k1_js_done
k1_js_gu:
  s_mov_b32 s72, 0
  s_mov_b32 s76, s24
  s_mov_b32 s77, s25
  s_mov_b32 s78, 1835008
  s_mov_b32 s79, 0x20000
  s_mov_b32 s80, s26
  s_mov_b32 s81, s27
  s_mov_b32 s82, 1835008
  s_mov_b32 s83, 0x20000
  s_add_u32 s84, s34, 13631488
  s_addc_u32 s85, s35, 0
  s_mov_b32 s86, 3670016
  s_mov_b32 s87, 0x20000
  s_mul_i32 s74, s70, 2341
  s_lshr_b32 s74, s74, 16
  s_mul_i32 s75, s74, 28
  s_sub_u32 s75, s70, s75
  s_movk_i32 s89, 3584
  v_mul_lo_u32 v30, v28, s89
  v_add_u32 v30, v30, v29
  s_mul_i32 s88, s74, 114688
  s_lshl_b32 s89, s75, 7
  s_add_u32 s88, s88, s89
  s_movk_i32 s90, 28672
  s_mov_b32 s91, s88
k1_js_done:
  s_mov_b32 m0, s63
  s_add_u32 s63, s63, s62
  buffer_load_dwordx4 v30, s[76:79], s88 offen lds
  s_add_u32 s88, s88, s90
  s_mov_b32 m0, s63
  s_add_u32 s63, s63, s62
  buffer_load_dwordx4 v30, s[76:79], s88 offen lds
  s_add_u32 s88, s88, s90
  s_mov_b32 m0, s63
  s_add_u32 s63, s63, s62
  buffer_load_dwordx4 v30, s[76:79], s88 offen lds
  s_add_u32 s88, s88, s90
  s_mov_b32 m0, s63
  s_add_u32 s63, s63, s62
  buffer_load_dwordx4 v30, s[76:79], s88 offen lds
  s_add_u32 s88, s88, s90
  s_mov_b32 m0, s63
  s_add_u32 s63, s63, s62
  buffer_load_dwordx4 v30, s[80:83], s91 offen lds
  s_add_u32 s91, s91, s90
  s_mov_b32 m0, s63
  s_add_u32 s63, s63, s62
  buffer_load_dwordx4 v30, s[80:83], s91 offen lds
  s_add_u32 s91, s91, s90
  s_mov_b32 m0, s63
  s_add_u32 s63, s63, s62
  buffer_load_dwordx4 v30, s[80:83], s91 offen lds
  s_add_u32 s91, s91, s90
  s_mov_b32 m0, s63
  s_add_u32 s63, s63, s62
  buffer_load_dwordx4 v30, s[80:83], s91 offen lds
  s_add_u32 s91, s91, s90
  s_waitcnt vmcnt(24)
  ds_write_b32 v22, v23 offset:80
  s_waitcnt vmcnt(16)
  ds_write_b32 v22, v23 offset:96
  s_waitcnt vmcnt(8)
  ds_write_b32 v22, v23 offset:112
  s_waitcnt vmcnt(0)
  s_cmp_eq_u32 s72, 3
  s_cbranch_scc1 k1_jf_end
  v_lshlrev_b32 v34, 4, v0
  v_lshrrev_b32 v35, 5, v0
  v_bfe_u32 v36, v0, 2, 2
  v_lshl_add_u32 v35, v35, 2, v36
  v_lshlrev_b32 v35, 7, v35
  v_and_b32 v36, 3, v0
  v_lshl_add_u32 v35, v36, 3, v35
  v_add_u32 v35, s71, v35
  v_bfe_u32 v36, v0, 4, 1
  s_cmp_eq_u32 s72, 0
  s_cbranch_scc1 k1_jf_gu
  v_lshl_add_u32 v35, v36, 5, v35
  s_lshl_b32 s60, s75, 1
  s_mul_i32 s60, s60, s73
  s_lshl_b32 s61, s74, 2
  s_add_u32 s60, s60, s61
  s_lshl_b32 s60, s60, 10
  s_lshl_b32 s61, s73, 10
  ds_read_b64_tr_b16 v[40:41], v35 offset:0
  ds_read_b64_tr_b16 v[42:43], v35 offset:1024
  ds_read_b64_tr_b16 v[44:45], v35 offset:2048
  ds_read_b64_tr_b16 v[46:47], v35 offset:3072
  ds_read_b64_tr_b16 v[48:49], v35 offset:4096
  ds_read_b64_tr_b16 v[50:51], v35 offset:5120
  ds_read_b64_tr_b16 v[52:53], v35 offset:6144
  ds_read_b64_tr_b16 v[54:55], v35 offset:7168
  ds_read_b64_tr_b16 v[56:57], v35 offset:64
  ds_read_b64_tr_b16 v[58:59], v35 offset:1088
  ds_read_b64_tr_b16 v[60:61], v35 offset:2112
  ds_read_b64_tr_b16 v[62:63], v35 offset:3136
  ds_read_b64_tr_b16 v[64:65], v35 offset:4160
  ds_read_b64_tr_b16 v[66:67], v35 offset:5184
  ds_read_b64_tr_b16 v[68:69], v35 offset:6208
  ds_read_b64_tr_b16 v[70:71], v35 offset:7232
  s_waitcnt lgkmcnt(0)
  buffer_store_dwordx4 v[40:43], v34, s[84:87], s60 offen offset:0 sc1
  buffer_store_dwordx4 v[44:47], v34, s[84:87], s60 offen offset:1024 sc1
  buffer_store_dwordx4 v[48:51], v34, s[84:87], s60 offen offset:2048 sc1
  buffer_store_dwordx4 v[52:55], v34, s[84:87], s60 offen offset:3072 sc1
  s_add_u32 s60, s60, s61
  buffer_store_dwordx4 v[56:59], v34, s[84:87], s60 offen offset:0 sc1
  buffer_store_dwordx4 v[60:63], v34, s[84:87], s60 offen offset:1024 sc1
  buffer_store_dwordx4 v[64:67], v34, s[84:87], s60 offen offset:2048 sc1
  buffer_store_dwordx4 v[68:71], v34, s[84:87], s60 offen offset:3072 sc1
  s_add_u32 s60, s60, s61
  s_branch k1_jf_end
k1_jf_gu:
  s_add_u32 s76, s34, 524288
  s_addc_u32 s77, s35, 0
  s_mov_b32 s78, 229376
  s_mov_b32 s79, 0x20000
  v_lshl_add_u32 v35, v36, 12, v35
  s_lshl_b32 s60, s75, 7
  s_lshl_b32 s61, s74, 1
  s_add_u32 s60, s60, s61
  s_lshl_b32 s60, s60, 10
  v_mov_b32 v72, 0
  v_mov_b32 v73, 0
  v_mov_b32 v74, 0
  v_mov_b32 v75, 0
  v_mov_b32 v76, 0
  v_mov_b32 v77, 0
  v_mov_b32 v78, 0
  v_mov_b32 v79, 0
  ds_read_b64_tr_b16 v[40:41], v35 offset:0
  ds_read_b64_tr_b16 v[42:43], v35 offset:1024
  ds_read_b64_tr_b16 v[44:45], v35 offset:2048
  ds_read_b64_tr_b16 v[46:47], v35 offset:3072
  ds_read_b64_tr_b16 v[48:49], v35 offset:32
  ds_read_b64_tr_b16 v[50:51], v35 offset:1056
  ds_read_b64_tr_b16 v[52:53], v35 offset:2080
  ds_read_b64_tr_b16 v[54:55], v35 offset:3104
  ds_read_b64_tr_b16 v[56:57], v35 offset:64
  ds_read_b64_tr_b16 v[58:59], v35 offset:1088
  ds_read_b64_tr_b16 v[60:61], v35 offset:2112
  ds_read_b64_tr_b16 v[62:63], v35 offset:3136
  ds_read_b64_tr_b16 v[64:65], v35 offset:96
  ds_read_b64_tr_b16 v[66:67], v35 offset:1120
  ds_read_b64_tr_b16 v[68:69], v35 offset:2144
  ds_read_b64_tr_b16 v[70:71], v35 offset:3168
  s_waitcnt lgkmcnt(0)
  s_add_u32 s61, s60, 0
  buffer_store_dwordx4 v[40:43], v34, s[84:87], s61 offen offset:0 sc1
  buffer_store_dwordx4 v[44:47], v34, s[84:87], s61 offen offset:1024 sc1
  s_add_u32 s61, s60, 32768
  buffer_store_dwordx4 v[48:51], v34, s[84:87], s61 offen offset:0 sc1
  buffer_store_dwordx4 v[52:55], v34, s[84:87], s61 offen offset:1024 sc1
  s_add_u32 s61, s60, 65536
  buffer_store_dwordx4 v[56:59], v34, s[84:87], s61 offen offset:0 sc1
  buffer_store_dwordx4 v[60:63], v34, s[84:87], s61 offen offset:1024 sc1
  s_add_u32 s61, s60, 98304
  buffer_store_dwordx4 v[64:67], v34, s[84:87], s61 offen offset:0 sc1
  buffer_store_dwordx4 v[68:71], v34, s[84:87], s61 offen offset:1024 sc1
  v_dot2c_f32_bf16 v72, 0x3f803f80, v40
  v_dot2c_f32_bf16 v73, 0x3f803f80, v48
  v_dot2c_f32_bf16 v74, 0x3f803f80, v56
  v_dot2c_f32_bf16 v75, 0x3f803f80, v64
  v_dot2c_f32_bf16 v76, 0x3f803f80, v44
  v_dot2c_f32_bf16 v77, 0x3f803f80, v52
  v_dot2c_f32_bf16 v78, 0x3f803f80, v60
  v_dot2c_f32_bf16 v79, 0x3f803f80, v68
  v_dot2c_f32_bf16 v72, 0x3f803f80, v41
  v_dot2c_f32_bf16 v73, 0x3f803f80, v49
  v_dot2c_f32_bf16 v74, 0x3f803f80, v57
  v_dot2c_f32_bf16 v75, 0x3f803f80, v65
  v_dot2c_f32_bf16 v76, 0x3f803f80, v45
  v_dot2c_f32_bf16 v77, 0x3f803f80, v53
  v_dot2c_f32_bf16 v78, 0x3f803f80, v61
  v_dot2c_f32_bf16 v79, 0x3f803f80, v69
  v_dot2c_f32_bf16 v72, 0x3f803f80, v42
  v_dot2c_f32_bf16 v73, 0x3f803f80, v50
  v_dot2c_f32_bf16 v74, 0x3f803f80, v58
  v_dot2c_f32_bf16 v75, 0x3f803f80, v66
  v_dot2c_f32_bf16 v76, 0x3f803f80, v46
  v_dot2c_f32_bf16 v77, 0x3f803f80, v54
  v_dot2c_f32_bf16 v78, 0x3f803f80, v62
  v_dot2c_f32_bf16 v79, 0x3f803f80, v70
  v_dot2c_f32_bf16 v72, 0x3f803f80, v43
  v_dot2c_f32_bf16 v73, 0x3f803f80, v51
  v_dot2c_f32_bf16 v74, 0x3f803f80, v59
  v_dot2c_f32_bf16 v75, 0x3f803f80, v67
  v_dot2c_f32_bf16 v76, 0x3f803f80, v47
  v_dot2c_f32_bf16 v77, 0x3f803f80, v55
  v_dot2c_f32_bf16 v78, 0x3f803f80, v63
  v_dot2c_f32_bf16 v79, 0x3f803f80, v71
  s_nop 2
  v_add_f32 v72, v72, v76
  v_add_f32 v73, v73, v77
  v_add_f32 v74, v74, v78
  v_add_f32 v75, v75, v79
  s_mulk_i32 s74, 3584
  s_lshl_b32 s61, s75, 7
  s_add_u32 s74, s74, s61
  s_lshl_b32 s74, s74, 2
  v_and_b32 v32, 31, v0
  v_lshlrev_b32 v32, 2, v32
  v_mov_b32 v33, v72
  s_nop 1
  v_permlane32_swap_b32 v72, v33
  s_nop 1
  v_add_f32 v72, v72, v33
  v_mov_b32 v33, v73
  s_nop 1
  v_permlane32_swap_b32 v73, v33
  s_nop 1
  v_add_f32 v73, v73, v33
  v_mov_b32 v33, v74
  s_nop 1
  v_permlane32_swap_b32 v74, v33
  s_nop 1
  v_add_f32 v74, v74, v33
  v_mov_b32 v33, v75
  s_nop 1
  v_permlane32_swap_b32 v75, v33
  s_nop 1
  v_add_f32 v75, v75, v33
  buffer_store_dword v72, v32, s[76:79], s74 offen offset:0 sc1
  buffer_store_dword v73, v32, s[76:79], s74 offen offset:128 sc1
  buffer_store_dword v74, v32, s[76:79], s74 offen offset:256 sc1
  buffer_store_dword v75, v32, s[76:79], s74 offen offset:384 sc1
k1_jf_end:
  s_branch k1_end
k1_fin:
k1_end:
  s_endpgm

.globl kf_kernel
.p2align 8
.type kf_kernel,@function
kf_kernel:
  s_cmp_ge_u32 s2, 256
  s_cbranch_scc1 kf_end
  s_load_dwordx16 s[16:31], s[0:1], 0
  s_load_dwordx4 s[32:35], s[0:1], 64
  v_lshrrev_b32 v1, 6, v0
  v_and_b32 v0, 63, v0
  v_readfirstlane_b32 s3, v1
  s_waitcnt lgkmcnt(0)
  s_and_b32 s74, s2, 7
  s_lshr_b32 s75, s2, 3
  s_lshr_b32 s4, s75, 3
  s_lshl_b32 s68, s74, 2
  s_add_u32 s68, s68, s4
  s_and_b32 s69, s75, 7
  s_lshr_b32 s4, s3, 1
  s_and_b32 s71, s3, 1
  s_lshl_b32 s70, s68, 1
  s_add_u32 s70, s70, s4
  s_lshr_b32 s4, s74, 2
  s_lshl_b32 s72, s4, 3
  s_lshr_b32 s4, s75, 2
  s_add_u32 s72, s72, s4
  s_and_b32 s4, s74, 3
  s_lshl_b32 s73, s4, 2
  s_and_b32 s4, s75, 3
  s_add_u32 s73, s73, s4
  s_mov_b32 s36, s34
  s_mov_b32 s37, s35
  s_mov_b32 s38, 34816
  s_mov_b32 s39, 0x20000
  s_add_u32 s40, s34, 1048576
  s_addc_u32 s41, s35, 0
  s_mov_b32 s42, 2097152
  s_mov_b32 s43, 0x20000
  s_add_u32 s44, s34, 19922944
  s_addc_u32 s45, s35, 0
  s_mov_b32 s46, 524288
  s_mov_b32 s47, 0x20000
  v_lshlrev_b32 v2, 4, v0
  v_and_b32 v3, 31, v0
  v_min_u32 v4, 16, v3
  v_lshlrev_b32 v4, 6, v4
  v_lshrrev_b32 v5, 5, v0
  v_lshl_add_u32 v4, v5, 4, v4
  s_lshl_b32 s8, s3, 3
  s_mul_i32 s9, s8, 1088
  s_lshl_b32 s10, s70, 5
  s_add_u32 s10, s10, s8
  s_lshl_b32 s10, s10, 10
  s_xor_b32 s14, s70, 1
  s_lshl_b32 s14, s14, 5
  s_add_u32 s14, s14, s8
  s_lshl_b32 s14, s14, 10
  s_lshl_b32 s11, s69, 1
  s_add_u32 s11, s11, s71
  s_xor_b32 s15, s11, 1
  s_lshl_b32 s11, s11, 5
  s_add_u32 s11, s11, s8
  s_lshl_b32 s11, s11, 10
  s_lshl_b32 s15, s15, 5
  s_add_u32 s15, s15, s8
  s_lshl_b32 s15, s15, 10
  s_add_u32 s12, s9, 0
  buffer_load_dwordx4 v[64:67], v4, s[36:39], s12 offen
  buffer_load_dwordx4 v[68:71], v4, s[36:39], s12 offen offset:32
  buffer_load_dwordx4 a[0:3], v2, s[40:43], s10 offen offset:0
  buffer_load_dwordx4 a[32:35], v2, s[40:43], s14 offen offset:0
  buffer_load_dwordx4 a[64:67], v2, s[44:47], s11 offen offset:0
  buffer_load_dwordx4 a[96:99], v2, s[44:47], s15 offen offset:0
  s_add_u32 s12, s9, 1088
  buffer_load_dwordx4 v[72:75], v4, s[36:39], s12 offen
  buffer_load_dwordx4 v[76:79], v4, s[36:39], s12 offen offset:32
  buffer_load_dwordx4 a[4:7], v2, s[40:43], s10 offen offset:1024
  buffer_load_dwordx4 a[36:39], v2, s[40:43], s14 offen offset:1024
  buffer_load_dwordx4 a[68:71], v2, s[44:47], s11 offen offset:1024
  buffer_load_dwordx4 a[100:103], v2, s[44:47], s15 offen offset:1024
  s_add_u32 s12, s9, 2176
  buffer_load_dwordx4 v[80:83], v4, s[36:39], s12 offen
  buffer_load_dwordx4 v[84:87], v4, s[36:39], s12 offen offset:32
  buffer_load_dwordx4 a[8:11], v2, s[40:43], s10 offen offset:2048
  buffer_load_dwordx4 a[40:43], v2, s[40:43], s14 offen offset:2048
  buffer_load_dwordx4 a[72:75], v2, s[44:47], s11 offen offset:2048
  buffer_load_dwordx4 a[104:107], v2, s[44:47], s15 offen offset:2048
  s_mov_b32 s48, s16
  s_mov_b32 s49, s17
  s_mov_b32 s50, 2097152
  s_mov_b32 s51, 0x20000
  s_add_u32 s52, s34, 3145728
  s_addc_u32 s53, s35, 0
  s_mov_b32 s54, 2097152
  s_mov_b32 s55, 0x20000
  s_add_u32 s56, s34, 131072
  s_addc_u32 s57, s35, 0
  s_mov_b32 s58, 262144
  s_mov_b32 s59, 0x20000
  s_add_u32 s60, s34, 13631488
  s_addc_u32 s61, s35, 0
  s_mov_b32 s62, 3670016
  s_mov_b32 s63, 0x20000
  s_add_u32 s64, s34, 491520
  s_addc_u32 s65, s35, 0
  s_mov_b32 s66, 4096
  s_mov_b32 s67, 0x20000
  v_accvgpr_write_b32 a128, 0
  v_accvgpr_write_b32 a129, 0
  v_accvgpr_write_b32 a130, 0
  v_accvgpr_write_b32 a131, 0
  v_accvgpr_write_b32 a132, 0
  v_accvgpr_write_b32 a133, 0
  v_accvgpr_write_b32 a134, 0
  v_accvgpr_write_b32 a135, 0
  v_accvgpr_write_b32 a136, 0
  v_accvgpr_write_b32 a137, 0
  v_accvgpr_write_b32 a138, 0
  v_accvgpr_write_b32 a139, 0
  v_accvgpr_write_b32 a140, 0
  v_accvgpr_write_b32 a141, 0
  v_accvgpr_write_b32 a142, 0
  v_accvgpr_write_b32 a143, 0
  v_accvgpr_write_b32 a144, 0
  v_accvgpr_write_b32 a145, 0
  v_accvgpr_write_b32 a146, 0
  v_accvgpr_write_b32 a147, 0
  v_accvgpr_write_b32 a148, 0
  v_accvgpr_write_b32 a149, 0
  v_accvgpr_write_b32 a150, 0
  v_accvgpr_write_b32 a151, 0
  v_accvgpr_write_b32 a152, 0
  v_accvgpr_write_b32 a153, 0
  v_accvgpr_write_b32 a154, 0
  v_accvgpr_write_b32 a155, 0
  v_accvgpr_write_b32 a156, 0
  v_accvgpr_write_b32 a157, 0
  v_accvgpr_write_b32 a158, 0
  v_accvgpr_write_b32 a159, 0
  v_accvgpr_write_b32 a160, 0
  v_accvgpr_write_b32 a161, 0
  v_accvgpr_write_b32 a162, 0
  v_accvgpr_write_b32 a163, 0
  v_accvgpr_write_b32 a164, 0
  v_accvgpr_write_b32 a165, 0
  v_accvgpr_write_b32 a166, 0
  v_accvgpr_write_b32 a167, 0
  v_accvgpr_write_b32 a168, 0
  v_accvgpr_write_b32 a169, 0
  v_accvgpr_write_b32 a170, 0
  v_accvgpr_write_b32 a171, 0
  v_accvgpr_write_b32 a172, 0
  v_accvgpr_write_b32 a173, 0
  v_accvgpr_write_b32 a174, 0
  v_accvgpr_write_b32 a175, 0
  v_accvgpr_write_b32 a176, 0
  v_accvgpr_write_b32 a177, 0
  v_accvgpr_write_b32 a178, 0
  v_accvgpr_write_b32 a179, 0
  v_accvgpr_write_b32 a180, 0
  v_accvgpr_write_b32 a181, 0
  v_accvgpr_write_b32 a182, 0
  v_accvgpr_write_b32 a183, 0
  v_accvgpr_write_b32 a184, 0
  v_accvgpr_write_b32 a185, 0
  v_accvgpr_write_b32 a186, 0
  v_accvgpr_write_b32 a187, 0
  v_accvgpr_write_b32 a188, 0
  v_accvgpr_write_b32 a189, 0
  v_accvgpr_write_b32 a190, 0
  v_accvgpr_write_b32 a191, 0
  v_mov_b32 v24, 0x358637bd
  s_mul_i32 s78, s73, 7
  s_lshr_b32 s79, s3, 1
  s_add_u32 s79, s79, s78
  s_lshl_b32 s79, s79, 15
  s_and_b32 s81, s3, 1
  s_lshl_b32 s81, s81, 13
  s_add_u32 s79, s79, s81
  s_lshl_b32 s80, s78, 15
  s_lshl_b32 s81, s3, 13
  s_add_u32 s80, s80, s81
  s_waitcnt vmcnt(12)
  v_cvt_pk_bf16_f32 v32, v64, v65
  v_cvt_pk_bf16_f32 v33, v66, v67
  v_cvt_pk_bf16_f32 v34, v68, v69
  v_cvt_pk_bf16_f32 v35, v70, v71
  s_nop 1
  v_mfma_f32_32x32x16_bf16 v[128:143], v[32:35], a[0:3], 0
  v_mfma_f32_32x32x16_bf16 v[144:159], v[32:35], a[32:35], 0
  s_add_u32 s12, s9, 3264
  buffer_load_dwordx4 v[88:91], v4, s[36:39], s12 offen
  buffer_load_dwordx4 v[92:95], v4, s[36:39], s12 offen offset:32
  buffer_load_dwordx4 a[12:15], v2, s[40:43], s10 offen offset:3072
  buffer_load_dwordx4 a[44:47], v2, s[40:43], s14 offen offset:3072
  buffer_load_dwordx4 a[76:79], v2, s[44:47], s11 offen offset:3072
  buffer_load_dwordx4 a[108:111], v2, s[44:47], s15 offen offset:3072
  s_waitcnt vmcnt(12)
  v_cvt_pk_bf16_f32 v36, v72, v73
  v_cvt_pk_bf16_f32 v37, v74, v75
  v_cvt_pk_bf16_f32 v38, v76, v77
  v_cvt_pk_bf16_f32 v39, v78, v79
  s_nop 1
  v_mfma_f32_32x32x16_bf16 v[160:175], v[36:39], a[4:7], 0
  v_mfma_f32_32x32x16_bf16 v[176:191], v[36:39], a[36:39], 0
  s_nop 5
  v_add_f32 v25, v136, v24
  v_add_f32 v26, v152, v24
  v_rcp_f32 v25, v25
  v_rcp_f32 v26, v26
  s_nop 0
  v_mul_f32 v128, v128, v25
  v_mul_f32 v144, v144, v26
  v_mul_f32 v129, v129, v25
  v_mul_f32 v145, v145, v26
  v_mul_f32 v130, v130, v25
  v_mul_f32 v146, v146, v26
  v_mul_f32 v131, v131, v25
  v_mul_f32 v147, v147, v26
  v_mul_f32 v132, v132, v25
  v_mul_f32 v148, v148, v26
  v_mul_f32 v133, v133, v25
  v_mul_f32 v149, v149, v26
  v_mul_f32 v134, v134, v25
  v_mul_f32 v150, v150, v26
  v_mul_f32 v135, v135, v25
  v_mul_f32 v151, v151, v26
  v_cvt_pk_bf16_f32 v8, v128, v129
  v_cvt_pk_bf16_f32 v12, v144, v145
  v_cvt_pk_bf16_f32 v9, v130, v131
  v_cvt_pk_bf16_f32 v13, v146, v147
  v_cvt_pk_bf16_f32 v10, v132, v133
  v_cvt_pk_bf16_f32 v14, v148, v149
  v_cvt_pk_bf16_f32 v11, v134, v135
  v_cvt_pk_bf16_f32 v15, v150, v151
  s_nop 1
  s_add_u32 s12, s9, 4352
  buffer_load_dwordx4 v[96:99], v4, s[36:39], s12 offen
  buffer_load_dwordx4 v[100:103], v4, s[36:39], s12 offen offset:32
  s_add_u32 s10, s10, 4096
  buffer_load_dwordx4 a[16:19], v2, s[40:43], s10 offen offset:0
  s_add_u32 s14, s14, 4096
  buffer_load_dwordx4 a[48:51], v2, s[40:43], s14 offen offset:0
  s_add_u32 s11, s11, 4096
  buffer_load_dwordx4 a[80:83], v2, s[44:47], s11 offen offset:0
  s_add_u32 s15, s15, 4096
  buffer_load_dwordx4 a[112:115], v2, s[44:47], s15 offen offset:0
  s_waitcnt vmcnt(12)
  v_cvt_pk_bf16_f32 v40, v80, v81
  v_cvt_pk_bf16_f32 v41, v82, v83
  v_cvt_pk_bf16_f32 v42, v84, v85
  v_cvt_pk_bf16_f32 v43, v86, v87
  s_nop 1
  v_mfma_f32_32x32x16_bf16 v[128:143], v[40:43], a[8:11], 0
  v_add_f32 v25, v168, v24
  v_add_f32 v26, v184, v24
  v_rcp_f32 v25, v25
  v_rcp_f32 v26, v26
  s_nop 0
  v_mfma_f32_32x32x16_bf16 v[144:159], v[40:43], a[40:43], 0
  v_mul_f32 v160, v160, v25
  v_mul_f32 v176, v176, v26
  v_mul_f32 v161, v161, v25
  v_mul_f32 v177, v177, v26
  v_mul_f32 v162, v162, v25
  v_mfma_f32_32x32x16_bf16 a[128:143], a[64:67], v[8:11], a[128:143]
  v_mul_f32 v178, v178, v26
  v_mul_f32 v163, v163, v25
  v_mul_f32 v179, v179, v26
  v_mul_f32 v164, v164, v25
  v_mul_f32 v180, v180, v26
  v_mfma_f32_32x32x16_bf16 a[144:159], a[96:99], v[8:11], a[144:159]
  v_mul_f32 v165, v165, v25
  v_mul_f32 v181, v181, v26
  v_mul_f32 v166, v166, v25
  v_mul_f32 v182, v182, v26
  v_mul_f32 v167, v167, v25
  v_mfma_f32_32x32x16_bf16 a[160:175], a[64:67], v[12:15], a[160:175]
  v_mul_f32 v183, v183, v26
  v_cvt_pk_bf16_f32 v16, v160, v161
  v_cvt_pk_bf16_f32 v20, v176, v177
  v_cvt_pk_bf16_f32 v17, v162, v163
  v_cvt_pk_bf16_f32 v21, v178, v179
  v_mfma_f32_32x32x16_bf16 a[176:191], a[96:99], v[12:15], a[176:191]
  v_cvt_pk_bf16_f32 v18, v164, v165
  v_cvt_pk_bf16_f32 v22, v180, v181
  v_cvt_pk_bf16_f32 v19, v166, v167
  v_cvt_pk_bf16_f32 v23, v182, v183
  s_nop 1
  s_add_u32 s12, s9, 5440
  buffer_load_dwordx4 v[104:107], v4, s[36:39], s12 offen
  buffer_load_dwordx4 v[108:111], v4, s[36:39], s12 offen offset:32
  buffer_load_dwordx4 a[20:23], v2, s[40:43], s10 offen offset:1024
  buffer_load_dwordx4 a[52:55], v2, s[40:43], s14 offen offset:1024
  buffer_load_dwordx4 a[84:87], v2, s[44:47], s11 offen offset:1024
  buffer_load_dwordx4 a[116:119], v2, s[44:47], s15 offen offset:1024
  s_waitcnt vmcnt(12)
  v_cvt_pk_bf16_f32 v44, v88, v89
  v_cvt_pk_bf16_f32 v45, v90, v91
  v_cvt_pk_bf16_f32 v46, v92, v93
  v_cvt_pk_bf16_f32 v47, v94, v95
  s_nop 1
  v_mfma_f32_32x32x16_bf16 v[160:175], v[44:47], a[12:15], 0
  v_add_f32 v25, v136, v24
  v_add_f32 v26, v152, v24
  v_rcp_f32 v25, v25
  v_rcp_f32 v26, v26
  s_nop 0
  v_mfma_f32_32x32x16_bf16 v[176:191], v[44:47], a[44:47], 0
  v_mul_f32 v128, v128, v25
  v_mul_f32 v144, v144, v26
  v_mul_f32 v129, v129, v25
  v_mul_f32 v145, v145, v26
  v_mul_f32 v130, v130, v25
  v_mfma_f32_32x32x16_bf16 a[128:143], a[68:71], v[16:19], a[128:143]
  v_mul_f32 v146, v146, v26
  v_mul_f32 v131, v131, v25
  v_mul_f32 v147, v147, v26
  v_mul_f32 v132, v132, v25
  v_mul_f32 v148, v148, v26
  v_mfma_f32_32x32x16_bf16 a[144:159], a[100:103], v[16:19], a[144:159]
  v_mul_f32 v133, v133, v25
  v_mul_f32 v149, v149, v26
  v_mul_f32 v134, v134, v25
  v_mul_f32 v150, v150, v26
  v_mul_f32 v135, v135, v25
  v_mfma_f32_32x32x16_bf16 a[160:175], a[68:71], v[20:23], a[160:175]
  v_mul_f32 v151, v151, v26
  v_cvt_pk_bf16_f32 v8, v128, v129
  v_cvt_pk_bf16_f32 v12, v144, v145
  v_cvt_pk_bf16_f32 v9, v130, v131
  v_cvt_pk_bf16_f32 v13, v146, v147
  v_mfma_f32_32x32x16_bf16 a[176:191], a[100:103], v[20:23], a[176:191]
  v_cvt_pk_bf16_f32 v10, v132, v133
  v_cvt_pk_bf16_f32 v14, v148, v149
  v_cvt_pk_bf16_f32 v11, v134, v135
  v_cvt_pk_bf16_f32 v15, v150, v151
  s_nop 1
  s_add_u32 s12, s9, 6528
  buffer_load_dwordx4 v[112:115], v4, s[36:39], s12 offen
  buffer_load_dwordx4 v[116:119], v4, s[36:39], s12 offen offset:32
  buffer_load_dwordx4 a[24:27], v2, s[40:43], s10 offen offset:2048
  buffer_load_dwordx4 a[56:59], v2, s[40:43], s14 offen offset:2048
  buffer_load_dwordx4 a[88:91], v2, s[44:47], s11 offen offset:2048
  buffer_load_dwordx4 a[120:123], v2, s[44:47], s15 offen offset:2048
  s_waitcnt vmcnt(12)
  v_cvt_pk_bf16_f32 v48, v96, v97
  v_cvt_pk_bf16_f32 v49, v98, v99
  v_cvt_pk_bf16_f32 v50, v100, v101
  v_cvt_pk_bf16_f32 v51, v102, v103
  s_nop 1
  v_mfma_f32_32x32x16_bf16 v[128:143], v[48:51], a[16:19], 0
  v_add_f32 v25, v168, v24
  v_add_f32 v26, v184, v24
  v_rcp_f32 v25, v25
  v_rcp_f32 v26, v26
  s_nop 0
  v_mfma_f32_32x32x16_bf16 v[144:159], v[48:51], a[48:51], 0
  v_mul_f32 v160, v160, v25
  v_mul_f32 v176, v176, v26
  v_mul_f32 v161, v161, v25
  v_mul_f32 v177, v177, v26
  v_mul_f32 v162, v162, v25
  v_mfma_f32_32x32x16_bf16 a[128:143], a[72:75], v[8:11], a[128:143]
  v_mul_f32 v178, v178, v26
  v_mul_f32 v163, v163, v25
  v_mul_f32 v179, v179, v26
  v_mul_f32 v164, v164, v25
  v_mul_f32 v180, v180, v26
  v_mfma_f32_32x32x16_bf16 a[144:159], a[104:107], v[8:11], a[144:159]
  v_mul_f32 v165, v165, v25
  v_mul_f32 v181, v181, v26
  v_mul_f32 v166, v166, v25
  v_mul_f32 v182, v182, v26
  v_mul_f32 v167, v167, v25
  v_mfma_f32_32x32x16_bf16 a[160:175], a[72:75], v[12:15], a[160:175]
  v_mul_f32 v183, v183, v26
  v_cvt_pk_bf16_f32 v16, v160, v161
  v_cvt_pk_bf16_f32 v20, v176, v177
  v_cvt_pk_bf16_f32 v17, v162, v163
  v_cvt_pk_bf16_f32 v21, v178, v179
  v_mfma_f32_32x32x16_bf16 a[176:191], a[104:107], v[12:15], a[176:191]
  v_cvt_pk_bf16_f32 v18, v164, v165
  v_cvt_pk_bf16_f32 v22, v180, v181
  v_cvt_pk_bf16_f32 v19, v166, v167
  v_cvt_pk_bf16_f32 v23, v182, v183
  s_nop 1
  s_add_u32 s12, s9, 7616
  buffer_load_dwordx4 v[120:123], v4, s[36:39], s12 offen
  buffer_load_dwordx4 v[124:127], v4, s[36:39], s12 offen offset:32
  buffer_load_dwordx4 a[28:31], v2, s[40:43], s10 offen offset:3072
  buffer_load_dwordx4 a[60:63], v2, s[40:43], s14 offen offset:3072
  buffer_load_dwordx4 a[92:95], v2, s[44:47], s11 offen offset:3072
  buffer_load_dwordx4 a[124:127], v2, s[44:47], s15 offen offset:3072
  s_waitcnt vmcnt(12)
  v_cvt_pk_bf16_f32 v52, v104, v105
  v_cvt_pk_bf16_f32 v53, v106, v107
  v_cvt_pk_bf16_f32 v54, v108, v109
  v_cvt_pk_bf16_f32 v55, v110, v111
  s_nop 1
  v_mfma_f32_32x32x16_bf16 v[160:175], v[52:55], a[20:23], 0
  v_add_f32 v25, v136, v24
  v_add_f32 v26, v152, v24
  v_rcp_f32 v25, v25
  v_rcp_f32 v26, v26
  s_nop 0
  v_mfma_f32_32x32x16_bf16 v[176:191], v[52:55], a[52:55], 0
  v_mul_f32 v128, v128, v25
  v_mul_f32 v144, v144, v26
  v_mul_f32 v129, v129, v25
  v_mul_f32 v145, v145, v26
  v_mul_f32 v130, v130, v25
  v_mfma_f32_32x32x16_bf16 a[128:143], a[76:79], v[16:19], a[128:143]
  v_mul_f32 v146, v146, v26
  v_mul_f32 v131, v131, v25
  v_mul_f32 v147, v147, v26
  v_mul_f32 v132, v132, v25
  v_mul_f32 v148, v148, v26
  v_mfma_f32_32x32x16_bf16 a[144:159], a[108:111], v[16:19], a[144:159]
  v_mul_f32 v133, v133, v25
  v_mul_f32 v149, v149, v26
  v_mul_f32 v134, v134, v25
  v_mul_f32 v150, v150, v26
  v_mul_f32 v135, v135, v25
  v_mfma_f32_32x32x16_bf16 a[160:175], a[76:79], v[20:23], a[160:175]
  v_mul_f32 v151, v151, v26
  v_cvt_pk_bf16_f32 v8, v128, v129
  v_cvt_pk_bf16_f32 v12, v144, v145
  v_cvt_pk_bf16_f32 v9, v130, v131
  v_cvt_pk_bf16_f32 v13, v146, v147
  v_mfma_f32_32x32x16_bf16 a[176:191], a[108:111], v[20:23], a[176:191]
  v_cvt_pk_bf16_f32 v10, v132, v133
  v_cvt_pk_bf16_f32 v14, v148, v149
  v_cvt_pk_bf16_f32 v11, v134, v135
  v_cvt_pk_bf16_f32 v15, v150, v151
  s_nop 1
  s_lshl_b32 s6, s70, 15
  s_lshl_b32 s7, s69, 7
  s_add_u32 s6, s6, s7
  s_lshl_b32 s7, s71, 6
  s_add_u32 s6, s6, s7
  v_lshlrev_b32 v6, 10, v3
  v_lshl_add_u32 v6, v5, 3, v6
  buffer_load_dwordx2 v[200:201], v6, s[48:51], s6 offen offset:0
  buffer_load_dwordx2 v[202:203], v6, s[48:51], s6 offen offset:16
  buffer_load_dwordx2 v[204:205], v6, s[48:51], s6 offen offset:32
  buffer_load_dwordx2 v[206:207], v6, s[48:51], s6 offen offset:48
  s_add_u32 s48, s34, 524288
  s_addc_u32 s49, s35, 0
  s_mov_b32 s50, 229376
  s_mov_b32 s51, 0x20000
  v_lshl_add_u32 v230, v1, 6, v0
  v_min_u32 v230, 223, v230
  v_lshlrev_b32 v230, 2, v230
  s_mul_i32 s6, s78, 128
  s_add_u32 s7, s6, 0
  buffer_load_dword v208, v230, s[48:51], s7 offen
  s_add_u32 s7, s6, 14336
  buffer_load_dword v209, v230, s[48:51], s7 offen
  s_add_u32 s7, s6, 28672
  buffer_load_dword v210, v230, s[48:51], s7 offen
  s_add_u32 s7, s6, 43008
  buffer_load_dword v211, v230, s[48:51], s7 offen
  s_add_u32 s7, s6, 57344
  buffer_load_dword v212, v230, s[48:51], s7 offen
  s_add_u32 s7, s6, 71680
  buffer_load_dword v213, v230, s[48:51], s7 offen
  s_add_u32 s7, s6, 86016
  buffer_load_dword v214, v230, s[48:51], s7 offen
  s_add_u32 s7, s6, 100352
  buffer_load_dword v215, v230, s[48:51], s7 offen
  s_add_u32 s7, s6, 114688
  buffer_load_dword v216, v230, s[48:51], s7 offen
  s_add_u32 s7, s6, 129024
  buffer_load_dword v217, v230, s[48:51], s7 offen
  s_add_u32 s7, s6, 143360
  buffer_load_dword v218, v230, s[48:51], s7 offen
  s_add_u32 s7, s6, 157696
  buffer_load_dword v219, v230, s[48:51], s7 offen
  s_add_u32 s7, s6, 172032
  buffer_load_dword v220, v230, s[48:51], s7 offen
  s_add_u32 s7, s6, 186368
  buffer_load_dword v221, v230, s[48:51], s7 offen
  s_add_u32 s7, s6, 200704
  buffer_load_dword v222, v230, s[48:51], s7 offen
  s_add_u32 s7, s6, 215040
  buffer_load_dword v223, v230, s[48:51], s7 offen
  s_and_b32 s6, s74, 3
  s_mul_i32 s6, s6, 917504
  s_mul_i32 s7, s75, 28672
  s_add_u32 s6, s6, s7
  s_mul_i32 s7, s3, 7168
  s_add_u32 s6, s6, s7
  v_min_u32 v7, 55, v0
  v_lshlrev_b32 v7, 7, v7
  buffer_load_dword v231, v7, s[60:63], s6 offen
  s_waitcnt vmcnt(27)
  v_cvt_pk_bf16_f32 v56, v112, v113
  v_cvt_pk_bf16_f32 v57, v114, v115
  v_cvt_pk_bf16_f32 v58, v116, v117
  v_cvt_pk_bf16_f32 v59, v118, v119
  s_nop 1
  v_mfma_f32_32x32x16_bf16 v[128:143], v[56:59], a[24:27], 0
  v_add_f32 v25, v168, v24
  v_add_f32 v26, v184, v24
  v_rcp_f32 v25, v25
  v_rcp_f32 v26, v26
  s_nop 0
  v_mfma_f32_32x32x16_bf16 v[144:159], v[56:59], a[56:59], 0
  v_mul_f32 v160, v160, v25
  v_mul_f32 v176, v176, v26
  v_mul_f32 v161, v161, v25
  v_mul_f32 v177, v177, v26
  v_mul_f32 v162, v162, v25
  v_mfma_f32_32x32x16_bf16 a[128:143], a[80:83], v[8:11], a[128:143]
  v_mul_f32 v178, v178, v26
  v_mul_f32 v163, v163, v25
  v_mul_f32 v179, v179, v26
  v_mul_f32 v164, v164, v25
  v_mul_f32 v180, v180, v26
  v_mfma_f32_32x32x16_bf16 a[144:159], a[112:115], v[8:11], a[144:159]
  v_mul_f32 v165, v165, v25
  v_mul_f32 v181, v181, v26
  v_mul_f32 v166, v166, v25
  v_mul_f32 v182, v182, v26
  v_mul_f32 v167, v167, v25
  v_mfma_f32_32x32x16_bf16 a[160:175], a[80:83], v[12:15], a[160:175]
  v_mul_f32 v183, v183, v26
  v_cvt_pk_bf16_f32 v16, v160, v161
  v_cvt_pk_bf16_f32 v20, v176, v177
  v_cvt_pk_bf16_f32 v17, v162, v163
  v_cvt_pk_bf16_f32 v21, v178, v179
  v_mfma_f32_32x32x16_bf16 a[176:191], a[112:115], v[12:15], a[176:191]
  v_cvt_pk_bf16_f32 v18, v164, v165
  v_cvt_pk_bf16_f32 v22, v180, v181
  v_cvt_pk_bf16_f32 v19, v166, v167
  v_cvt_pk_bf16_f32 v23, v182, v183
  s_nop 1
  s_waitcnt vmcnt(21)
  v_cvt_pk_bf16_f32 v60, v120, v121
  v_cvt_pk_bf16_f32 v61, v122, v123
  v_cvt_pk_bf16_f32 v62, v124, v125
  v_cvt_pk_bf16_f32 v63, v126, v127
  s_nop 1
  v_mfma_f32_32x32x16_bf16 v[160:175], v[60:63], a[28:31], 0
  v_add_f32 v25, v136, v24
  v_add_f32 v26, v152, v24
  v_rcp_f32 v25, v25
  v_rcp_f32 v26, v26
  s_nop 0
  v_mfma_f32_32x32x16_bf16 v[176:191], v[60:63], a[60:63], 0
  v_mul_f32 v128, v128, v25
  v_mul_f32 v144, v144, v26
  v_mul_f32 v129, v129, v25
  v_mul_f32 v145, v145, v26
  v_mul_f32 v130, v130, v25
  v_mfma_f32_32x32x16_bf16 a[128:143], a[84:87], v[16:19], a[128:143]
  v_mul_f32 v146, v146, v26
  v_mul_f32 v131, v131, v25
  v_mul_f32 v147, v147, v26
  v_mul_f32 v132, v132, v25
  v_mul_f32 v148, v148, v26
  v_mfma_f32_32x32x16_bf16 a[144:159], a[116:119], v[16:19], a[144:159]
  v_mul_f32 v133, v133, v25
  v_mul_f32 v149, v149, v26
  v_mul_f32 v134, v134, v25
  v_mul_f32 v150, v150, v26
  v_mul_f32 v135, v135, v25
  v_mfma_f32_32x32x16_bf16 a[160:175], a[84:87], v[20:23], a[160:175]
  v_mul_f32 v151, v151, v26
  v_cvt_pk_bf16_f32 v8, v128, v129
  v_cvt_pk_bf16_f32 v12, v144, v145
  v_cvt_pk_bf16_f32 v9, v130, v131
  v_cvt_pk_bf16_f32 v13, v146, v147
  v_mfma_f32_32x32x16_bf16 a[176:191], a[116:119], v[20:23], a[176:191]
  v_cvt_pk_bf16_f32 v10, v132, v133
  v_cvt_pk_bf16_f32 v14, v148, v149
  v_cvt_pk_bf16_f32 v11, v134, v135
  v_cvt_pk_bf16_f32 v15, v150, v151
  s_nop 1
  v_mfma_f32_32x32x16_bf16 a[128:143], a[88:91], v[8:11], a[128:143]
  v_add_f32 v25, v168, v24
  v_add_f32 v26, v184, v24
  v_rcp_f32 v25, v25
  v_rcp_f32 v26, v26
  s_nop 0
  v_mul_f32 v160, v160, v25
  v_mul_f32 v176, v176, v26
  v_mul_f32 v161, v161, v25
  v_mfma_f32_32x32x16_bf16 a[144:159], a[120:123], v[8:11], a[144:159]
  v_mul_f32 v177, v177, v26
  v_mul_f32 v162, v162, v25
  v_mul_f32 v178, v178, v26
  v_mul_f32 v163, v163, v25
  v_mul_f32 v179, v179, v26
  v_mul_f32 v164, v164, v25
  v_mul_f32 v180, v180, v26
  v_mul_f32 v165, v165, v25
  v_mfma_f32_32x32x16_bf16 a[160:175], a[88:91], v[12:15], a[160:175]
  v_mul_f32 v181, v181, v26
  v_mul_f32 v166, v166, v25
  v_mul_f32 v182, v182, v26
  v_mul_f32 v167, v167, v25
  v_mul_f32 v183, v183, v26
  v_cvt_pk_bf16_f32 v16, v160, v161
  v_cvt_pk_bf16_f32 v20, v176, v177
  v_cvt_pk_bf16_f32 v17, v162, v163
  v_mfma_f32_32x32x16_bf16 a[176:191], a[120:123], v[12:15], a[176:191]
  v_cvt_pk_bf16_f32 v21, v178, v179
  v_cvt_pk_bf16_f32 v18, v164, v165
  v_cvt_pk_bf16_f32 v22, v180, v181
  v_cvt_pk_bf16_f32 v19, v166, v167
  v_cvt_pk_bf16_f32 v23, v182, v183
  s_nop 1
  v_mfma_f32_32x32x16_bf16 a[128:143], a[92:95], v[16:19], a[128:143]
  v_mfma_f32_32x32x16_bf16 a[144:159], a[124:127], v[16:19], a[144:159]
  v_mfma_f32_32x32x16_bf16 a[160:175], a[92:95], v[20:23], a[160:175]
  v_mfma_f32_32x32x16_bf16 a[176:191], a[124:127], v[20:23], a[176:191]
  s_nop 1
  s_nop 7
  s_nop 3
  v_lshlrev_b32 v7, 4, v0
  s_xor_b32 s8, s3, 1
  s_mulk_i32 s8, 12288
  s_add_u32 s8, s8, 98304
  v_add_u32 v6, s8, v7
  ds_write_b128 v6, a[144:147] offset:0
  ds_write_b128 v6, a[148:151] offset:1024
  ds_write_b128 v6, a[152:155] offset:2048
  ds_write_b128 v6, a[156:159] offset:3072
  s_xor_b32 s8, s3, 2
  s_mulk_i32 s8, 12288
  s_add_u32 s8, s8, 98304
  v_add_u32 v6, s8, v7
  ds_write_b128 v6, a[160:163] offset:4096
  ds_write_b128 v6, a[164:167] offset:5120
  ds_write_b128 v6, a[168:171] offset:6144
  ds_write_b128 v6, a[172:175] offset:7168
  s_xor_b32 s8, s3, 3
  s_mulk_i32 s8, 12288
  s_add_u32 s8, s8, 98304
  v_add_u32 v6, s8, v7
  ds_write_b128 v6, a[176:179] offset:8192
  ds_write_b128 v6, a[180:183] offset:9216
  ds_write_b128 v6, a[184:187] offset:10240
  ds_write_b128 v6, a[188:191] offset:11264
  v_accvgpr_read_b32 v64, a128
  v_accvgpr_read_b32 v65, a129
  v_accvgpr_read_b32 v66, a130
  v_accvgpr_read_b32 v67, a131
  v_accvgpr_read_b32 v68, a132
  v_accvgpr_read_b32 v69, a133
  v_accvgpr_read_b32 v70, a134
  v_accvgpr_read_b32 v71, a135
  v_accvgpr_read_b32 v72, a136
  v_accvgpr_read_b32 v73, a137
  v_accvgpr_read_b32 v74, a138
  v_accvgpr_read_b32 v75, a139
  v_accvgpr_read_b32 v76, a140
  v_accvgpr_read_b32 v77, a141
  v_accvgpr_read_b32 v78, a142
  v_accvgpr_read_b32 v79, a143
  s_mul_i32 s8, s3, 12288
  s_add_u32 s8, s8, 98304
  v_add_u32 v6, s8, v7
  s_waitcnt lgkmcnt(0)
  s_barrier
  ds_read_b128 v[80:83], v6 offset:0
  ds_read_b128 v[84:87], v6 offset:1024
  ds_read_b128 v[88:91], v6 offset:2048
  ds_read_b128 v[92:95], v6 offset:3072
  ds_read_b128 v[96:99], v6 offset:4096
  ds_read_b128 v[100:103], v6 offset:5120
  ds_read_b128 v[104:107], v6 offset:6144
  ds_read_b128 v[108:111], v6 offset:7168
  ds_read_b128 v[112:115], v6 offset:8192
  ds_read_b128 v[116:119], v6 offset:9216
  ds_read_b128 v[120:123], v6 offset:10240
  ds_read_b128 v[124:127], v6 offset:11264
  s_waitcnt lgkmcnt(8)
  v_pk_add_f32 v[64:65], v[64:65], v[80:81]
  v_pk_add_f32 v[66:67], v[66:67], v[82:83]
  v_pk_add_f32 v[68:69], v[68:69], v[84:85]
  v_pk_add_f32 v[70:71], v[70:71], v[86:87]
  v_pk_add_f32 v[72:73], v[72:73], v[88:89]
  v_pk_add_f32 v[74:75], v[74:75], v[90:91]
  v_pk_add_f32 v[76:77], v[76:77], v[92:93]
  v_pk_add_f32 v[78:79], v[78:79], v[94:95]
  s_waitcnt lgkmcnt(0)
  v_pk_add_f32 v[96:97], v[96:97], v[112:113]
  v_pk_add_f32 v[98:99], v[98:99], v[114:115]
  v_pk_add_f32 v[100:101], v[100:101], v[116:117]
  v_pk_add_f32 v[102:103], v[102:103], v[118:119]
  v_pk_add_f32 v[104:105], v[104:105], v[120:121]
  v_pk_add_f32 v[106:107], v[106:107], v[122:123]
  v_pk_add_f32 v[108:109], v[108:109], v[124:125]
  v_pk_add_f32 v[110:111], v[110:111], v[126:127]
  v_pk_add_f32 v[64:65], v[64:65], v[96:97]
  v_pk_add_f32 v[66:67], v[66:67], v[98:99]
  v_pk_add_f32 v[68:69], v[68:69], v[100:101]
  v_pk_add_f32 v[70:71], v[70:71], v[102:103]
  v_pk_add_f32 v[72:73], v[72:73], v[104:105]
  v_pk_add_f32 v[74:75], v[74:75], v[106:107]
  v_pk_add_f32 v[76:77], v[76:77], v[108:109]
  v_pk_add_f32 v[78:79], v[78:79], v[110:111]
  s_waitcnt vmcnt(17)
  v_lshlrev_b32 v8, 16, v200
  v_and_b32 v9, 0xffff0000, v200
  v_pk_add_f32 v[64:65], v[64:65], v[8:9]
  v_lshlrev_b32 v10, 16, v201
  v_and_b32 v11, 0xffff0000, v201
  v_pk_add_f32 v[66:67], v[66:67], v[10:11]
  v_lshlrev_b32 v12, 16, v202
  v_and_b32 v13, 0xffff0000, v202
  v_pk_add_f32 v[68:69], v[68:69], v[12:13]
  v_lshlrev_b32 v14, 16, v203
  v_and_b32 v15, 0xffff0000, v203
  v_pk_add_f32 v[70:71], v[70:71], v[14:15]
  v_lshlrev_b32 v8, 16, v204
  v_and_b32 v9, 0xffff0000, v204
  v_pk_add_f32 v[72:73], v[72:73], v[8:9]
  v_lshlrev_b32 v10, 16, v205
  v_and_b32 v11, 0xffff0000, v205
  v_pk_add_f32 v[74:75], v[74:75], v[10:11]
  v_lshlrev_b32 v12, 16, v206
  v_and_b32 v13, 0xffff0000, v206
  v_pk_add_f32 v[76:77], v[76:77], v[12:13]
  v_lshlrev_b32 v14, 16, v207
  v_and_b32 v15, 0xffff0000, v207
  v_pk_add_f32 v[78:79], v[78:79], v[14:15]
  v_cvt_pk_bf16_f32 v240, v64, v65
  v_cvt_pk_bf16_f32 v241, v66, v67
  v_cvt_pk_bf16_f32 v242, v68, v69
  v_cvt_pk_bf16_f32 v243, v70, v71
  v_cvt_pk_bf16_f32 v244, v72, v73
  v_cvt_pk_bf16_f32 v245, v74, v75
  v_cvt_pk_bf16_f32 v246, v76, v77
  v_cvt_pk_bf16_f32 v247, v78, v79
  s_lshl_b32 s8, s70, 5
  s_lshl_b32 s9, s69, 2
  s_add_u32 s8, s8, s9
  s_lshl_b32 s9, s71, 1
  s_add_u32 s8, s8, s9
  s_lshl_b32 s8, s8, 10
  buffer_store_dwordx4 v[240:243], v2, s[52:55], s8 offen sc1
  buffer_store_dwordx4 v[244:247], v2, s[52:55], s8 offen offset:1024 sc1
  v_mov_b32 v16, 0
  v_mov_b32 v17, 0
  v_mov_b32 v18, 0
  v_mov_b32 v19, 0
  v_dot2c_f32_bf16 v16, 0x3f803f80, v240
  v_dot2c_f32_bf16 v18, v240, v240
  v_dot2c_f32_bf16 v17, 0x3f803f80, v241
  v_dot2c_f32_bf16 v19, v241, v241
  v_dot2c_f32_bf16 v16, 0x3f803f80, v242
  v_dot2c_f32_bf16 v18, v242, v242
  v_dot2c_f32_bf16 v17, 0x3f803f80, v243
  v_dot2c_f32_bf16 v19, v243, v243
  v_dot2c_f32_bf16 v16, 0x3f803f80, v244
  v_dot2c_f32_bf16 v18, v244, v244
  v_dot2c_f32_bf16 v17, 0x3f803f80, v245
  v_dot2c_f32_bf16 v19, v245, v245
  v_dot2c_f32_bf16 v16, 0x3f803f80, v246
  v_dot2c_f32_bf16 v18, v246, v246
  v_dot2c_f32_bf16 v17, 0x3f803f80, v247
  v_dot2c_f32_bf16 v19, v247, v247
  s_nop 2
  v_add_f32 v10, v16, v17
  v_add_f32 v11, v18, v19
  v_mov_b32 v12, v10
  s_nop 1
  v_permlane32_swap_b32 v10, v12
  s_nop 1
  v_add_f32 v10, v10, v12
  v_mov_b32 v12, v11
  s_nop 1
  v_permlane32_swap_b32 v11, v12
  s_nop 1
  v_add_f32 v11, v11, v12
  s_lshl_b32 s8, s70, 12
  s_lshl_b32 s9, s69, 9
  s_add_u32 s8, s8, s9
  s_lshl_b32 s9, s71, 8
  s_add_u32 s8, s8, s9
  v_lshlrev_b32 v6, 3, v3
  buffer_store_dwordx2 v[10:11], v6, s[56:59], s8 offen sc1
  s_waitcnt vmcnt(4)
  v_add_f32 v208, v208, v216
  v_add_f32 v209, v209, v217
  v_add_f32 v210, v210, v218
  v_add_f32 v211, v211, v219
  v_add_f32 v212, v212, v220
  v_add_f32 v213, v213, v221
  v_add_f32 v214, v214, v222
  v_add_f32 v215, v215, v223
  v_add_f32 v208, v208, v212
  v_add_f32 v209, v209, v213
  v_add_f32 v210, v210, v214
  v_add_f32 v211, v211, v215
  v_add_f32 v208, v208, v210
  v_add_f32 v209, v209, v211
  v_add_f32 v208, v208, v209
  v_add_u32 v7, 147456, v230
  ds_write_b32 v7, v208
  s_add_u32 m0, s81, 0
  s_add_u32 s82, s79, 0
  buffer_load_dwordx4 v2, s[60:63], s82 offen offset:0 lds
  buffer_load_dwordx4 v2, s[60:63], s82 offen offset:1024 lds
  buffer_load_dwordx4 v2, s[60:63], s82 offen offset:2048 lds
  buffer_load_dwordx4 v2, s[60:63], s82 offen offset:3072 lds
  s_add_u32 m0, s81, 4096
  s_add_u32 s82, s79, 4096
  buffer_load_dwordx4 v2, s[60:63], s82 offen offset:0 lds
  buffer_load_dwordx4 v2, s[60:63], s82 offen offset:1024 lds
  buffer_load_dwordx4 v2, s[60:63], s82 offen offset:2048 lds
  buffer_load_dwordx4 v2, s[60:63], s82 offen offset:3072 lds
  s_waitcnt vmcnt(8) lgkmcnt(0)
  s_barrier
  s_lshr_b32 s83, s68, 1
  s_lshl_b32 s83, s83, 7
  s_cmp_lg_u32 s3, 0
  s_cbranch_scc1 kf_sig1
  v_mov_b32 v250, 1
  v_mov_b32 v251, 0
  s_mov_b64 exec, 1
  buffer_atomic_add v250, v251, s[64:67], s83 offen sc1
  s_mov_b64 exec, -1
kf_sig1:
  s_add_u32 m0, s81, 32768
  s_add_u32 s82, s79, 16384
  buffer_load_dwordx4 v2, s[60:63], s82 offen offset:0 lds
  buffer_load_dwordx4 v2, s[60:63], s82 offen offset:1024 lds
  buffer_load_dwordx4 v2, s[60:63], s82 offen offset:2048 lds
  buffer_load_dwordx4 v2, s[60:63], s82 offen offset:3072 lds
  s_add_u32 m0, s81, 36864
  s_add_u32 s82, s79, 20480
  buffer_load_dwordx4 v2, s[60:63], s82 offen offset:0 lds
  buffer_load_dwordx4 v2, s[60:63], s82 offen offset:1024 lds
  buffer_load_dwordx4 v2, s[60:63], s82 offen offset:2048 lds
  buffer_load_dwordx4 v2, s[60:63], s82 offen offset:3072 lds
  s_add_u32 m0, s81, 65536
  s_add_u32 s82, s80, 65536
  buffer_load_dwordx4 v2, s[60:63], s82 offen offset:0 lds
  buffer_load_dwordx4 v2, s[60:63], s82 offen offset:1024 lds
  buffer_load_dwordx4 v2, s[60:63], s82 offen offset:2048 lds
  buffer_load_dwordx4 v2, s[60:63], s82 offen offset:3072 lds
  s_add_u32 m0, s81, 69632
  s_add_u32 s82, s80, 69632
  buffer_load_dwordx4 v2, s[60:63], s82 offen offset:0 lds
  buffer_load_dwordx4 v2, s[60:63], s82 offen offset:1024 lds
  buffer_load_dwordx4 v2, s[60:63], s82 offen offset:2048 lds
  buffer_load_dwordx4 v2, s[60:63], s82 offen offset:3072 lds
  s_add_u32 s40, s34, 3145728
  s_addc_u32 s41, s35, 0
  s_mov_b32 s42, 2097152
  s_mov_b32 s43, 0x20000
  s_add_u32 s44, s34, 131072
  s_addc_u32 s45, s35, 0
  s_mov_b32 s46, 262144
  s_mov_b32 s47, 0x20000
  s_add_u32 s52, s34, 5242880
  s_addc_u32 s53, s35, 0
  s_mov_b32 s54, 7340032
  s_mov_b32 s55, 0x20000
  s_add_u32 s56, s34, 17825792
  s_addc_u32 s57, s35, 0
  s_mov_b32 s58, 1835008
  s_mov_b32 s59, 0x20000
  s_lshl_b32 s6, s72, 2
  s_add_u32 s6, s6, s3
  s_lshl_b32 s11, s6, 15
  v_lshlrev_b32 v4, 3, v3
  v_lshl_add_u32 v4, v5, 11, v4
  v_lshlrev_b32 v11, 4, v5
  v_add_u32 v11, 147456, v11
  v_mov_b32 v12, v2
  v_add_u32 v13, 0x10000, v2
  s_mul_i32 s14, s6, 112
  s_add_u32 s14, s14, s78
  s_lshl_b32 s14, s14, 10
  s_mul_i32 s8, s3, 28
  s_lshl_b32 s84, s69, 1
  s_add_u32 s84, s84, s71
  s_xor_b32 s85, s84, 1
  s_mul_i32 s84, s84, 112
  s_add_u32 s84, s84, s8
  s_lshl_b32 s84, s84, 10
  s_mul_i32 s85, s85, 112
  s_add_u32 s85, s85, s8
  s_lshl_b32 s85, s85, 10
  s_add_u32 m0, s81, 98304
  s_add_u32 s82, s80, 98304
  buffer_load_dwordx4 v2, s[60:63], s82 offen offset:0 lds
  buffer_load_dwordx4 v2, s[60:63], s82 offen offset:1024 lds
  buffer_load_dwordx4 v2, s[60:63], s82 offen offset:2048 lds
  buffer_load_dwordx4 v2, s[60:63], s82 offen offset:3072 lds
  s_add_u32 m0, s81, 102400
  s_add_u32 s82, s80, 102400
  buffer_load_dwordx4 v2, s[60:63], s82 offen offset:0 lds
  buffer_load_dwordx4 v2, s[60:63], s82 offen offset:1024 lds
  buffer_load_dwordx4 v2, s[60:63], s82 offen offset:2048 lds
  buffer_load_dwordx4 v2, s[60:63], s82 offen offset:3072 lds
  s_lshl_b32 s83, s72, 7
  s_cmp_lg_u32 s3, 0
  s_cbranch_scc1 kf_w1_done
  v_mov_b32 v251, 0
  s_mov_b32 s76, 0
kf_w1:
  buffer_load_dword v250, v251, s[64:67], s83 offen sc1
  s_waitcnt vmcnt(0)
  v_readfirstlane_b32 s77, v250
  s_add_u32 s76, s76, 1
  s_nop 2
  s_cmp_ge_u32 s77, 16
  s_cbranch_scc1 kf_w1_done
  s_cmp_ge_u32 s76, 0x20000
  s_cbranch_scc1 kf_w1_done
  s_sleep 1
  s_branch kf_w1
kf_w1_done:
  s_barrier
  s_add_u32 s13, s11, 0
  buffer_load_dwordx4 a[0:3], v2, s[40:43], s13 offen offset:0 sc1
  buffer_load_dwordx4 a[4:7], v2, s[40:43], s13 offen offset:1024 sc1
  buffer_load_dwordx4 a[8:11], v2, s[40:43], s13 offen offset:2048 sc1
  buffer_load_dwordx4 a[12:15], v2, s[40:43], s13 offen offset:3072 sc1
  s_add_u32 s13, s11, 4096
  buffer_load_dwordx4 a[16:19], v2, s[40:43], s13 offen offset:0 sc1
  buffer_load_dwordx4 a[20:23], v2, s[40:43], s13 offen offset:1024 sc1
  buffer_load_dwordx4 a[24:27], v2, s[40:43], s13 offen offset:2048 sc1
  buffer_load_dwordx4 a[28:31], v2, s[40:43], s13 offen offset:3072 sc1
  s_add_u32 s13, s11, 8192
  buffer_load_dwordx4 a[32:35], v2, s[40:43], s13 offen offset:0 sc1
  buffer_load_dwordx4 a[36:39], v2, s[40:43], s13 offen offset:1024 sc1
  buffer_load_dwordx4 a[40:43], v2, s[40:43], s13 offen offset:2048 sc1
  buffer_load_dwordx4 a[44:47], v2, s[40:43], s13 offen offset:3072 sc1
  s_add_u32 s13, s11, 12288
  buffer_load_dwordx4 a[48:51], v2, s[40:43], s13 offen offset:0 sc1
  buffer_load_dwordx4 a[52:55], v2, s[40:43], s13 offen offset:1024 sc1
  buffer_load_dwordx4 a[56:59], v2, s[40:43], s13 offen offset:2048 sc1
  buffer_load_dwordx4 a[60:63], v2, s[40:43], s13 offen offset:3072 sc1
  s_waitcnt vmcnt(15)
  s_barrier
  ds_read_b128 v[16:19], v12 offset:0
  ds_read_b128 v[20:23], v12 offset:16384
  ds_read_b128 v[24:27], v12 offset:1024
  ds_read_b128 v[28:31], v12 offset:17408
  ds_read_b128 v[32:35], v12 offset:2048
  ds_read_b128 v[36:39], v12 offset:18432
  ds_read_b128 v[40:43], v12 offset:3072
  ds_read_b128 v[44:47], v12 offset:19456
  s_waitcnt vmcnt(14)
  ds_read_b128 v[48:51], v12 offset:4096
  s_waitcnt lgkmcnt(7)
  v_mfma_f32_32x32x16_bf16 v[64:79], v[16:19], a[0:3], 0
  ds_read_b128 v[52:55], v12 offset:20480
  v_mfma_f32_32x32x16_bf16 v[80:95], v[20:23], a[0:3], 0
  s_add_u32 s13, s11, 16384
  buffer_load_dwordx4 a[64:67], v2, s[40:43], s13 offen offset:0 sc1
  ds_read_b128 v[56:59], v12 offset:5120
  s_waitcnt lgkmcnt(7)
  v_mfma_f32_32x32x16_bf16 v[64:79], v[24:27], a[4:7], v[64:79]
  ds_read_b128 v[60:63], v12 offset:21504
  v_mfma_f32_32x32x16_bf16 v[80:95], v[28:31], a[4:7], v[80:95]
  buffer_load_dwordx4 a[68:71], v2, s[40:43], s13 offen offset:1024 sc1
  s_waitcnt vmcnt(14)
  ds_read_b128 v[16:19], v12 offset:6144
  s_waitcnt lgkmcnt(7)
  v_mfma_f32_32x32x16_bf16 v[64:79], v[32:35], a[8:11], v[64:79]
  ds_read_b128 v[20:23], v12 offset:22528
  v_mfma_f32_32x32x16_bf16 v[80:95], v[36:39], a[8:11], v[80:95]
  buffer_load_dwordx4 a[72:75], v2, s[40:43], s13 offen offset:2048 sc1
  ds_read_b128 v[24:27], v12 offset:7168
  s_waitcnt lgkmcnt(7)
  v_mfma_f32_32x32x16_bf16 v[64:79], v[40:43], a[12:15], v[64:79]
  ds_read_b128 v[28:31], v12 offset:23552
  v_mfma_f32_32x32x16_bf16 v[80:95], v[44:47], a[12:15], v[80:95]
  buffer_load_dwordx4 a[76:79], v2, s[40:43], s13 offen offset:3072 sc1
  s_waitcnt vmcnt(14)
  ds_read_b128 v[32:35], v12 offset:8192
  s_waitcnt lgkmcnt(7)
  v_mfma_f32_32x32x16_bf16 v[64:79], v[48:51], a[16:19], v[64:79]
  ds_read_b128 v[36:39], v12 offset:24576
  v_mfma_f32_32x32x16_bf16 v[80:95], v[52:55], a[16:19], v[80:95]
  s_add_u32 s13, s11, 20480
  buffer_load_dwordx4 a[80:83], v2, s[40:43], s13 offen offset:0 sc1
  ds_read_b128 v[40:43], v12 offset:9216
  s_waitcnt lgkmcnt(7)
  v_mfma_f32_32x32x16_bf16 v[64:79], v[56:59], a[20:23], v[64:79]
  ds_read_b128 v[44:47], v12 offset:25600
  v_mfma_f32_32x32x16_bf16 v[80:95], v[60:63], a[20:23], v[80:95]
  buffer_load_dwordx4 a[84:87], v2, s[40:43], s13 offen offset:1024 sc1
  s_waitcnt vmcnt(14)
  ds_read_b128 v[48:51], v12 offset:10240
  s_waitcnt lgkmcnt(7)
  v_mfma_f32_32x32x16_bf16 v[64:79], v[16:19], a[24:27], v[64:79]
  ds_read_b128 v[52:55], v12 offset:26624
  v_mfma_f32_32x32x16_bf16 v[80:95], v[20:23], a[24:27], v[80:95]
  buffer_load_dwordx4 a[88:91], v2, s[40:43], s13 offen offset:2048 sc1
  ds_read_b128 v[56:59], v12 offset:11264
  s_waitcnt lgkmcnt(7)
  v_mfma_f32_32x32x16_bf16 v[64:79], v[24:27], a[28:31], v[64:79]
  ds_read_b128 v[60:63], v12 offset:27648
  v_mfma_f32_32x32x16_bf16 v[80:95], v[28:31], a[28:31], v[80:95]
  buffer_load_dwordx4 a[92:95], v2, s[40:43], s13 offen offset:3072 sc1
  s_waitcnt vmcnt(14)
  ds_read_b128 v[16:19], v12 offset:12288
  s_waitcnt lgkmcnt(7)
  v_mfma_f32_32x32x16_bf16 v[64:79], v[32:35], a[32:35], v[64:79]
  ds_read_b128 v[20:23], v12 offset:28672
  v_mfma_f32_32x32x16_bf16 v[80:95], v[36:39], a[32:35], v[80:95]
  s_add_u32 s13, s11, 24576
  buffer_load_dwordx4 a[96:99], v2, s[40:43], s13 offen offset:0 sc1
  ds_read_b128 v[24:27], v12 offset:13312
  s_waitcnt lgkmcnt(7)
  v_mfma_f32_32x32x16_bf16 v[64:79], v[40:43], a[36:39], v[64:79]
  ds_read_b128 v[28:31], v12 offset:29696
  v_mfma_f32_32x32x16_bf16 v[80:95], v[44:47], a[36:39], v[80:95]
  buffer_load_dwordx4 a[100:103], v2, s[40:43], s13 offen offset:1024 sc1
  s_waitcnt vmcnt(14)
  ds_read_b128 v[32:35], v12 offset:14336
  s_waitcnt lgkmcnt(7)
  v_mfma_f32_32x32x16_bf16 v[64:79], v[48:51], a[40:43], v[64:79]
  ds_read_b128 v[36:39], v12 offset:30720
  v_mfma_f32_32x32x16_bf16 v[80:95], v[52:55], a[40:43], v[80:95]
  buffer_load_dwordx4 a[104:107], v2, s[40:43], s13 offen offset:2048 sc1
  ds_read_b128 v[40:43], v12 offset:15360
  s_waitcnt lgkmcnt(7)
  v_mfma_f32_32x32x16_bf16 v[64:79], v[56:59], a[44:47], v[64:79]
  ds_read_b128 v[44:47], v12 offset:31744
  v_mfma_f32_32x32x16_bf16 v[80:95], v[60:63], a[44:47], v[80:95]
  buffer_load_dwordx4 a[108:111], v2, s[40:43], s13 offen offset:3072 sc1
  s_waitcnt vmcnt(14)
  ds_read_b128 v[48:51], v12 offset:32768
  s_waitcnt lgkmcnt(7)
  v_mfma_f32_32x32x16_bf16 v[64:79], v[16:19], a[48:51], v[64:79]
  ds_read_b128 v[52:55], v12 offset:49152
  v_mfma_f32_32x32x16_bf16 v[80:95], v[20:23], a[48:51], v[80:95]
  s_add_u32 s13, s11, 28672
  buffer_load_dwordx4 a[112:115], v2, s[40:43], s13 offen offset:0 sc1
  ds_read_b128 v[56:59], v12 offset:33792
  s_waitcnt lgkmcnt(7)
  v_mfma_f32_32x32x16_bf16 v[64:79], v[24:27], a[52:55], v[64:79]
  ds_read_b128 v[60:63], v12 offset:50176
  v_mfma_f32_32x32x16_bf16 v[80:95], v[28:31], a[52:55], v[80:95]
  buffer_load_dwordx4 a[116:119], v2, s[40:43], s13 offen offset:1024 sc1
  s_waitcnt vmcnt(14)
  ds_read_b128 v[16:19], v12 offset:34816
  s_waitcnt lgkmcnt(7)
  v_mfma_f32_32x32x16_bf16 v[64:79], v[32:35], a[56:59], v[64:79]
  ds_read_b128 v[20:23], v12 offset:51200
  v_mfma_f32_32x32x16_bf16 v[80:95], v[36:39], a[56:59], v[80:95]
  buffer_load_dwordx4 a[120:123], v2, s[40:43], s13 offen offset:2048 sc1
  ds_read_b128 v[24:27], v12 offset:35840
  s_waitcnt lgkmcnt(7)
  v_mfma_f32_32x32x16_bf16 v[64:79], v[40:43], a[60:63], v[64:79]
  ds_read_b128 v[28:31], v12 offset:52224
  v_mfma_f32_32x32x16_bf16 v[80:95], v[44:47], a[60:63], v[80:95]
  buffer_load_dwordx4 a[124:127], v2, s[40:43], s13 offen offset:3072 sc1
  s_waitcnt vmcnt(14)
  ds_read_b128 v[32:35], v12 offset:36864
  s_waitcnt lgkmcnt(7)
  v_mfma_f32_32x32x16_bf16 v[64:79], v[48:51], a[64:67], v[64:79]
  ds_read_b128 v[36:39], v12 offset:53248
  v_mfma_f32_32x32x16_bf16 v[80:95], v[52:55], a[64:67], v[80:95]
  s_lshl_b32 s15, s6, 12
  buffer_load_dwordx2 v[212:213], v4, s[44:47], s15 offen sc1
  ds_read_b128 v[40:43], v12 offset:37888
  s_waitcnt lgkmcnt(7)
  v_mfma_f32_32x32x16_bf16 v[64:79], v[56:59], a[68:71], v[64:79]
  ds_read_b128 v[44:47], v12 offset:54272
  v_mfma_f32_32x32x16_bf16 v[80:95], v[60:63], a[68:71], v[80:95]
  buffer_load_dwordx2 v[214:215], v4, s[44:47], s15 offen offset:256 sc1
  s_waitcnt vmcnt(14)
  ds_read_b128 v[48:51], v12 offset:38912
  s_waitcnt lgkmcnt(7)
  v_mfma_f32_32x32x16_bf16 v[64:79], v[16:19], a[72:75], v[64:79]
  ds_read_b128 v[52:55], v12 offset:55296
  v_mfma_f32_32x32x16_bf16 v[80:95], v[20:23], a[72:75], v[80:95]
  buffer_load_dwordx2 v[216:217], v4, s[44:47], s15 offen offset:512 sc1
  ds_read_b128 v[56:59], v12 offset:39936
  s_waitcnt lgkmcnt(7)
  v_mfma_f32_32x32x16_bf16 v[64:79], v[24:27], a[76:79], v[64:79]
  ds_read_b128 v[60:63], v12 offset:56320
  v_mfma_f32_32x32x16_bf16 v[80:95], v[28:31], a[76:79], v[80:95]
  buffer_load_dwordx2 v[218:219], v4, s[44:47], s15 offen offset:768 sc1
  s_waitcnt vmcnt(14)
  ds_read_b128 v[16:19], v12 offset:40960
  s_waitcnt lgkmcnt(7)
  v_mfma_f32_32x32x16_bf16 v[64:79], v[32:35], a[80:83], v[64:79]
  ds_read_b128 v[20:23], v12 offset:57344
  v_mfma_f32_32x32x16_bf16 v[80:95], v[36:39], a[80:83], v[80:95]
  buffer_load_dwordx2 v[220:221], v4, s[44:47], s15 offen offset:1024 sc1
  ds_read_b128 v[24:27], v12 offset:41984
  s_waitcnt lgkmcnt(7)
  v_mfma_f32_32x32x16_bf16 v[64:79], v[40:43], a[84:87], v[64:79]
  ds_read_b128 v[28:31], v12 offset:58368
  v_mfma_f32_32x32x16_bf16 v[80:95], v[44:47], a[84:87], v[80:95]
  buffer_load_dwordx2 v[222:223], v4, s[44:47], s15 offen offset:1280 sc1
  s_waitcnt vmcnt(14)
  ds_read_b128 v[32:35], v12 offset:43008
  s_waitcnt lgkmcnt(7)
  v_mfma_f32_32x32x16_bf16 v[64:79], v[48:51], a[88:91], v[64:79]
  ds_read_b128 v[36:39], v12 offset:59392
  v_mfma_f32_32x32x16_bf16 v[80:95], v[52:55], a[88:91], v[80:95]
  buffer_load_dwordx2 v[224:225], v4, s[44:47], s15 offen offset:1536 sc1
  ds_read_b128 v[40:43], v12 offset:44032
  s_waitcnt lgkmcnt(7)
  v_mfma_f32_32x32x16_bf16 v[64:79], v[56:59], a[92:95], v[64:79]
  ds_read_b128 v[44:47], v12 offset:60416
  v_mfma_f32_32x32x16_bf16 v[80:95], v[60:63], a[92:95], v[80:95]
  buffer_load_dwordx2 v[226:227], v4, s[44:47], s15 offen offset:1792 sc1
  s_waitcnt vmcnt(14)
  ds_read_b128 v[48:51], v12 offset:45056
  s_waitcnt lgkmcnt(7)
  v_mfma_f32_32x32x16_bf16 v[64:79], v[16:19], a[96:99], v[64:79]
  ds_read_b128 v[52:55], v12 offset:61440
  v_mfma_f32_32x32x16_bf16 v[80:95], v[20:23], a[96:99], v[80:95]
  ds_read_b128 v[56:59], v12 offset:46080
  s_waitcnt lgkmcnt(7)
  v_mfma_f32_32x32x16_bf16 v[64:79], v[24:27], a[100:103], v[64:79]
  ds_read_b128 v[176:179], v11 offset:0
  ds_read_b128 v[180:183], v11 offset:32
  ds_read_b128 v[184:187], v11 offset:64
  ds_read_b128 v[188:191], v11 offset:96
  ds_read_b128 v[60:63], v12 offset:62464
  v_mfma_f32_32x32x16_bf16 v[80:95], v[28:31], a[100:103], v[80:95]
  s_waitcnt vmcnt(12)
  ds_read_b128 v[16:19], v12 offset:47104
  s_waitcnt lgkmcnt(7)
  v_mfma_f32_32x32x16_bf16 v[64:79], v[32:35], a[104:107], v[64:79]
  ds_read_b128 v[20:23], v12 offset:63488
  v_mfma_f32_32x32x16_bf16 v[80:95], v[36:39], a[104:107], v[80:95]
  ds_read_b128 v[24:27], v12 offset:48128
  s_waitcnt lgkmcnt(7)
  v_mfma_f32_32x32x16_bf16 v[64:79], v[40:43], a[108:111], v[64:79]
  ds_read_b128 v[28:31], v12 offset:64512
  v_mfma_f32_32x32x16_bf16 v[80:95], v[44:47], a[108:111], v[80:95]
  s_barrier
  s_waitcnt vmcnt(10)
  ds_read_b128 v[32:35], v13 offset:0
  s_waitcnt lgkmcnt(7)
  v_mfma_f32_32x32x16_bf16 v[64:79], v[48:51], a[112:115], v[64:79]
  ds_read_b128 v[36:39], v13 offset:1024
  v_mfma_f32_32x32x16_bf16 v[80:95], v[52:55], a[112:115], v[80:95]
  s_add_u32 m0, s81, 0
  s_add_u32 s82, s80, 131072
  buffer_load_dwordx4 v2, s[60:63], s82 offen offset:0 lds
  ds_read_b128 v[40:43], v13 offset:2048
  s_waitcnt lgkmcnt(7)
  v_mfma_f32_32x32x16_bf16 v[64:79], v[56:59], a[116:119], v[64:79]
  ds_read_b128 v[44:47], v13 offset:3072
  v_mfma_f32_32x32x16_bf16 v[80:95], v[60:63], a[116:119], v[80:95]
  buffer_load_dwordx4 v2, s[60:63], s82 offen offset:1024 lds
  s_waitcnt vmcnt(10)
  ds_read_b128 v[48:51], v13 offset:4096
  s_waitcnt lgkmcnt(7)
  v_mfma_f32_32x32x16_bf16 v[64:79], v[16:19], a[120:123], v[64:79]
  ds_read_b128 v[52:55], v13 offset:5120
  v_mfma_f32_32x32x16_bf16 v[80:95], v[20:23], a[120:123], v[80:95]
  buffer_load_dwordx4 v2, s[60:63], s82 offen offset:2048 lds
  ds_read_b128 v[56:59], v13 offset:6144
  s_waitcnt lgkmcnt(7)
  v_mfma_f32_32x32x16_bf16 v[64:79], v[24:27], a[124:127], v[64:79]
  ds_read_b128 v[60:63], v13 offset:7168
  v_mfma_f32_32x32x16_bf16 v[80:95], v[28:31], a[124:127], v[80:95]
  buffer_load_dwordx4 v2, s[60:63], s82 offen offset:3072 lds
  ds_read_b128 v[16:19], v13 offset:8192
  s_waitcnt lgkmcnt(7)
  v_mfma_f32_32x32x16_bf16 v[96:111], v[32:35], a[0:3], 0
  ds_read_b128 v[20:23], v13 offset:9216
  v_mfma_f32_32x32x16_bf16 v[96:111], v[36:39], a[4:7], v[96:111]
  s_add_u32 m0, s81, 4096
  s_add_u32 s82, s80, 135168
  buffer_load_dwordx4 v2, s[60:63], s82 offen offset:0 lds
  s_waitcnt vmcnt(5)
  ds_read_b128 v[24:27], v13 offset:10240
  s_waitcnt lgkmcnt(7)
  v_mfma_f32_32x32x16_bf16 v[96:111], v[40:43], a[8:11], v[96:111]
  v_add_f32 v212, v212, v220
  v_add_f32 v213, v213, v221
  v_add_f32 v214, v214, v222
  ds_read_b128 v[28:31], v13 offset:11264
  v_mfma_f32_32x32x16_bf16 v[96:111], v[44:47], a[12:15], v[96:111]
  buffer_load_dwordx4 v2, s[60:63], s82 offen offset:1024 lds
  v_add_f32 v215, v215, v223
  v_add_f32 v216, v216, v224
  v_add_f32 v217, v217, v225
  v_add_f32 v218, v218, v226
  ds_read_b128 v[32:35], v13 offset:12288
  s_waitcnt lgkmcnt(7)
  v_mfma_f32_32x32x16_bf16 v[96:111], v[48:51], a[16:19], v[96:111]
  v_add_f32 v219, v219, v227
  v_add_f32 v212, v212, v216
  v_add_f32 v213, v213, v217
  v_add_f32 v214, v214, v218
  ds_read_b128 v[36:39], v13 offset:13312
  v_mfma_f32_32x32x16_bf16 v[96:111], v[52:55], a[20:23], v[96:111]
  buffer_load_dwordx4 v2, s[60:63], s82 offen offset:2048 lds
  v_add_f32 v215, v215, v219
  v_add_f32 v212, v212, v214
  v_add_f32 v213, v213, v215
  v_mov_b32 v216, v212
  ds_read_b128 v[40:43], v13 offset:14336
  s_waitcnt lgkmcnt(7)
  v_mfma_f32_32x32x16_bf16 v[96:111], v[56:59], a[24:27], v[96:111]
  v_mov_b32 v217, v213
  s_nop 1
  v_permlane32_swap_b32 v212, v216
  v_permlane32_swap_b32 v213, v217
  ds_read_b128 v[44:47], v13 offset:15360
  v_mfma_f32_32x32x16_bf16 v[96:111], v[60:63], a[28:31], v[96:111]
  buffer_load_dwordx4 v2, s[60:63], s82 offen offset:3072 lds
  s_nop 1
  v_add_f32 v212, v212, v216
  v_add_f32 v213, v213, v217
  v_mul_f32 v212, 0x3b000000, v212
  ds_read_b128 v[48:51], v13 offset:16384
  s_waitcnt lgkmcnt(7)
  v_mfma_f32_32x32x16_bf16 v[96:111], v[16:19], a[32:35], v[96:111]
  v_mul_f32 v213, 0x3b000000, v213
  v_fma_f32 v213, -v212, v212, v213
  v_max_f32 v213, 0, v213
  v_add_f32 v10, 0x3727c5ac, v213
  ds_read_b128 v[52:55], v13 offset:17408
  v_mfma_f32_32x32x16_bf16 v[96:111], v[20:23], a[36:39], v[96:111]
  v_rsq_f32 v213, v10
  v_sub_f32 v8, 0, v212
  v_mul_f32 v9, 0xbfb8aa3b, v213
  v_fmac_f32 v64, v8, v176
  ds_read_b128 v[56:59], v13 offset:18432
  s_waitcnt lgkmcnt(7)
  v_mfma_f32_32x32x16_bf16 v[96:111], v[24:27], a[40:43], v[96:111]
  v_fmac_f32 v65, v8, v177
  v_fmac_f32 v66, v8, v178
  v_fmac_f32 v67, v8, v179
  v_fmac_f32 v68, v8, v180
  ds_read_b128 v[60:63], v13 offset:19456
  v_mfma_f32_32x32x16_bf16 v[96:111], v[28:31], a[44:47], v[96:111]
  v_fmac_f32 v69, v8, v181
  v_fmac_f32 v70, v8, v182
  v_fmac_f32 v71, v8, v183
  v_fmac_f32 v72, v8, v184
  v_fmac_f32 v73, v8, v185
  ds_read_b128 v[16:19], v13 offset:20480
  s_waitcnt lgkmcnt(7)
  v_mfma_f32_32x32x16_bf16 v[96:111], v[32:35], a[48:51], v[96:111]
  v_fmac_f32 v74, v8, v186
  v_fmac_f32 v75, v8, v187
  v_fmac_f32 v76, v8, v188
  v_fmac_f32 v77, v8, v189
  ds_read_b128 v[20:23], v13 offset:21504
  v_mfma_f32_32x32x16_bf16 v[96:111], v[36:39], a[52:55], v[96:111]
  v_fmac_f32 v78, v8, v190
  v_fmac_f32 v79, v8, v191
  ds_read_b128 v[176:179], v11 offset:128
  ds_read_b128 v[180:183], v11 offset:160
  ds_read_b128 v[184:187], v11 offset:192
  ds_read_b128 v[24:27], v13 offset:22528
  s_waitcnt lgkmcnt(7)
  v_mfma_f32_32x32x16_bf16 v[96:111], v[40:43], a[56:59], v[96:111]
  ds_read_b128 v[188:191], v11 offset:224
  v_mul_f32 v192, v9, v64
  v_mul_f32 v193, v9, v65
  v_mul_f32 v194, v9, v66
  ds_read_b128 v[28:31], v13 offset:23552
  v_mfma_f32_32x32x16_bf16 v[96:111], v[44:47], a[60:63], v[96:111]
  v_mul_f32 v195, v9, v67
  v_mul_f32 v196, v9, v68
  v_mul_f32 v197, v9, v69
  v_mul_f32 v198, v9, v70
  v_mul_f32 v199, v9, v71
  ds_read_b128 v[32:35], v13 offset:24576
  s_waitcnt lgkmcnt(7)
  v_mfma_f32_32x32x16_bf16 v[96:111], v[48:51], a[64:67], v[96:111]
  v_exp_f32 v192, v192
  v_mul_f32 v200, v64, v72
  ds_read_b128 v[36:39], v13 offset:25600
  v_mfma_f32_32x32x16_bf16 v[96:111], v[52:55], a[68:71], v[96:111]
  v_exp_f32 v193, v193
  v_mul_f32 v201, v65, v73
  v_exp_f32 v194, v194
  ds_read_b128 v[40:43], v13 offset:26624
  s_waitcnt lgkmcnt(7)
  v_mfma_f32_32x32x16_bf16 v[96:111], v[56:59], a[72:75], v[96:111]
  v_mul_f32 v202, v66, v74
  v_exp_f32 v195, v195
  v_mul_f32 v203, v67, v75
  ds_read_b128 v[44:47], v13 offset:27648
  v_mfma_f32_32x32x16_bf16 v[96:111], v[60:63], a[76:79], v[96:111]
  v_exp_f32 v196, v196
  v_mul_f32 v204, v68, v76
  v_exp_f32 v197, v197
  ds_read_b128 v[48:51], v13 offset:28672
  s_waitcnt lgkmcnt(7)
  v_mfma_f32_32x32x16_bf16 v[96:111], v[16:19], a[80:83], v[96:111]
  v_mul_f32 v205, v69, v77
  v_exp_f32 v198, v198
  v_mul_f32 v206, v70, v78
  ds_read_b128 v[52:55], v13 offset:29696
  v_mfma_f32_32x32x16_bf16 v[96:111], v[20:23], a[84:87], v[96:111]
  v_exp_f32 v199, v199
  v_mul_f32 v207, v71, v79
  v_fma_f32 v192, v192, v10, v10
  v_fma_f32 v193, v193, v10, v10
  ds_read_b128 v[56:59], v13 offset:30720
  s_waitcnt lgkmcnt(7)
  v_mfma_f32_32x32x16_bf16 v[96:111], v[24:27], a[88:91], v[96:111]
  v_fma_f32 v194, v194, v10, v10
  v_fma_f32 v195, v195, v10, v10
  v_fma_f32 v196, v196, v10, v10
  v_fma_f32 v197, v197, v10, v10
  ds_read_b128 v[60:63], v13 offset:31744
  v_mfma_f32_32x32x16_bf16 v[96:111], v[28:31], a[92:95], v[96:111]
  v_fma_f32 v198, v198, v10, v10
  v_fma_f32 v199, v199, v10, v10
  v_rcp_f32 v192, v192
  s_waitcnt vmcnt(48)
  s_barrier
  ds_read_b128 v[16:19], v13 offset:32768
  s_waitcnt lgkmcnt(7)
  v_mfma_f32_32x32x16_bf16 v[96:111], v[32:35], a[96:99], v[96:111]
  v_rcp_f32 v193, v193
  ds_read_b128 v[20:23], v13 offset:33792
  v_mfma_f32_32x32x16_bf16 v[96:111], v[36:39], a[100:103], v[96:111]
  s_add_u32 m0, s81, 32768
  s_add_u32 s82, s80, 163840
  buffer_load_dwordx4 v2, s[60:63], s82 offen offset:0 lds
  v_rcp_f32 v194, v194
  ds_read_b128 v[24:27], v13 offset:34816
  s_waitcnt lgkmcnt(7)
  v_mfma_f32_32x32x16_bf16 v[96:111], v[40:43], a[104:107], v[96:111]
  v_rcp_f32 v195, v195
  v_rcp_f32 v196, v196
  ds_read_b128 v[28:31], v13 offset:35840
  v_mfma_f32_32x32x16_bf16 v[96:111], v[44:47], a[108:111], v[96:111]
  buffer_load_dwordx4 v2, s[60:63], s82 offen offset:1024 lds
  v_rcp_f32 v197, v197
  v_rcp_f32 v198, v198
  ds_read_b128 v[32:35], v13 offset:36864
  s_waitcnt lgkmcnt(7)
  v_mfma_f32_32x32x16_bf16 v[96:111], v[48:51], a[112:115], v[96:111]
  v_rcp_f32 v199, v199
  v_mul_f32 v200, v200, v192
  v_mul_f32 v201, v201, v193
  ds_read_b128 v[36:39], v13 offset:37888
  v_mfma_f32_32x32x16_bf16 v[96:111], v[52:55], a[116:119], v[96:111]
  buffer_load_dwordx4 v2, s[60:63], s82 offen offset:2048 lds
  v_mul_f32 v202, v202, v194
  v_mul_f32 v203, v203, v195
  v_mul_f32 v204, v204, v196
  v_mul_f32 v205, v205, v197
  ds_read_b128 v[40:43], v13 offset:38912
  s_waitcnt lgkmcnt(7)
  v_mfma_f32_32x32x16_bf16 v[96:111], v[56:59], a[120:123], v[96:111]
  v_mul_f32 v206, v206, v198
  v_mul_f32 v207, v207, v199
  v_cvt_pk_bf16_f32 v208, v200, v201
  v_cvt_pk_bf16_f32 v209, v202, v203
  ds_read_b128 v[44:47], v13 offset:39936
  v_mfma_f32_32x32x16_bf16 v[96:111], v[60:63], a[124:127], v[96:111]
  buffer_load_dwordx4 v2, s[60:63], s82 offen offset:3072 lds
  v_cvt_pk_bf16_f32 v210, v204, v205
  v_cvt_pk_bf16_f32 v211, v206, v207
  s_add_u32 s15, s14, 0
  buffer_store_dwordx4 v[208:211], v2, s[52:55], s15 offen sc1
  ds_read_b128 v[48:51], v13 offset:40960
  s_waitcnt lgkmcnt(7)
  v_mfma_f32_32x32x16_bf16 v[112:127], v[16:19], a[0:3], 0
  v_fmac_f32 v80, v8, v176
  v_fmac_f32 v81, v8, v177
  v_fmac_f32 v82, v8, v178
  v_fmac_f32 v83, v8, v179
  ds_read_b128 v[52:55], v13 offset:41984
  v_mfma_f32_32x32x16_bf16 v[112:127], v[20:23], a[4:7], v[112:127]
  s_add_u32 m0, s81, 36864
  s_add_u32 s82, s80, 167936
  buffer_load_dwordx4 v2, s[60:63], s82 offen offset:0 lds
  v_fmac_f32 v84, v8, v180
  v_fmac_f32 v85, v8, v181
  ds_read_b128 v[56:59], v13 offset:43008
  s_waitcnt lgkmcnt(7)
  v_mfma_f32_32x32x16_bf16 v[112:127], v[24:27], a[8:11], v[112:127]
  v_fmac_f32 v86, v8, v182
  v_fmac_f32 v87, v8, v183
  v_fmac_f32 v88, v8, v184
  v_fmac_f32 v89, v8, v185
  ds_read_b128 v[60:63], v13 offset:44032
  v_mfma_f32_32x32x16_bf16 v[112:127], v[28:31], a[12:15], v[112:127]
  buffer_load_dwordx4 v2, s[60:63], s82 offen offset:1024 lds
  v_fmac_f32 v90, v8, v186
  v_fmac_f32 v91, v8, v187
  v_fmac_f32 v92, v8, v188
  v_fmac_f32 v93, v8, v189
  ds_read_b128 v[16:19], v13 offset:45056
  s_waitcnt lgkmcnt(7)
  v_mfma_f32_32x32x16_bf16 v[112:127], v[32:35], a[16:19], v[112:127]
  v_fmac_f32 v94, v8, v190
  v_fmac_f32 v95, v8, v191
  ds_read_b128 v[176:179], v11 offset:256
  ds_read_b128 v[180:183], v11 offset:288
  ds_read_b128 v[20:23], v13 offset:46080
  v_mfma_f32_32x32x16_bf16 v[112:127], v[36:39], a[20:23], v[112:127]
  buffer_load_dwordx4 v2, s[60:63], s82 offen offset:2048 lds
  ds_read_b128 v[184:187], v11 offset:320
  ds_read_b128 v[188:191], v11 offset:352
  v_mul_f32 v192, v9, v80
  v_mul_f32 v193, v9, v81
  ds_read_b128 v[24:27], v13 offset:47104
  s_waitcnt lgkmcnt(7)
  v_mfma_f32_32x32x16_bf16 v[112:127], v[40:43], a[24:27], v[112:127]
  v_mul_f32 v194, v9, v82
  v_mul_f32 v195, v9, v83
  v_mul_f32 v196, v9, v84
  v_mul_f32 v197, v9, v85
  ds_read_b128 v[28:31], v13 offset:48128
  v_mfma_f32_32x32x16_bf16 v[112:127], v[44:47], a[28:31], v[112:127]
  buffer_load_dwordx4 v2, s[60:63], s82 offen offset:3072 lds
  v_mul_f32 v198, v9, v86
  v_mul_f32 v199, v9, v87
  v_exp_f32 v192, v192
  ds_read_b128 v[32:35], v13 offset:49152
  s_waitcnt lgkmcnt(7)
  v_mfma_f32_32x32x16_bf16 v[112:127], v[48:51], a[32:35], v[112:127]
  v_mul_f32 v200, v80, v88
  v_exp_f32 v193, v193
  v_mul_f32 v201, v81, v89
  ds_read_b128 v[36:39], v13 offset:50176
  v_mfma_f32_32x32x16_bf16 v[112:127], v[52:55], a[36:39], v[112:127]
  v_exp_f32 v194, v194
  v_mul_f32 v202, v82, v90
  v_exp_f32 v195, v195
  ds_read_b128 v[40:43], v13 offset:51200
  s_waitcnt lgkmcnt(7)
  v_mfma_f32_32x32x16_bf16 v[112:127], v[56:59], a[40:43], v[112:127]
  v_mul_f32 v203, v83, v91
  v_exp_f32 v196, v196
  v_mul_f32 v204, v84, v92
  ds_read_b128 v[44:47], v13 offset:52224
  v_mfma_f32_32x32x16_bf16 v[112:127], v[60:63], a[44:47], v[112:127]
  v_exp_f32 v197, v197
  v_mul_f32 v205, v85, v93
  v_exp_f32 v198, v198
  ds_read_b128 v[48:51], v13 offset:53248
  s_waitcnt lgkmcnt(7)
  v_mfma_f32_32x32x16_bf16 v[112:127], v[16:19], a[48:51], v[112:127]
  v_mul_f32 v206, v86, v94
  v_exp_f32 v199, v199
  v_mul_f32 v207, v87, v95
  ds_read_b128 v[52:55], v13 offset:54272
  v_mfma_f32_32x32x16_bf16 v[112:127], v[20:23], a[52:55], v[112:127]
  v_fma_f32 v192, v192, v10, v10
  v_fma_f32 v193, v193, v10, v10
  v_fma_f32 v194, v194, v10, v10
  v_fma_f32 v195, v195, v10, v10
  v_fma_f32 v196, v196, v10, v10
  ds_read_b128 v[56:59], v13 offset:55296
  s_waitcnt lgkmcnt(7)
  v_mfma_f32_32x32x16_bf16 v[112:127], v[24:27], a[56:59], v[112:127]
  v_fma_f32 v197, v197, v10, v10
  v_fma_f32 v198, v198, v10, v10
  v_fma_f32 v199, v199, v10, v10
  ds_read_b128 v[60:63], v13 offset:56320
  v_mfma_f32_32x32x16_bf16 v[112:127], v[28:31], a[60:63], v[112:127]
  v_rcp_f32 v192, v192
  v_rcp_f32 v193, v193
  ds_read_b128 v[16:19], v13 offset:57344
  s_waitcnt lgkmcnt(7)
  v_mfma_f32_32x32x16_bf16 v[112:127], v[32:35], a[64:67], v[112:127]
  v_rcp_f32 v194, v194
  v_rcp_f32 v195, v195
  ds_read_b128 v[20:23], v13 offset:58368
  v_mfma_f32_32x32x16_bf16 v[112:127], v[36:39], a[68:71], v[112:127]
  v_rcp_f32 v196, v196
  v_rcp_f32 v197, v197
  ds_read_b128 v[24:27], v13 offset:59392
  s_waitcnt lgkmcnt(7)
  v_mfma_f32_32x32x16_bf16 v[112:127], v[40:43], a[72:75], v[112:127]
  v_rcp_f32 v198, v198
  v_rcp_f32 v199, v199
  ds_read_b128 v[28:31], v13 offset:60416
  v_mfma_f32_32x32x16_bf16 v[112:127], v[44:47], a[76:79], v[112:127]
  v_mul_f32 v200, v200, v192
  v_mul_f32 v201, v201, v193
  v_mul_f32 v202, v202, v194
  v_mul_f32 v203, v203, v195
  v_mul_f32 v204, v204, v196
  ds_read_b128 v[32:35], v13 offset:61440
  s_waitcnt lgkmcnt(7)
  v_mfma_f32_32x32x16_bf16 v[112:127], v[48:51], a[80:83], v[112:127]
  v_mul_f32 v205, v205, v197
  v_mul_f32 v206, v206, v198
  v_mul_f32 v207, v207, v199
  v_cvt_pk_bf16_f32 v208, v200, v201
  ds_read_b128 v[36:39], v13 offset:62464
  v_mfma_f32_32x32x16_bf16 v[112:127], v[52:55], a[84:87], v[112:127]
  v_cvt_pk_bf16_f32 v209, v202, v203
  v_cvt_pk_bf16_f32 v210, v204, v205
  v_cvt_pk_bf16_f32 v211, v206, v207
  s_add_u32 s15, s14, 1024
  buffer_store_dwordx4 v[208:211], v2, s[52:55], s15 offen sc1
  ds_read_b128 v[40:43], v13 offset:63488
  s_waitcnt lgkmcnt(7)
  v_mfma_f32_32x32x16_bf16 v[112:127], v[56:59], a[88:91], v[112:127]
  v_fmac_f32 v96, v8, v176
  v_fmac_f32 v97, v8, v177
  v_fmac_f32 v98, v8, v178
  v_fmac_f32 v99, v8, v179
  ds_read_b128 v[44:47], v13 offset:64512
  v_mfma_f32_32x32x16_bf16 v[112:127], v[60:63], a[92:95], v[112:127]
  v_fmac_f32 v100, v8, v180
  v_fmac_f32 v101, v8, v181
  v_fmac_f32 v102, v8, v182
  v_fmac_f32 v103, v8, v183
  v_fmac_f32 v104, v8, v184
  s_waitcnt vmcnt(10)
  s_barrier
  ds_read_b128 v[48:51], v12 offset:0
  s_waitcnt lgkmcnt(7)
  v_mfma_f32_32x32x16_bf16 v[112:127], v[16:19], a[96:99], v[112:127]
  v_fmac_f32 v105, v8, v185
  v_fmac_f32 v106, v8, v186
  ds_read_b128 v[52:55], v12 offset:1024
  v_mfma_f32_32x32x16_bf16 v[112:127], v[20:23], a[100:103], v[112:127]
  s_add_u32 m0, s81, 65536
  s_add_u32 s82, s80, 196608
  buffer_load_dwordx4 v2, s[60:63], s82 offen offset:0 lds
  v_fmac_f32 v107, v8, v187
  v_fmac_f32 v108, v8, v188
  ds_read_b128 v[56:59], v12 offset:2048
  s_waitcnt lgkmcnt(7)
  v_mfma_f32_32x32x16_bf16 v[112:127], v[24:27], a[104:107], v[112:127]
  v_fmac_f32 v109, v8, v189
  v_fmac_f32 v110, v8, v190
  v_fmac_f32 v111, v8, v191
  ds_read_b128 v[176:179], v11 offset:384
  ds_read_b128 v[60:63], v12 offset:3072
  v_mfma_f32_32x32x16_bf16 v[112:127], v[28:31], a[108:111], v[112:127]
  buffer_load_dwordx4 v2, s[60:63], s82 offen offset:1024 lds
  ds_read_b128 v[180:183], v11 offset:416
  ds_read_b128 v[184:187], v11 offset:448
  ds_read_b128 v[188:191], v11 offset:480
  v_mul_f32 v192, v9, v96
  ds_read_b128 v[16:19], v12 offset:4096
  s_waitcnt lgkmcnt(7)
  v_mfma_f32_32x32x16_bf16 v[112:127], v[32:35], a[112:115], v[112:127]
  v_mul_f32 v193, v9, v97
  v_mul_f32 v194, v9, v98
  v_mul_f32 v195, v9, v99
  v_mul_f32 v196, v9, v100
  ds_read_b128 v[20:23], v12 offset:5120
  v_mfma_f32_32x32x16_bf16 v[112:127], v[36:39], a[116:119], v[112:127]
  buffer_load_dwordx4 v2, s[60:63], s82 offen offset:2048 lds
  v_mul_f32 v197, v9, v101
  v_mul_f32 v198, v9, v102
  v_mul_f32 v199, v9, v103
  ds_read_b128 v[24:27], v12 offset:6144
  s_waitcnt lgkmcnt(7)
  v_mfma_f32_32x32x16_bf16 v[112:127], v[40:43], a[120:123], v[112:127]
  v_exp_f32 v192, v192
  v_mul_f32 v200, v96, v104
  ds_read_b128 v[28:31], v12 offset:7168
  v_mfma_f32_32x32x16_bf16 v[112:127], v[44:47], a[124:127], v[112:127]
  buffer_load_dwordx4 v2, s[60:63], s82 offen offset:3072 lds
  v_exp_f32 v193, v193
  v_mul_f32 v201, v97, v105
  ds_read_b128 v[32:35], v12 offset:8192
  s_waitcnt lgkmcnt(7)
  v_mfma_f32_32x32x16_bf16 v[128:143], v[48:51], a[0:3], 0
  v_exp_f32 v194, v194
  v_mul_f32 v202, v98, v106
  ds_read_b128 v[36:39], v12 offset:9216
  v_mfma_f32_32x32x16_bf16 v[128:143], v[52:55], a[4:7], v[128:143]
  s_add_u32 m0, s81, 69632
  s_add_u32 s82, s80, 200704
  buffer_load_dwordx4 v2, s[60:63], s82 offen offset:0 lds
  v_exp_f32 v195, v195
  ds_read_b128 v[40:43], v12 offset:10240
  s_waitcnt lgkmcnt(7)
  v_mfma_f32_32x32x16_bf16 v[128:143], v[56:59], a[8:11], v[128:143]
  v_mul_f32 v203, v99, v107
  v_exp_f32 v196, v196
  v_mul_f32 v204, v100, v108
  ds_read_b128 v[44:47], v12 offset:11264
  v_mfma_f32_32x32x16_bf16 v[128:143], v[60:63], a[12:15], v[128:143]
  buffer_load_dwordx4 v2, s[60:63], s82 offen offset:1024 lds
  v_exp_f32 v197, v197
  v_mul_f32 v205, v101, v109
  ds_read_b128 v[48:51], v12 offset:12288
  s_waitcnt lgkmcnt(7)
  v_mfma_f32_32x32x16_bf16 v[128:143], v[16:19], a[16:19], v[128:143]
  v_exp_f32 v198, v198
  v_mul_f32 v206, v102, v110
  ds_read_b128 v[52:55], v12 offset:13312
  v_mfma_f32_32x32x16_bf16 v[128:143], v[20:23], a[20:23], v[128:143]
  buffer_load_dwordx4 v2, s[60:63], s82 offen offset:2048 lds
  v_exp_f32 v199, v199
  v_mul_f32 v207, v103, v111
  v_fma_f32 v192, v192, v10, v10
  ds_read_b128 v[56:59], v12 offset:14336
  s_waitcnt lgkmcnt(7)
  v_mfma_f32_32x32x16_bf16 v[128:143], v[24:27], a[24:27], v[128:143]
  v_fma_f32 v193, v193, v10, v10
  v_fma_f32 v194, v194, v10, v10
  v_fma_f32 v195, v195, v10, v10
  v_fma_f32 v196, v196, v10, v10
  ds_read_b128 v[60:63], v12 offset:15360
  v_mfma_f32_32x32x16_bf16 v[128:143], v[28:31], a[28:31], v[128:143]
  buffer_load_dwordx4 v2, s[60:63], s82 offen offset:3072 lds
  v_fma_f32 v197, v197, v10, v10
  v_fma_f32 v198, v198, v10, v10
  v_fma_f32 v199, v199, v10, v10
  ds_read_b128 v[16:19], v12 offset:16384
  s_waitcnt lgkmcnt(7)
  v_mfma_f32_32x32x16_bf16 v[128:143], v[32:35], a[32:35], v[128:143]
  v_rcp_f32 v192, v192
  v_rcp_f32 v193, v193
  ds_read_b128 v[20:23], v12 offset:17408
  v_mfma_f32_32x32x16_bf16 v[128:143], v[36:39], a[36:39], v[128:143]
  v_rcp_f32 v194, v194
  v_rcp_f32 v195, v195
  ds_read_b128 v[24:27], v12 offset:18432
  s_waitcnt lgkmcnt(7)
  v_mfma_f32_32x32x16_bf16 v[128:143], v[40:43], a[40:43], v[128:143]
  v_rcp_f32 v196, v196
  v_rcp_f32 v197, v197
  ds_read_b128 v[28:31], v12 offset:19456
  v_mfma_f32_32x32x16_bf16 v[128:143], v[44:47], a[44:47], v[128:143]
  buffer_load_dwordx4 a[128:131], v2, s[56:59], s84 offen offset:0
  v_rcp_f32 v198, v198
  v_rcp_f32 v199, v199
  ds_read_b128 v[32:35], v12 offset:20480
  s_waitcnt lgkmcnt(7)
  v_mfma_f32_32x32x16_bf16 v[128:143], v[48:51], a[48:51], v[128:143]
  v_mul_f32 v200, v200, v192
  v_mul_f32 v201, v201, v193
  v_mul_f32 v202, v202, v194
  v_mul_f32 v203, v203, v195
  ds_read_b128 v[36:39], v12 offset:21504
  v_mfma_f32_32x32x16_bf16 v[128:143], v[52:55], a[52:55], v[128:143]
  buffer_load_dwordx4 a[132:135], v2, s[56:59], s85 offen offset:0
  v_mul_f32 v204, v204, v196
  v_mul_f32 v205, v205, v197
  v_mul_f32 v206, v206, v198
  v_mul_f32 v207, v207, v199
  ds_read_b128 v[40:43], v12 offset:22528
  s_waitcnt lgkmcnt(7)
  v_mfma_f32_32x32x16_bf16 v[128:143], v[56:59], a[56:59], v[128:143]
  v_cvt_pk_bf16_f32 v208, v200, v201
  v_cvt_pk_bf16_f32 v209, v202, v203
  v_cvt_pk_bf16_f32 v210, v204, v205
  v_cvt_pk_bf16_f32 v211, v206, v207
  ds_read_b128 v[44:47], v12 offset:23552
  v_mfma_f32_32x32x16_bf16 v[128:143], v[60:63], a[60:63], v[128:143]
  buffer_load_dwordx4 a[136:139], v2, s[56:59], s84 offen offset:1024
  s_add_u32 s15, s14, 2048
  buffer_store_dwordx4 v[208:211], v2, s[52:55], s15 offen sc1
  v_fmac_f32 v112, v8, v176
  v_fmac_f32 v113, v8, v177
  ds_read_b128 v[48:51], v12 offset:24576
  s_waitcnt lgkmcnt(7)
  v_mfma_f32_32x32x16_bf16 v[128:143], v[16:19], a[64:67], v[128:143]
  v_fmac_f32 v114, v8, v178
  v_fmac_f32 v115, v8, v179
  v_fmac_f32 v116, v8, v180
  v_fmac_f32 v117, v8, v181
  ds_read_b128 v[52:55], v12 offset:25600
  v_mfma_f32_32x32x16_bf16 v[128:143], v[20:23], a[68:71], v[128:143]
  buffer_load_dwordx4 a[140:143], v2, s[56:59], s85 offen offset:1024
  v_fmac_f32 v118, v8, v182
  v_fmac_f32 v119, v8, v183
  v_fmac_f32 v120, v8, v184
  v_fmac_f32 v121, v8, v185
  ds_read_b128 v[56:59], v12 offset:26624
  s_waitcnt lgkmcnt(7)
  v_mfma_f32_32x32x16_bf16 v[128:143], v[24:27], a[72:75], v[128:143]
  v_fmac_f32 v122, v8, v186
  v_fmac_f32 v123, v8, v187
  v_fmac_f32 v124, v8, v188
  v_fmac_f32 v125, v8, v189
  ds_read_b128 v[60:63], v12 offset:27648
  v_mfma_f32_32x32x16_bf16 v[128:143], v[28:31], a[76:79], v[128:143]
  buffer_load_dwordx4 a[144:147], v2, s[56:59], s84 offen offset:2048
  v_fmac_f32 v126, v8, v190
  v_fmac_f32 v127, v8, v191
  ds_read_b128 v[176:179], v11 offset:512
  ds_read_b128 v[180:183], v11 offset:544
  ds_read_b128 v[16:19], v12 offset:28672
  s_waitcnt lgkmcnt(7)
  v_mfma_f32_32x32x16_bf16 v[128:143], v[32:35], a[80:83], v[128:143]
  ds_read_b128 v[184:187], v11 offset:576
  ds_read_b128 v[188:191], v11 offset:608
  v_mul_f32 v192, v9, v112
  v_mul_f32 v193, v9, v113
  ds_read_b128 v[20:23], v12 offset:29696
  v_mfma_f32_32x32x16_bf16 v[128:143], v[36:39], a[84:87], v[128:143]
  buffer_load_dwordx4 a[148:151], v2, s[56:59], s85 offen offset:2048
  v_mul_f32 v194, v9, v114
  v_mul_f32 v195, v9, v115
  v_mul_f32 v196, v9, v116
  v_mul_f32 v197, v9, v117
  ds_read_b128 v[24:27], v12 offset:30720
  s_waitcnt lgkmcnt(7)
  v_mfma_f32_32x32x16_bf16 v[128:143], v[40:43], a[88:91], v[128:143]
  v_mul_f32 v198, v9, v118
  v_mul_f32 v199, v9, v119
  v_exp_f32 v192, v192
  ds_read_b128 v[28:31], v12 offset:31744
  v_mfma_f32_32x32x16_bf16 v[128:143], v[44:47], a[92:95], v[128:143]
  buffer_load_dwordx4 a[152:155], v2, s[56:59], s84 offen offset:3072
  v_mul_f32 v200, v112, v120
  v_exp_f32 v193, v193
  v_mul_f32 v201, v113, v121
  s_waitcnt vmcnt(17)
  s_barrier
  ds_read_b128 v[32:35], v12 offset:32768
  s_waitcnt lgkmcnt(7)
  v_mfma_f32_32x32x16_bf16 v[128:143], v[48:51], a[96:99], v[128:143]
  v_exp_f32 v194, v194
  ds_read_b128 v[36:39], v12 offset:33792
  v_mfma_f32_32x32x16_bf16 v[128:143], v[52:55], a[100:103], v[128:143]
  buffer_load_dwordx4 a[156:159], v2, s[56:59], s85 offen offset:3072
  v_mul_f32 v202, v114, v122
  v_exp_f32 v195, v195
  v_mul_f32 v203, v115, v123
  ds_read_b128 v[40:43], v12 offset:34816
  s_waitcnt lgkmcnt(7)
  v_mfma_f32_32x32x16_bf16 v[128:143], v[56:59], a[104:107], v[128:143]
  v_exp_f32 v196, v196
  v_mul_f32 v204, v116, v124
  ds_read_b128 v[44:47], v12 offset:35840
  v_mfma_f32_32x32x16_bf16 v[128:143], v[60:63], a[108:111], v[128:143]
  s_add_u32 s84, s84, 4096
  s_add_u32 s85, s85, 4096
  buffer_load_dwordx4 a[160:163], v2, s[56:59], s84 offen offset:0
  v_exp_f32 v197, v197
  ds_read_b128 v[48:51], v12 offset:36864
  s_waitcnt lgkmcnt(7)
  v_mfma_f32_32x32x16_bf16 v[128:143], v[16:19], a[112:115], v[128:143]
  v_mul_f32 v205, v117, v125
  v_exp_f32 v198, v198
  v_mul_f32 v206, v118, v126
  ds_read_b128 v[52:55], v12 offset:37888
  v_mfma_f32_32x32x16_bf16 v[128:143], v[20:23], a[116:119], v[128:143]
  buffer_load_dwordx4 a[164:167], v2, s[56:59], s85 offen offset:0
  v_exp_f32 v199, v199
  v_mul_f32 v207, v119, v127
  v_fma_f32 v192, v192, v10, v10
  ds_read_b128 v[56:59], v12 offset:38912
  s_waitcnt lgkmcnt(7)
  v_mfma_f32_32x32x16_bf16 v[128:143], v[24:27], a[120:123], v[128:143]
  v_fma_f32 v193, v193, v10, v10
  v_fma_f32 v194, v194, v10, v10
  v_fma_f32 v195, v195, v10, v10
  v_fma_f32 v196, v196, v10, v10
  ds_read_b128 v[60:63], v12 offset:39936
  v_mfma_f32_32x32x16_bf16 v[128:143], v[28:31], a[124:127], v[128:143]
  buffer_load_dwordx4 a[168:171], v2, s[56:59], s84 offen offset:1024
  v_fma_f32 v197, v197, v10, v10
  v_fma_f32 v198, v198, v10, v10
  v_fma_f32 v199, v199, v10, v10
  ds_read_b128 v[16:19], v12 offset:40960
  s_waitcnt lgkmcnt(7)
  v_mfma_f32_32x32x16_bf16 v[144:159], v[32:35], a[0:3], 0
  v_rcp_f32 v192, v192
  v_rcp_f32 v193, v193
  ds_read_b128 v[20:23], v12 offset:41984
  v_mfma_f32_32x32x16_bf16 v[144:159], v[36:39], a[4:7], v[144:159]
  buffer_load_dwordx4 a[172:175], v2, s[56:59], s85 offen offset:1024
  v_rcp_f32 v194, v194
  v_rcp_f32 v195, v195
  ds_read_b128 v[24:27], v12 offset:43008
  s_waitcnt lgkmcnt(7)
  v_mfma_f32_32x32x16_bf16 v[144:159], v[40:43], a[8:11], v[144:159]
  v_rcp_f32 v196, v196
  v_rcp_f32 v197, v197
  ds_read_b128 v[28:31], v12 offset:44032
  v_mfma_f32_32x32x16_bf16 v[144:159], v[44:47], a[12:15], v[144:159]
  buffer_load_dwordx4 a[176:179], v2, s[56:59], s84 offen offset:2048
  v_rcp_f32 v198, v198
  v_rcp_f32 v199, v199
  ds_read_b128 v[32:35], v12 offset:45056
  s_waitcnt lgkmcnt(7)
  v_mfma_f32_32x32x16_bf16 v[144:159], v[48:51], a[16:19], v[144:159]
  v_mul_f32 v200, v200, v192
  v_mul_f32 v201, v201, v193
  v_mul_f32 v202, v202, v194
  v_mul_f32 v203, v203, v195
  ds_read_b128 v[36:39], v12 offset:46080
  v_mfma_f32_32x32x16_bf16 v[144:159], v[52:55], a[20:23], v[144:159]
  buffer_load_dwordx4 a[180:183], v2, s[56:59], s85 offen offset:2048
  v_mul_f32 v204, v204, v196
  v_mul_f32 v205, v205, v197
  v_mul_f32 v206, v206, v198
  v_mul_f32 v207, v207, v199
  ds_read_b128 v[40:43], v12 offset:47104
  s_waitcnt lgkmcnt(7)
  v_mfma_f32_32x32x16_bf16 v[144:159], v[56:59], a[24:27], v[144:159]
  v_cvt_pk_bf16_f32 v208, v200, v201
  v_cvt_pk_bf16_f32 v209, v202, v203
  v_cvt_pk_bf16_f32 v210, v204, v205
  v_cvt_pk_bf16_f32 v211, v206, v207
  ds_read_b128 v[44:47], v12 offset:48128
  v_mfma_f32_32x32x16_bf16 v[144:159], v[60:63], a[28:31], v[144:159]
  buffer_load_dwordx4 a[184:187], v2, s[56:59], s84 offen offset:3072
  s_add_u32 s15, s14, 3072
  buffer_store_dwordx4 v[208:211], v2, s[52:55], s15 offen sc1
  v_fmac_f32 v128, v8, v176
  v_fmac_f32 v129, v8, v177
  ds_read_b128 v[48:51], v12 offset:49152
  s_waitcnt lgkmcnt(7)
  v_mfma_f32_32x32x16_bf16 v[144:159], v[16:19], a[32:35], v[144:159]
  v_fmac_f32 v130, v8, v178
  v_fmac_f32 v131, v8, v179
  v_fmac_f32 v132, v8, v180
  v_fmac_f32 v133, v8, v181
  ds_read_b128 v[52:55], v12 offset:50176
  v_mfma_f32_32x32x16_bf16 v[144:159], v[20:23], a[36:39], v[144:159]
  buffer_load_dwordx4 a[188:191], v2, s[56:59], s85 offen offset:3072
  v_fmac_f32 v134, v8, v182
  v_fmac_f32 v135, v8, v183
  v_fmac_f32 v136, v8, v184
  v_fmac_f32 v137, v8, v185
  ds_read_b128 v[56:59], v12 offset:51200
  s_waitcnt lgkmcnt(7)
  v_mfma_f32_32x32x16_bf16 v[144:159], v[24:27], a[40:43], v[144:159]
  v_fmac_f32 v138, v8, v186
  v_fmac_f32 v139, v8, v187
  v_fmac_f32 v140, v8, v188
  v_fmac_f32 v141, v8, v189
  ds_read_b128 v[60:63], v12 offset:52224
  v_mfma_f32_32x32x16_bf16 v[144:159], v[28:31], a[44:47], v[144:159]
  s_add_u32 s84, s84, 4096
  s_add_u32 s85, s85, 4096
  buffer_load_dwordx4 a[192:195], v2, s[56:59], s84 offen offset:0
  v_fmac_f32 v142, v8, v190
  v_fmac_f32 v143, v8, v191
  ds_read_b128 v[16:19], v12 offset:53248
  s_waitcnt lgkmcnt(7)
  v_mfma_f32_32x32x16_bf16 v[144:159], v[32:35], a[48:51], v[144:159]
  ds_read_b128 v[176:179], v11 offset:640
  ds_read_b128 v[180:183], v11 offset:672
  ds_read_b128 v[184:187], v11 offset:704
  ds_read_b128 v[188:191], v11 offset:736
  ds_read_b128 v[20:23], v12 offset:54272
  v_mfma_f32_32x32x16_bf16 v[144:159], v[36:39], a[52:55], v[144:159]
  buffer_load_dwordx4 a[196:199], v2, s[56:59], s85 offen offset:0
  v_mul_f32 v192, v9, v128
  v_mul_f32 v193, v9, v129
  v_mul_f32 v194, v9, v130
  v_mul_f32 v195, v9, v131
  ds_read_b128 v[24:27], v12 offset:55296
  s_waitcnt lgkmcnt(7)
  v_mfma_f32_32x32x16_bf16 v[144:159], v[40:43], a[56:59], v[144:159]
  v_mul_f32 v196, v9, v132
  v_mul_f32 v197, v9, v133
  v_mul_f32 v198, v9, v134
  v_mul_f32 v199, v9, v135
  ds_read_b128 v[28:31], v12 offset:56320
  v_mfma_f32_32x32x16_bf16 v[144:159], v[44:47], a[60:63], v[144:159]
  buffer_load_dwordx4 a[200:203], v2, s[56:59], s84 offen offset:1024
  v_exp_f32 v192, v192
  v_mul_f32 v200, v128, v136
  ds_read_b128 v[32:35], v12 offset:57344
  s_waitcnt lgkmcnt(7)
  v_mfma_f32_32x32x16_bf16 v[144:159], v[48:51], a[64:67], v[144:159]
  v_exp_f32 v193, v193
  v_mul_f32 v201, v129, v137
  ds_read_b128 v[36:39], v12 offset:58368
  v_mfma_f32_32x32x16_bf16 v[144:159], v[52:55], a[68:71], v[144:159]
  buffer_load_dwordx4 a[204:207], v2, s[56:59], s85 offen offset:1024
  v_exp_f32 v194, v194
  v_mul_f32 v202, v130, v138
  ds_read_b128 v[40:43], v12 offset:59392
  s_waitcnt lgkmcnt(7)
  v_mfma_f32_32x32x16_bf16 v[144:159], v[56:59], a[72:75], v[144:159]
  v_exp_f32 v195, v195
  v_mul_f32 v203, v131, v139
  ds_read_b128 v[44:47], v12 offset:60416
  v_mfma_f32_32x32x16_bf16 v[144:159], v[60:63], a[76:79], v[144:159]
  buffer_load_dwordx4 a[208:211], v2, s[56:59], s84 offen offset:2048
  v_exp_f32 v196, v196
  v_mul_f32 v204, v132, v140
  ds_read_b128 v[48:51], v12 offset:61440
  s_waitcnt lgkmcnt(7)
  v_mfma_f32_32x32x16_bf16 v[144:159], v[16:19], a[80:83], v[144:159]
  v_exp_f32 v197, v197
  v_mul_f32 v205, v133, v141
  ds_read_b128 v[52:55], v12 offset:62464
  v_mfma_f32_32x32x16_bf16 v[144:159], v[20:23], a[84:87], v[144:159]
  buffer_load_dwordx4 a[212:215], v2, s[56:59], s85 offen offset:2048
  v_exp_f32 v198, v198
  v_mul_f32 v206, v134, v142
  ds_read_b128 v[56:59], v12 offset:63488
  s_waitcnt lgkmcnt(7)
  v_mfma_f32_32x32x16_bf16 v[144:159], v[24:27], a[88:91], v[144:159]
  v_exp_f32 v199, v199
  v_mul_f32 v207, v135, v143
  v_fma_f32 v192, v192, v10, v10
  ds_read_b128 v[60:63], v12 offset:64512
  v_mfma_f32_32x32x16_bf16 v[144:159], v[28:31], a[92:95], v[144:159]
  buffer_load_dwordx4 a[216:219], v2, s[56:59], s84 offen offset:3072
  v_fma_f32 v193, v193, v10, v10
  v_fma_f32 v194, v194, v10, v10
  v_fma_f32 v195, v195, v10, v10
  v_fma_f32 v196, v196, v10, v10
  s_waitcnt vmcnt(25)
  s_barrier
  ds_read_b128 v[16:19], v13 offset:0
  s_waitcnt lgkmcnt(7)
  v_mfma_f32_32x32x16_bf16 v[144:159], v[32:35], a[96:99], v[144:159]
  v_fma_f32 v197, v197, v10, v10
  v_fma_f32 v198, v198, v10, v10
  ds_read_b128 v[20:23], v13 offset:1024
  v_mfma_f32_32x32x16_bf16 v[144:159], v[36:39], a[100:103], v[144:159]
  buffer_load_dwordx4 a[220:223], v2, s[56:59], s85 offen offset:3072
  v_fma_f32 v199, v199, v10, v10
  v_rcp_f32 v192, v192
  ds_read_b128 v[24:27], v13 offset:2048
  s_waitcnt lgkmcnt(7)
  v_mfma_f32_32x32x16_bf16 v[144:159], v[40:43], a[104:107], v[144:159]
  v_rcp_f32 v193, v193
  v_rcp_f32 v194, v194
  ds_read_b128 v[28:31], v13 offset:3072
  v_mfma_f32_32x32x16_bf16 v[144:159], v[44:47], a[108:111], v[144:159]
  s_add_u32 s84, s84, 4096
  s_add_u32 s85, s85, 4096
  buffer_load_dwordx4 a[224:227], v2, s[56:59], s84 offen offset:0
  v_rcp_f32 v195, v195
  ds_read_b128 v[32:35], v13 offset:4096
  s_waitcnt lgkmcnt(7)
  v_mfma_f32_32x32x16_bf16 v[144:159], v[48:51], a[112:115], v[144:159]
  v_rcp_f32 v196, v196
  v_rcp_f32 v197, v197
  ds_read_b128 v[36:39], v13 offset:5120
  v_mfma_f32_32x32x16_bf16 v[144:159], v[52:55], a[116:119], v[144:159]
  buffer_load_dwordx4 a[228:231], v2, s[56:59], s85 offen offset:0
  v_rcp_f32 v198, v198
  v_rcp_f32 v199, v199
  ds_read_b128 v[40:43], v13 offset:6144
  s_waitcnt lgkmcnt(7)
  v_mfma_f32_32x32x16_bf16 v[144:159], v[56:59], a[120:123], v[144:159]
  v_mul_f32 v200, v200, v192
  v_mul_f32 v201, v201, v193
  v_mul_f32 v202, v202, v194
  v_mul_f32 v203, v203, v195
  ds_read_b128 v[44:47], v13 offset:7168
  v_mfma_f32_32x32x16_bf16 v[144:159], v[60:63], a[124:127], v[144:159]
  buffer_load_dwordx4 a[232:235], v2, s[56:59], s84 offen offset:1024
  v_mul_f32 v204, v204, v196
  v_mul_f32 v205, v205, v197
  v_mul_f32 v206, v206, v198
  v_mul_f32 v207, v207, v199
  ds_read_b128 v[48:51], v13 offset:8192
  s_waitcnt lgkmcnt(7)
  v_mfma_f32_32x32x16_bf16 v[160:175], v[16:19], a[0:3], 0
  v_cvt_pk_bf16_f32 v208, v200, v201
  v_cvt_pk_bf16_f32 v209, v202, v203
  v_cvt_pk_bf16_f32 v210, v204, v205
  v_cvt_pk_bf16_f32 v211, v206, v207
  ds_read_b128 v[52:55], v13 offset:9216
  v_mfma_f32_32x32x16_bf16 v[160:175], v[20:23], a[4:7], v[160:175]
  buffer_load_dwordx4 a[236:239], v2, s[56:59], s85 offen offset:1024
  s_add_u32 s15, s14, 4096
  buffer_store_dwordx4 v[208:211], v2, s[52:55], s15 offen sc1
  ds_read_b128 v[56:59], v13 offset:10240
  s_waitcnt lgkmcnt(7)
  v_mfma_f32_32x32x16_bf16 v[160:175], v[24:27], a[8:11], v[160:175]
  ds_read_b128 v[60:63], v13 offset:11264
  v_mfma_f32_32x32x16_bf16 v[160:175], v[28:31], a[12:15], v[160:175]
  buffer_load_dwordx4 a[240:243], v2, s[56:59], s84 offen offset:2048
  ds_read_b128 v[16:19], v13 offset:12288
  s_waitcnt lgkmcnt(7)
  v_mfma_f32_32x32x16_bf16 v[160:175], v[32:35], a[16:19], v[160:175]
  v_fmac_f32 v144, v8, v176
  v_fmac_f32 v145, v8, v177
  v_fmac_f32 v146, v8, v178
  v_fmac_f32 v147, v8, v179
  ds_read_b128 v[20:23], v13 offset:13312
  v_mfma_f32_32x32x16_bf16 v[160:175], v[36:39], a[20:23], v[160:175]
  buffer_load_dwordx4 a[244:247], v2, s[56:59], s85 offen offset:2048
  v_fmac_f32 v148, v8, v180
  v_fmac_f32 v149, v8, v181
  v_fmac_f32 v150, v8, v182
  v_fmac_f32 v151, v8, v183
  ds_read_b128 v[24:27], v13 offset:14336
  s_waitcnt lgkmcnt(7)
  v_mfma_f32_32x32x16_bf16 v[160:175], v[40:43], a[24:27], v[160:175]
  v_fmac_f32 v152, v8, v184
  v_fmac_f32 v153, v8, v185
  v_fmac_f32 v154, v8, v186
  v_fmac_f32 v155, v8, v187
  ds_read_b128 v[28:31], v13 offset:15360
  v_mfma_f32_32x32x16_bf16 v[160:175], v[44:47], a[28:31], v[160:175]
  buffer_load_dwordx4 a[248:251], v2, s[56:59], s84 offen offset:3072
  v_fmac_f32 v156, v8, v188
  v_fmac_f32 v157, v8, v189
  v_fmac_f32 v158, v8, v190
  v_fmac_f32 v159, v8, v191
  ds_read_b128 v[32:35], v13 offset:16384
  s_waitcnt lgkmcnt(7)
  v_mfma_f32_32x32x16_bf16 v[160:175], v[48:51], a[32:35], v[160:175]
  ds_read_b128 v[176:179], v11 offset:768
  ds_read_b128 v[180:183], v11 offset:800
  ds_read_b128 v[184:187], v11 offset:832
  ds_read_b128 v[188:191], v11 offset:864
  ds_read_b128 v[36:39], v13 offset:17408
  v_mfma_f32_32x32x16_bf16 v[160:175], v[52:55], a[36:39], v[160:175]
  buffer_load_dwordx4 a[252:255], v2, s[56:59], s85 offen offset:3072
  v_mul_f32 v192, v9, v144
  v_mul_f32 v193, v9, v145
  v_mul_f32 v194, v9, v146
  v_mul_f32 v195, v9, v147
  ds_read_b128 v[40:43], v13 offset:18432
  s_waitcnt lgkmcnt(7)
  v_mfma_f32_32x32x16_bf16 v[160:175], v[56:59], a[40:43], v[160:175]
  v_mul_f32 v196, v9, v148
  v_mul_f32 v197, v9, v149
  v_mul_f32 v198, v9, v150
  v_mul_f32 v199, v9, v151
  ds_read_b128 v[44:47], v13 offset:19456
  v_mfma_f32_32x32x16_bf16 v[160:175], v[60:63], a[44:47], v[160:175]
  v_exp_f32 v192, v192
  v_mul_f32 v200, v144, v152
  v_exp_f32 v193, v193
  ds_read_b128 v[48:51], v13 offset:20480
  s_waitcnt lgkmcnt(7)
  v_mfma_f32_32x32x16_bf16 v[160:175], v[16:19], a[48:51], v[160:175]
  v_mul_f32 v201, v145, v153
  v_exp_f32 v194, v194
  v_mul_f32 v202, v146, v154
  ds_read_b128 v[52:55], v13 offset:21504
  v_mfma_f32_32x32x16_bf16 v[160:175], v[20:23], a[52:55], v[160:175]
  v_exp_f32 v195, v195
  v_mul_f32 v203, v147, v155
  v_exp_f32 v196, v196
  ds_read_b128 v[56:59], v13 offset:22528
  s_waitcnt lgkmcnt(7)
  v_mfma_f32_32x32x16_bf16 v[160:175], v[24:27], a[56:59], v[160:175]
  v_mul_f32 v204, v148, v156
  v_exp_f32 v197, v197
  v_mul_f32 v205, v149, v157
  ds_read_b128 v[60:63], v13 offset:23552
  v_mfma_f32_32x32x16_bf16 v[160:175], v[28:31], a[60:63], v[160:175]
  v_exp_f32 v198, v198
  v_mul_f32 v206, v150, v158
  v_exp_f32 v199, v199
  ds_read_b128 v[16:19], v13 offset:24576
  s_waitcnt lgkmcnt(7)
  v_mfma_f32_32x32x16_bf16 v[160:175], v[32:35], a[64:67], v[160:175]
  v_mul_f32 v207, v151, v159
  v_fma_f32 v192, v192, v10, v10
  v_fma_f32 v193, v193, v10, v10
  v_fma_f32 v194, v194, v10, v10
  ds_read_b128 v[20:23], v13 offset:25600
  v_mfma_f32_32x32x16_bf16 v[160:175], v[36:39], a[68:71], v[160:175]
  v_fma_f32 v195, v195, v10, v10
  v_fma_f32 v196, v196, v10, v10
  v_fma_f32 v197, v197, v10, v10
  v_fma_f32 v198, v198, v10, v10
  v_fma_f32 v199, v199, v10, v10
  ds_read_b128 v[24:27], v13 offset:26624
  s_waitcnt lgkmcnt(7)
  v_mfma_f32_32x32x16_bf16 v[160:175], v[40:43], a[72:75], v[160:175]
  v_rcp_f32 v192, v192
  v_rcp_f32 v193, v193
  ds_read_b128 v[28:31], v13 offset:27648
  v_mfma_f32_32x32x16_bf16 v[160:175], v[44:47], a[76:79], v[160:175]
  v_rcp_f32 v194, v194
  v_rcp_f32 v195, v195
  ds_read_b128 v[32:35], v13 offset:28672
  s_waitcnt lgkmcnt(7)
  v_mfma_f32_32x32x16_bf16 v[160:175], v[48:51], a[80:83], v[160:175]
  v_rcp_f32 v196, v196
  v_rcp_f32 v197, v197
  ds_read_b128 v[36:39], v13 offset:29696
  v_mfma_f32_32x32x16_bf16 v[160:175], v[52:55], a[84:87], v[160:175]
  v_rcp_f32 v198, v198
  v_rcp_f32 v199, v199
  v_mul_f32 v200, v200, v192
  ds_read_b128 v[40:43], v13 offset:30720
  s_waitcnt lgkmcnt(7)
  v_mfma_f32_32x32x16_bf16 v[160:175], v[56:59], a[88:91], v[160:175]
  v_mul_f32 v201, v201, v193
  v_mul_f32 v202, v202, v194
  v_mul_f32 v203, v203, v195
  v_mul_f32 v204, v204, v196
  ds_read_b128 v[44:47], v13 offset:31744
  v_mfma_f32_32x32x16_bf16 v[160:175], v[60:63], a[92:95], v[160:175]
  v_mul_f32 v205, v205, v197
  v_mul_f32 v206, v206, v198
  v_mul_f32 v207, v207, v199
  v_cvt_pk_bf16_f32 v208, v200, v201
  v_cvt_pk_bf16_f32 v209, v202, v203
  s_waitcnt lgkmcnt(6)
  v_mfma_f32_32x32x16_bf16 v[160:175], v[16:19], a[96:99], v[160:175]
  v_cvt_pk_bf16_f32 v210, v204, v205
  v_cvt_pk_bf16_f32 v211, v206, v207
  s_add_u32 s15, s14, 5120
  buffer_store_dwordx4 v[208:211], v2, s[52:55], s15 offen sc1
  v_mfma_f32_32x32x16_bf16 v[160:175], v[20:23], a[100:103], v[160:175]
  s_waitcnt lgkmcnt(4)
  v_mfma_f32_32x32x16_bf16 v[160:175], v[24:27], a[104:107], v[160:175]
  v_mfma_f32_32x32x16_bf16 v[160:175], v[28:31], a[108:111], v[160:175]
  s_waitcnt lgkmcnt(2)
  v_mfma_f32_32x32x16_bf16 v[160:175], v[32:35], a[112:115], v[160:175]
  v_mfma_f32_32x32x16_bf16 v[160:175], v[36:39], a[116:119], v[160:175]
  s_waitcnt lgkmcnt(0)
  v_mfma_f32_32x32x16_bf16 v[160:175], v[40:43], a[120:123], v[160:175]
  v_mfma_f32_32x32x16_bf16 v[160:175], v[44:47], a[124:127], v[160:175]
  s_nop 7
  s_nop 3
  s_waitcnt lgkmcnt(0)
  v_fmac_f32 v160, v8, v176
  v_fmac_f32 v161, v8, v177
  v_fmac_f32 v162, v8, v178
  v_fmac_f32 v163, v8, v179
  v_fmac_f32 v164, v8, v180
  v_fmac_f32 v165, v8, v181
  v_fmac_f32 v166, v8, v182
  v_fmac_f32 v167, v8, v183
  v_fmac_f32 v168, v8, v184
  v_fmac_f32 v169, v8, v185
  v_fmac_f32 v170, v8, v186
  v_fmac_f32 v171, v8, v187
  v_fmac_f32 v172, v8, v188
  v_fmac_f32 v173, v8, v189
  v_fmac_f32 v174, v8, v190
  v_fmac_f32 v175, v8, v191
  v_mul_f32 v192, v9, v160
  v_mul_f32 v193, v9, v161
  v_mul_f32 v194, v9, v162
  v_mul_f32 v195, v9, v163
  v_mul_f32 v196, v9, v164
  v_mul_f32 v197, v9, v165
  v_mul_f32 v198, v9, v166
  v_mul_f32 v199, v9, v167
  v_exp_f32 v192, v192
  v_mul_f32 v200, v160, v168
  v_exp_f32 v193, v193
  v_mul_f32 v201, v161, v169
  v_exp_f32 v194, v194
  v_mul_f32 v202, v162, v170
  v_exp_f32 v195, v195
  v_mul_f32 v203, v163, v171
  v_exp_f32 v196, v196
  v_mul_f32 v204, v164, v172
  v_exp_f32 v197, v197
  v_mul_f32 v205, v165, v173
  v_exp_f32 v198, v198
  v_mul_f32 v206, v166, v174
  v_exp_f32 v199, v199
  v_mul_f32 v207, v167, v175
  v_fma_f32 v192, v192, v10, v10
  v_fma_f32 v193, v193, v10, v10
  v_fma_f32 v194, v194, v10, v10
  v_fma_f32 v195, v195, v10, v10
  v_fma_f32 v196, v196, v10, v10
  v_fma_f32 v197, v197, v10, v10
  v_fma_f32 v198, v198, v10, v10
  v_fma_f32 v199, v199, v10, v10
  v_rcp_f32 v192, v192
  v_rcp_f32 v193, v193
  v_rcp_f32 v194, v194
  v_rcp_f32 v195, v195
  v_rcp_f32 v196, v196
  v_rcp_f32 v197, v197
  v_rcp_f32 v198, v198
  v_rcp_f32 v199, v199
  v_mul_f32 v200, v200, v192
  v_mul_f32 v201, v201, v193
  v_mul_f32 v202, v202, v194
  v_mul_f32 v203, v203, v195
  v_mul_f32 v204, v204, v196
  v_mul_f32 v205, v205, v197
  v_mul_f32 v206, v206, v198
  v_mul_f32 v207, v207, v199
  v_cvt_pk_bf16_f32 v208, v200, v201
  v_cvt_pk_bf16_f32 v209, v202, v203
  v_cvt_pk_bf16_f32 v210, v204, v205
  v_cvt_pk_bf16_f32 v211, v206, v207
  s_add_u32 s15, s14, 6144
  buffer_store_dwordx4 v[208:211], v2, s[52:55], s15 offen sc1
  s_add_u32 s84, s84, 4096
  s_add_u32 s85, s85, 4096
  buffer_load_dwordx4 a[0:3], v2, s[56:59], s84 offen offset:0
  buffer_load_dwordx4 a[4:7], v2, s[56:59], s85 offen offset:0
  buffer_load_dwordx4 a[8:11], v2, s[56:59], s84 offen offset:1024
  buffer_load_dwordx4 a[12:15], v2, s[56:59], s85 offen offset:1024
  s_waitcnt vmcnt(4)
  s_barrier
  s_lshl_b32 s83, s72, 7
  s_add_u32 s83, s83, 2048
  s_cmp_lg_u32 s3, 0
  s_cbranch_scc1 kf_sig2
  v_mov_b32 v250, 1
  v_mov_b32 v251, 0
  s_mov_b64 exec, 1
  buffer_atomic_add v250, v251, s[64:67], s83 offen sc1
  s_mov_b64 exec, -1
kf_sig2:
  buffer_load_dwordx4 a[16:19], v2, s[56:59], s84 offen offset:2048
  buffer_load_dwordx4 a[20:23], v2, s[56:59], s85 offen offset:2048
  buffer_load_dwordx4 a[24:27], v2, s[56:59], s84 offen offset:3072
  buffer_load_dwordx4 a[28:31], v2, s[56:59], s85 offen offset:3072
  s_add_u32 s84, s84, 4096
  s_add_u32 s85, s85, 4096
  buffer_load_dwordx4 a[32:35], v2, s[56:59], s84 offen offset:0
  buffer_load_dwordx4 a[36:39], v2, s[56:59], s85 offen offset:0
  buffer_load_dwordx4 a[40:43], v2, s[56:59], s84 offen offset:1024
  buffer_load_dwordx4 a[44:47], v2, s[56:59], s85 offen offset:1024
  buffer_load_dwordx4 a[48:51], v2, s[56:59], s84 offen offset:2048
  buffer_load_dwordx4 a[52:55], v2, s[56:59], s85 offen offset:2048
  buffer_load_dwordx4 a[56:59], v2, s[56:59], s84 offen offset:3072
  buffer_load_dwordx4 a[60:63], v2, s[56:59], s85 offen offset:3072
  s_add_u32 s84, s84, 4096
  s_add_u32 s85, s85, 4096
  buffer_load_dwordx4 a[64:67], v2, s[56:59], s84 offen offset:0
  buffer_load_dwordx4 a[68:71], v2, s[56:59], s85 offen offset:0
  buffer_load_dwordx4 a[72:75], v2, s[56:59], s84 offen offset:1024
  buffer_load_dwordx4 a[76:79], v2, s[56:59], s85 offen offset:1024
  buffer_load_dwordx4 a[80:83], v2, s[56:59], s84 offen offset:2048
  buffer_load_dwordx4 a[84:87], v2, s[56:59], s85 offen offset:2048
  buffer_load_dwordx4 a[88:91], v2, s[56:59], s84 offen offset:3072
  buffer_load_dwordx4 a[92:95], v2, s[56:59], s85 offen offset:3072
  s_add_u32 s36, s34, 5242880
  s_addc_u32 s37, s35, 0
  s_mov_b32 s38, 7340032
  s_mov_b32 s39, 0x20000
  s_mov_b32 s48, s30
  s_mov_b32 s49, s31
  s_mov_b32 s50, 2097152
  s_mov_b32 s51, 0x20000
  s_mul_i32 s8, s3, 28
  s_mul_i32 s9, s70, 112
  s_add_u32 s9, s9, s8
  s_lshl_b32 s9, s9, 10
  s_xor_b32 s11, s70, 1
  s_mul_i32 s11, s11, 112
  s_add_u32 s11, s11, s8
  s_lshl_b32 s11, s11, 10
  s_lshr_b32 s83, s68, 1
  s_lshl_b32 s83, s83, 7
  s_add_u32 s83, s83, 2048
  s_cmp_lg_u32 s3, 0
  s_cbranch_scc1 kf_w2_done
  v_mov_b32 v251, 0
  s_mov_b32 s76, 0
kf_w2:
  buffer_load_dword v250, v251, s[64:67], s83 offen sc1
  s_waitcnt vmcnt(0)
  v_readfirstlane_b32 s77, v250
  s_add_u32 s76, s76, 1
  s_nop 2
  s_cmp_ge_u32 s77, 16
  s_cbranch_scc1 kf_w2_done
  s_cmp_ge_u32 s76, 0x20000
  s_cbranch_scc1 kf_w2_done
  s_sleep 1
  s_branch kf_w2
kf_w2_done:
  s_barrier
  buffer_load_dwordx4 v[16:19], v2, s[36:39], s9 offen offset:0 sc1
  buffer_load_dwordx4 v[20:23], v2, s[36:39], s11 offen offset:0 sc1
  buffer_load_dwordx4 v[24:27], v2, s[36:39], s9 offen offset:1024 sc1
  buffer_load_dwordx4 v[28:31], v2, s[36:39], s11 offen offset:1024 sc1
  buffer_load_dwordx4 v[32:35], v2, s[36:39], s9 offen offset:2048 sc1
  buffer_load_dwordx4 v[36:39], v2, s[36:39], s11 offen offset:2048 sc1
  buffer_load_dwordx4 v[40:43], v2, s[36:39], s9 offen offset:3072 sc1
  buffer_load_dwordx4 v[44:47], v2, s[36:39], s11 offen offset:3072 sc1
  s_add_u32 s9, s9, 4096
  buffer_load_dwordx4 v[48:51], v2, s[36:39], s9 offen offset:0 sc1
  s_add_u32 s11, s11, 4096
  buffer_load_dwordx4 v[52:55], v2, s[36:39], s11 offen offset:0 sc1
  buffer_load_dwordx4 v[56:59], v2, s[36:39], s9 offen offset:1024 sc1
  buffer_load_dwordx4 v[60:63], v2, s[36:39], s11 offen offset:1024 sc1
  buffer_load_dwordx4 v[64:67], v2, s[36:39], s9 offen offset:2048 sc1
  buffer_load_dwordx4 v[68:71], v2, s[36:39], s11 offen offset:2048 sc1
  s_waitcnt vmcnt(12)
  v_mfma_f32_32x32x16_bf16 v[128:143], a[128:131], v[16:19], 0
  v_mfma_f32_32x32x16_bf16 v[144:159], a[132:135], v[16:19], 0
  v_mfma_f32_32x32x16_bf16 v[160:175], a[128:131], v[20:23], 0
  v_mfma_f32_32x32x16_bf16 v[176:191], a[132:135], v[20:23], 0
  buffer_load_dwordx4 v[16:19], v2, s[36:39], s9 offen offset:3072 sc1
  buffer_load_dwordx4 v[20:23], v2, s[36:39], s11 offen offset:3072 sc1
  s_waitcnt vmcnt(12)
  v_mfma_f32_32x32x16_bf16 v[128:143], a[136:139], v[24:27], v[128:143]
  v_mfma_f32_32x32x16_bf16 v[144:159], a[140:143], v[24:27], v[144:159]
  v_mfma_f32_32x32x16_bf16 v[160:175], a[136:139], v[28:31], v[160:175]
  v_mfma_f32_32x32x16_bf16 v[176:191], a[140:143], v[28:31], v[176:191]
  s_add_u32 s9, s9, 4096
  buffer_load_dwordx4 v[24:27], v2, s[36:39], s9 offen offset:0 sc1
  s_add_u32 s11, s11, 4096
  buffer_load_dwordx4 v[28:31], v2, s[36:39], s11 offen offset:0 sc1
  s_waitcnt vmcnt(12)
  v_mfma_f32_32x32x16_bf16 v[128:143], a[144:147], v[32:35], v[128:143]
  v_mfma_f32_32x32x16_bf16 v[144:159], a[148:151], v[32:35], v[144:159]
  v_mfma_f32_32x32x16_bf16 v[160:175], a[144:147], v[36:39], v[160:175]
  v_mfma_f32_32x32x16_bf16 v[176:191], a[148:151], v[36:39], v[176:191]
  buffer_load_dwordx4 v[32:35], v2, s[36:39], s9 offen offset:1024 sc1
  buffer_load_dwordx4 v[36:39], v2, s[36:39], s11 offen offset:1024 sc1
  s_waitcnt vmcnt(12)
  v_mfma_f32_32x32x16_bf16 v[128:143], a[152:155], v[40:43], v[128:143]
  v_mfma_f32_32x32x16_bf16 v[144:159], a[156:159], v[40:43], v[144:159]
  v_mfma_f32_32x32x16_bf16 v[160:175], a[152:155], v[44:47], v[160:175]
  v_mfma_f32_32x32x16_bf16 v[176:191], a[156:159], v[44:47], v[176:191]
  buffer_load_dwordx4 v[40:43], v2, s[36:39], s9 offen offset:2048 sc1
  buffer_load_dwordx4 v[44:47], v2, s[36:39], s11 offen offset:2048 sc1
  s_waitcnt vmcnt(12)
  v_mfma_f32_32x32x16_bf16 v[128:143], a[160:163], v[48:51], v[128:143]
  v_mfma_f32_32x32x16_bf16 v[144:159], a[164:167], v[48:51], v[144:159]
  v_mfma_f32_32x32x16_bf16 v[160:175], a[160:163], v[52:55], v[160:175]
  v_mfma_f32_32x32x16_bf16 v[176:191], a[164:167], v[52:55], v[176:191]
  buffer_load_dwordx4 v[48:51], v2, s[36:39], s9 offen offset:3072 sc1
  buffer_load_dwordx4 v[52:55], v2, s[36:39], s11 offen offset:3072 sc1
  s_waitcnt vmcnt(12)
  v_mfma_f32_32x32x16_bf16 v[128:143], a[168:171], v[56:59], v[128:143]
  v_mfma_f32_32x32x16_bf16 v[144:159], a[172:175], v[56:59], v[144:159]
  v_mfma_f32_32x32x16_bf16 v[160:175], a[168:171], v[60:63], v[160:175]
  v_mfma_f32_32x32x16_bf16 v[176:191], a[172:175], v[60:63], v[176:191]
  s_add_u32 s9, s9, 4096
  buffer_load_dwordx4 v[56:59], v2, s[36:39], s9 offen offset:0 sc1
  s_add_u32 s11, s11, 4096
  buffer_load_dwordx4 v[60:63], v2, s[36:39], s11 offen offset:0 sc1
  s_waitcnt vmcnt(12)
  v_mfma_f32_32x32x16_bf16 v[128:143], a[176:179], v[64:67], v[128:143]
  v_mfma_f32_32x32x16_bf16 v[144:159], a[180:183], v[64:67], v[144:159]
  v_mfma_f32_32x32x16_bf16 v[160:175], a[176:179], v[68:71], v[160:175]
  v_mfma_f32_32x32x16_bf16 v[176:191], a[180:183], v[68:71], v[176:191]
  buffer_load_dwordx4 v[64:67], v2, s[36:39], s9 offen offset:1024 sc1
  buffer_load_dwordx4 v[68:71], v2, s[36:39], s11 offen offset:1024 sc1
  s_waitcnt vmcnt(12)
  v_mfma_f32_32x32x16_bf16 v[128:143], a[184:187], v[16:19], v[128:143]
  v_mfma_f32_32x32x16_bf16 v[144:159], a[188:191], v[16:19], v[144:159]
  v_mfma_f32_32x32x16_bf16 v[160:175], a[184:187], v[20:23], v[160:175]
  v_mfma_f32_32x32x16_bf16 v[176:191], a[188:191], v[20:23], v[176:191]
  buffer_load_dwordx4 v[16:19], v2, s[36:39], s9 offen offset:2048 sc1
  buffer_load_dwordx4 v[20:23], v2, s[36:39], s11 offen offset:2048 sc1
  s_waitcnt vmcnt(12)
  v_mfma_f32_32x32x16_bf16 v[128:143], a[192:195], v[24:27], v[128:143]
  v_mfma_f32_32x32x16_bf16 v[144:159], a[196:199], v[24:27], v[144:159]
  v_mfma_f32_32x32x16_bf16 v[160:175], a[192:195], v[28:31], v[160:175]
  v_mfma_f32_32x32x16_bf16 v[176:191], a[196:199], v[28:31], v[176:191]
  buffer_load_dwordx4 v[24:27], v2, s[36:39], s9 offen offset:3072 sc1
  buffer_load_dwordx4 v[28:31], v2, s[36:39], s11 offen offset:3072 sc1
  s_waitcnt vmcnt(12)
  v_mfma_f32_32x32x16_bf16 v[128:143], a[200:203], v[32:35], v[128:143]
  v_mfma_f32_32x32x16_bf16 v[144:159], a[204:207], v[32:35], v[144:159]
  v_mfma_f32_32x32x16_bf16 v[160:175], a[200:203], v[36:39], v[160:175]
  v_mfma_f32_32x32x16_bf16 v[176:191], a[204:207], v[36:39], v[176:191]
  s_add_u32 s9, s9, 4096
  buffer_load_dwordx4 v[32:35], v2, s[36:39], s9 offen offset:0 sc1
  s_add_u32 s11, s11, 4096
  buffer_load_dwordx4 v[36:39], v2, s[36:39], s11 offen offset:0 sc1
  s_waitcnt vmcnt(12)
  v_mfma_f32_32x32x16_bf16 v[128:143], a[208:211], v[40:43], v[128:143]
  v_mfma_f32_32x32x16_bf16 v[144:159], a[212:215], v[40:43], v[144:159]
  v_mfma_f32_32x32x16_bf16 v[160:175], a[208:211], v[44:47], v[160:175]
  v_mfma_f32_32x32x16_bf16 v[176:191], a[212:215], v[44:47], v[176:191]
  buffer_load_dwordx4 v[40:43], v2, s[36:39], s9 offen offset:1024 sc1
  buffer_load_dwordx4 v[44:47], v2, s[36:39], s11 offen offset:1024 sc1
  s_waitcnt vmcnt(12)
  v_mfma_f32_32x32x16_bf16 v[128:143], a[216:219], v[48:51], v[128:143]
  v_mfma_f32_32x32x16_bf16 v[144:159], a[220:223], v[48:51], v[144:159]
  v_mfma_f32_32x32x16_bf16 v[160:175], a[216:219], v[52:55], v[160:175]
  v_mfma_f32_32x32x16_bf16 v[176:191], a[220:223], v[52:55], v[176:191]
  buffer_load_dwordx4 v[48:51], v2, s[36:39], s9 offen offset:2048 sc1
  buffer_load_dwordx4 v[52:55], v2, s[36:39], s11 offen offset:2048 sc1
  s_waitcnt vmcnt(12)
  v_mfma_f32_32x32x16_bf16 v[128:143], a[224:227], v[56:59], v[128:143]
  v_mfma_f32_32x32x16_bf16 v[144:159], a[228:231], v[56:59], v[144:159]
  v_mfma_f32_32x32x16_bf16 v[160:175], a[224:227], v[60:63], v[160:175]
  v_mfma_f32_32x32x16_bf16 v[176:191], a[228:231], v[60:63], v[176:191]
  buffer_load_dwordx4 v[56:59], v2, s[36:39], s9 offen offset:3072 sc1
  buffer_load_dwordx4 v[60:63], v2, s[36:39], s11 offen offset:3072 sc1
  s_waitcnt vmcnt(12)
  v_mfma_f32_32x32x16_bf16 v[128:143], a[232:235], v[64:67], v[128:143]
  v_mfma_f32_32x32x16_bf16 v[144:159], a[236:239], v[64:67], v[144:159]
  v_mfma_f32_32x32x16_bf16 v[160:175], a[232:235], v[68:71], v[160:175]
  v_mfma_f32_32x32x16_bf16 v[176:191], a[236:239], v[68:71], v[176:191]
  s_add_u32 s9, s9, 4096
  buffer_load_dwordx4 v[64:67], v2, s[36:39], s9 offen offset:0 sc1
  s_add_u32 s11, s11, 4096
  buffer_load_dwordx4 v[68:71], v2, s[36:39], s11 offen offset:0 sc1
  s_waitcnt vmcnt(12)
  v_mfma_f32_32x32x16_bf16 v[128:143], a[240:243], v[16:19], v[128:143]
  v_mfma_f32_32x32x16_bf16 v[144:159], a[244:247], v[16:19], v[144:159]
  v_mfma_f32_32x32x16_bf16 v[160:175], a[240:243], v[20:23], v[160:175]
  v_mfma_f32_32x32x16_bf16 v[176:191], a[244:247], v[20:23], v[176:191]
  buffer_load_dwordx4 v[16:19], v2, s[36:39], s9 offen offset:1024 sc1
  buffer_load_dwordx4 v[20:23], v2, s[36:39], s11 offen offset:1024 sc1
  s_waitcnt vmcnt(12)
  v_mfma_f32_32x32x16_bf16 v[128:143], a[248:251], v[24:27], v[128:143]
  v_mfma_f32_32x32x16_bf16 v[144:159], a[252:255], v[24:27], v[144:159]
  v_mfma_f32_32x32x16_bf16 v[160:175], a[248:251], v[28:31], v[160:175]
  v_mfma_f32_32x32x16_bf16 v[176:191], a[252:255], v[28:31], v[176:191]
  buffer_load_dwordx4 v[24:27], v2, s[36:39], s9 offen offset:2048 sc1
  buffer_load_dwordx4 v[28:31], v2, s[36:39], s11 offen offset:2048 sc1
  s_waitcnt vmcnt(12)
  v_mfma_f32_32x32x16_bf16 v[128:143], a[0:3], v[32:35], v[128:143]
  v_mfma_f32_32x32x16_bf16 v[144:159], a[4:7], v[32:35], v[144:159]
  v_mfma_f32_32x32x16_bf16 v[160:175], a[0:3], v[36:39], v[160:175]
  v_mfma_f32_32x32x16_bf16 v[176:191], a[4:7], v[36:39], v[176:191]
  buffer_load_dwordx4 v[32:35], v2, s[36:39], s9 offen offset:3072 sc1
  buffer_load_dwordx4 v[36:39], v2, s[36:39], s11 offen offset:3072 sc1
  s_waitcnt vmcnt(12)
  v_mfma_f32_32x32x16_bf16 v[128:143], a[8:11], v[40:43], v[128:143]
  v_mfma_f32_32x32x16_bf16 v[144:159], a[12:15], v[40:43], v[144:159]
  v_mfma_f32_32x32x16_bf16 v[160:175], a[8:11], v[44:47], v[160:175]
  v_mfma_f32_32x32x16_bf16 v[176:191], a[12:15], v[44:47], v[176:191]
  s_add_u32 s9, s9, 4096
  buffer_load_dwordx4 v[40:43], v2, s[36:39], s9 offen offset:0 sc1
  s_add_u32 s11, s11, 4096
  buffer_load_dwordx4 v[44:47], v2, s[36:39], s11 offen offset:0 sc1
  s_waitcnt vmcnt(12)
  v_mfma_f32_32x32x16_bf16 v[128:143], a[16:19], v[48:51], v[128:143]
  v_mfma_f32_32x32x16_bf16 v[144:159], a[20:23], v[48:51], v[144:159]
  v_mfma_f32_32x32x16_bf16 v[160:175], a[16:19], v[52:55], v[160:175]
  v_mfma_f32_32x32x16_bf16 v[176:191], a[20:23], v[52:55], v[176:191]
  buffer_load_dwordx4 v[48:51], v2, s[36:39], s9 offen offset:1024 sc1
  buffer_load_dwordx4 v[52:55], v2, s[36:39], s11 offen offset:1024 sc1
  s_waitcnt vmcnt(12)
  v_mfma_f32_32x32x16_bf16 v[128:143], a[24:27], v[56:59], v[128:143]
  v_mfma_f32_32x32x16_bf16 v[144:159], a[28:31], v[56:59], v[144:159]
  v_mfma_f32_32x32x16_bf16 v[160:175], a[24:27], v[60:63], v[160:175]
  v_mfma_f32_32x32x16_bf16 v[176:191], a[28:31], v[60:63], v[176:191]
  buffer_load_dwordx4 v[56:59], v2, s[36:39], s9 offen offset:2048 sc1
  buffer_load_dwordx4 v[60:63], v2, s[36:39], s11 offen offset:2048 sc1
  s_waitcnt vmcnt(12)
  v_mfma_f32_32x32x16_bf16 v[128:143], a[32:35], v[64:67], v[128:143]
  v_mfma_f32_32x32x16_bf16 v[144:159], a[36:39], v[64:67], v[144:159]
  v_mfma_f32_32x32x16_bf16 v[160:175], a[32:35], v[68:71], v[160:175]
  v_mfma_f32_32x32x16_bf16 v[176:191], a[36:39], v[68:71], v[176:191]
  buffer_load_dwordx4 v[64:67], v2, s[36:39], s9 offen offset:3072 sc1
  buffer_load_dwordx4 v[68:71], v2, s[36:39], s11 offen offset:3072 sc1
  s_waitcnt vmcnt(12)
  v_mfma_f32_32x32x16_bf16 v[128:143], a[40:43], v[16:19], v[128:143]
  v_mfma_f32_32x32x16_bf16 v[144:159], a[44:47], v[16:19], v[144:159]
  v_mfma_f32_32x32x16_bf16 v[160:175], a[40:43], v[20:23], v[160:175]
  v_mfma_f32_32x32x16_bf16 v[176:191], a[44:47], v[20:23], v[176:191]
  s_waitcnt vmcnt(10)
  v_mfma_f32_32x32x16_bf16 v[128:143], a[48:51], v[24:27], v[128:143]
  v_mfma_f32_32x32x16_bf16 v[144:159], a[52:55], v[24:27], v[144:159]
  v_mfma_f32_32x32x16_bf16 v[160:175], a[48:51], v[28:31], v[160:175]
  v_mfma_f32_32x32x16_bf16 v[176:191], a[52:55], v[28:31], v[176:191]
  s_waitcnt vmcnt(8)
  v_mfma_f32_32x32x16_bf16 v[128:143], a[56:59], v[32:35], v[128:143]
  v_mfma_f32_32x32x16_bf16 v[144:159], a[60:63], v[32:35], v[144:159]
  v_mfma_f32_32x32x16_bf16 v[160:175], a[56:59], v[36:39], v[160:175]
  v_mfma_f32_32x32x16_bf16 v[176:191], a[60:63], v[36:39], v[176:191]
  s_waitcnt vmcnt(6)
  v_mfma_f32_32x32x16_bf16 v[128:143], a[64:67], v[40:43], v[128:143]
  v_mfma_f32_32x32x16_bf16 v[144:159], a[68:71], v[40:43], v[144:159]
  v_mfma_f32_32x32x16_bf16 v[160:175], a[64:67], v[44:47], v[160:175]
  v_mfma_f32_32x32x16_bf16 v[176:191], a[68:71], v[44:47], v[176:191]
  s_waitcnt vmcnt(4)
  v_mfma_f32_32x32x16_bf16 v[128:143], a[72:75], v[48:51], v[128:143]
  v_mfma_f32_32x32x16_bf16 v[144:159], a[76:79], v[48:51], v[144:159]
  v_mfma_f32_32x32x16_bf16 v[160:175], a[72:75], v[52:55], v[160:175]
  v_mfma_f32_32x32x16_bf16 v[176:191], a[76:79], v[52:55], v[176:191]
  s_waitcnt vmcnt(2)
  v_mfma_f32_32x32x16_bf16 v[128:143], a[80:83], v[56:59], v[128:143]
  v_mfma_f32_32x32x16_bf16 v[144:159], a[84:87], v[56:59], v[144:159]
  v_mfma_f32_32x32x16_bf16 v[160:175], a[80:83], v[60:63], v[160:175]
  v_mfma_f32_32x32x16_bf16 v[176:191], a[84:87], v[60:63], v[176:191]
  s_waitcnt vmcnt(0)
  v_mfma_f32_32x32x16_bf16 v[128:143], a[88:91], v[64:67], v[128:143]
  v_mfma_f32_32x32x16_bf16 v[144:159], a[92:95], v[64:67], v[144:159]
  v_mfma_f32_32x32x16_bf16 v[160:175], a[88:91], v[68:71], v[160:175]
  v_mfma_f32_32x32x16_bf16 v[176:191], a[92:95], v[68:71], v[176:191]
  s_nop 7
  s_nop 3
  v_lshlrev_b32 v7, 4, v0
  s_xor_b32 s8, s3, 1
  s_mulk_i32 s8, 12288
  s_add_u32 s8, s8, 0
  v_add_u32 v6, s8, v7
  ds_write_b128 v6, v[144:147] offset:0
  ds_write_b128 v6, v[148:151] offset:1024
  ds_write_b128 v6, v[152:155] offset:2048
  ds_write_b128 v6, v[156:159] offset:3072
  s_xor_b32 s8, s3, 2
  s_mulk_i32 s8, 12288
  s_add_u32 s8, s8, 0
  v_add_u32 v6, s8, v7
  ds_write_b128 v6, v[160:163] offset:4096
  ds_write_b128 v6, v[164:167] offset:5120
  ds_write_b128 v6, v[168:171] offset:6144
  ds_write_b128 v6, v[172:175] offset:7168
  s_xor_b32 s8, s3, 3
  s_mulk_i32 s8, 12288
  s_add_u32 s8, s8, 0
  v_add_u32 v6, s8, v7
  ds_write_b128 v6, v[176:179] offset:8192
  ds_write_b128 v6, v[180:183] offset:9216
  ds_write_b128 v6, v[184:187] offset:10240
  ds_write_b128 v6, v[188:191] offset:11264
  s_mul_i32 s8, s3, 12288
  s_add_u32 s8, s8, 0
  v_add_u32 v6, s8, v7
  s_waitcnt lgkmcnt(0)
  s_barrier
  ds_read_b128 v[80:83], v6 offset:0
  ds_read_b128 v[84:87], v6 offset:1024
  ds_read_b128 v[88:91], v6 offset:2048
  ds_read_b128 v[92:95], v6 offset:3072
  ds_read_b128 v[96:99], v6 offset:4096
  ds_read_b128 v[100:103], v6 offset:5120
  ds_read_b128 v[104:107], v6 offset:6144
  ds_read_b128 v[108:111], v6 offset:7168
  ds_read_b128 v[112:115], v6 offset:8192
  ds_read_b128 v[116:119], v6 offset:9216
  ds_read_b128 v[120:123], v6 offset:10240
  ds_read_b128 v[124:127], v6 offset:11264
  s_waitcnt lgkmcnt(8)
  v_pk_add_f32 v[64:65], v[128:129], v[80:81]
  v_pk_add_f32 v[66:67], v[130:131], v[82:83]
  v_pk_add_f32 v[68:69], v[132:133], v[84:85]
  v_pk_add_f32 v[70:71], v[134:135], v[86:87]
  v_pk_add_f32 v[72:73], v[136:137], v[88:89]
  v_pk_add_f32 v[74:75], v[138:139], v[90:91]
  v_pk_add_f32 v[76:77], v[140:141], v[92:93]
  v_pk_add_f32 v[78:79], v[142:143], v[94:95]
  s_waitcnt lgkmcnt(0)
  v_pk_add_f32 v[96:97], v[96:97], v[112:113]
  v_pk_add_f32 v[98:99], v[98:99], v[114:115]
  v_pk_add_f32 v[100:101], v[100:101], v[116:117]
  v_pk_add_f32 v[102:103], v[102:103], v[118:119]
  v_pk_add_f32 v[104:105], v[104:105], v[120:121]
  v_pk_add_f32 v[106:107], v[106:107], v[122:123]
  v_pk_add_f32 v[108:109], v[108:109], v[124:125]
  v_pk_add_f32 v[110:111], v[110:111], v[126:127]
  v_pk_add_f32 v[64:65], v[64:65], v[96:97]
  v_pk_add_f32 v[66:67], v[66:67], v[98:99]
  v_pk_add_f32 v[68:69], v[68:69], v[100:101]
  v_pk_add_f32 v[70:71], v[70:71], v[102:103]
  v_pk_add_f32 v[72:73], v[72:73], v[104:105]
  v_pk_add_f32 v[74:75], v[74:75], v[106:107]
  v_pk_add_f32 v[76:77], v[76:77], v[108:109]
  v_pk_add_f32 v[78:79], v[78:79], v[110:111]
  v_lshlrev_b32 v8, 16, v240
  v_and_b32 v9, 0xffff0000, v240
  v_pk_add_f32 v[64:65], v[64:65], v[8:9]
  v_lshlrev_b32 v10, 16, v241
  v_and_b32 v11, 0xffff0000, v241
  v_pk_add_f32 v[66:67], v[66:67], v[10:11]
  v_lshlrev_b32 v12, 16, v242
  v_and_b32 v13, 0xffff0000, v242
  v_pk_add_f32 v[68:69], v[68:69], v[12:13]
  v_lshlrev_b32 v14, 16, v243
  v_and_b32 v15, 0xffff0000, v243
  v_pk_add_f32 v[70:71], v[70:71], v[14:15]
  v_lshlrev_b32 v8, 16, v244
  v_and_b32 v9, 0xffff0000, v244
  v_pk_add_f32 v[72:73], v[72:73], v[8:9]
  v_lshlrev_b32 v10, 16, v245
  v_and_b32 v11, 0xffff0000, v245
  v_pk_add_f32 v[74:75], v[74:75], v[10:11]
  v_lshlrev_b32 v12, 16, v246
  v_and_b32 v13, 0xffff0000, v246
  v_pk_add_f32 v[76:77], v[76:77], v[12:13]
  v_lshlrev_b32 v14, 16, v247
  v_and_b32 v15, 0xffff0000, v247
  v_pk_add_f32 v[78:79], v[78:79], v[14:15]
  v_cvt_pk_bf16_f32 v96, v64, v65
  v_cvt_pk_bf16_f32 v97, v66, v67
  v_cvt_pk_bf16_f32 v98, v68, v69
  v_cvt_pk_bf16_f32 v99, v70, v71
  v_cvt_pk_bf16_f32 v100, v72, v73
  v_cvt_pk_bf16_f32 v101, v74, v75
  v_cvt_pk_bf16_f32 v102, v76, v77
  v_cvt_pk_bf16_f32 v103, v78, v79
  s_nop 1
  v_permlane32_swap_b32 v96, v98
  v_permlane32_swap_b32 v97, v99
  v_permlane32_swap_b32 v100, v102
  v_permlane32_swap_b32 v101, v103
  v_lshlrev_b32 v6, 10, v3
  v_lshl_add_u32 v6, v5, 4, v6
  s_lshl_b32 s8, s70, 15
  s_lshl_b32 s9, s69, 7
  s_add_u32 s8, s8, s9
  s_lshl_b32 s9, s71, 6
  s_add_u32 s8, s8, s9
  buffer_store_dwordx4 v[96:99], v6, s[48:51], s8 offen offset:0
  buffer_store_dwordx4 v[100:103], v6, s[48:51], s8 offen offset:32
kf_end:
  s_endpgm

code_end:
  s_endpgm
.section .rodata,"a"
.p2align 6
.amdhsa_kernel k1_kernel
  .amdhsa_next_free_vgpr 256
  .amdhsa_next_free_sgpr 100
  .amdhsa_accum_offset 256
  .amdhsa_group_segment_fixed_size 0
  .amdhsa_kernarg_size 80
  .amdhsa_user_sgpr_count 2
  .amdhsa_user_sgpr_kernarg_segment_ptr 1
  .amdhsa_system_sgpr_workgroup_id_x 1
.end_amdhsa_kernel

.p2align 6
.amdhsa_kernel kf_kernel
  .amdhsa_next_free_vgpr 512
  .amdhsa_next_free_sgpr 100
  .amdhsa_accum_offset 256
  .amdhsa_group_segment_fixed_size 0
  .amdhsa_kernarg_size 80
  .amdhsa_user_sgpr_count 2
  .amdhsa_user_sgpr_kernarg_segment_ptr 1
  .amdhsa_system_sgpr_workgroup_id_x 1
.end_amdhsa_kernel
```
